```python
import torch

def _softmax(x, axis=-1):
    return torch.softmax(x, dim=axis)

def _gelu(x):
    return torch.nn.functional.gelu(x, approximate='tanh')

def _silu(x):
    return torch.nn.functional.silu(x)

def _sigmoid(x):
    return torch.sigmoid(x)

def _layernorm(x, axis=-1, eps=1e-05):
    m = x.mean(dim=axis, keepdim=True)
    v = x.var(dim=axis, keepdim=True, unbiased=False)
    return (x - m) / torch.sqrt(v + eps)

def _scatter_add(tgt, idx, src, axis=0):
    return tgt.clone().index_add_(axis, idx, src)

def _segment_sum(src, seg, n):
    out = torch.zeros((n,) + src.shape[1:], dtype=src.dtype)
    return out.index_add_(0, seg, src)

def _pad(x, pw):
    flat = tuple((v for pair in reversed(pw) for v in pair))
    return torch.nn.functional.pad(x, flat)
kernel_name = 'standalone__memory_aug_recurrent_mem_tr__prompt'

def setup_inputs():

    _w = lambda a: (lambda t: t.to(torch.bfloat16) if t.is_floating_point() else t)(torch.as_tensor(a))
    B, S, Dm = (1, 2048, 448)
    H, Dh = (16, 256)
    M, seg = (8, 32)
    seg = min(seg, S)
    S = S // seg * seg
    return {'x': _w((lambda *s: torch.randn(*s, dtype=torch.bfloat16) * 0.05)(B, S, Dm)), 'mem0': _w((lambda *s: torch.randn(*s, dtype=torch.bfloat16) * 0.4)(B, M, Dm)), 'Wq': _w((lambda *s: torch.randn(*s, dtype=torch.bfloat16) * 6.4)(Dm, H, Dh) * Dm ** (-0.5)), 'Wk': _w((lambda *s: torch.randn(*s, dtype=torch.bfloat16) * 6.4)(Dm, H, Dh) * Dm ** (-0.5)), 'Wv': _w((lambda *s: torch.randn(*s, dtype=torch.bfloat16) * 0.4)(Dm, H, Dh) * Dm ** (-0.5)), 'Wo': _w((lambda *s: torch.randn(*s, dtype=torch.bfloat16) * 0.4)(H, Dh, Dm) * (H * Dh) ** (-0.5)), 'seg_len': seg}

def reference(x, mem0, Wq, Wk, Wv, Wo, seg_len):
    B, S, Dm = x.shape
    H, Dh = (Wq.shape[1], Wq.shape[2])
    M = mem0.shape[1]
    scale = Dh ** (-0.5)
    n_seg = S // seg_len
    L = M + seg_len
    idx = torch.arange(L)
    mask = (idx[:, None] < M) | (idx[:, None] >= idx[None, :])
    mem = mem0
    outs = []
    for s in range(n_seg):
        xs = x[:, s * seg_len:(s + 1) * seg_len, :].clone()
        h = torch.concatenate([mem, xs], axis=1)
        q = torch.einsum('btd,dhe->bhte', h, Wq)
        k = torch.einsum('btd,dhe->bhte', h, Wk)
        v = torch.einsum('btd,dhe->bhte', h, Wv)
        scores = torch.einsum('bhqe,bhke->bhqk', q, k) * scale
        scores = torch.where(mask[None, None], scores, -1000000000.0)
        p = _softmax(scores, axis=-1)
        o = torch.einsum('bhqk,bhke->bhqe', p, v)
        o = torch.einsum('bhte,hed->btd', o, Wo)
        mem = o[:, :M, :].clone()
        outs.append(o[:, M:, :])
    return torch.concatenate(outs, axis=1)
```

```asm
; @launch grid=(256,1,1) block=(256,1,1) lds=98304
.amdgcn_target "amdgcn-amd-amdhsa--gfx950"
.text
.globl standalone__memory_aug_recurrent_mem_tr__prompt_kernel
.p2align 8
.type standalone__memory_aug_recurrent_mem_tr__prompt_kernel,@function
standalone__memory_aug_recurrent_mem_tr__prompt_kernel:
    s_cmp_ge_u32 s2, 256
    s_cbranch_scc1 Lexit0
    s_load_dwordx4 s[4:7], s[0:1], 0
    s_load_dwordx4 s[44:47], s[0:1], 16
    s_load_dwordx4 s[48:51], s[0:1], 32
    s_load_dwordx4 s[56:59], s[0:1], 64
    v_lshrrev_b32 v3, 6, v0
    v_and_b32 v1, 63, v0
    v_lshrrev_b32 v2, 4, v1
    v_lshlrev_b32 v9, 4, v1
    v_readfirstlane_b32 s32, v3
    s_waitcnt lgkmcnt(0)
    s_mov_b32 s52, s58
    s_mov_b32 s53, s59
    s_mov_b32 s24, s4
    s_mov_b32 s25, s5
    s_mov_b32 s26, 1835008
    s_mov_b32 s27, 0x00020000
    s_mov_b32 s28, s6
    s_mov_b32 s29, s7
    s_mov_b32 s30, 7168
    s_mov_b32 s31, 0x00020000
    s_mov_b32 s20, s52
    s_mov_b32 s21, s53
    s_mov_b32 s22, 268435456
    s_mov_b32 s23, 0x00020000
    s_mov_b32 s60, s56
    s_mov_b32 s61, s57
    s_mov_b32 s62, 256
    s_mov_b32 s63, 0x00020000
    s_cmp_eq_u32 s2, 0
    s_cbranch_scc0 Lnn
    s_cmp_eq_u32 s32, 0
    s_cbranch_scc0 Lnn
    s_memrealtime s[64:65]
    s_waitcnt lgkmcnt(0)
    s_or_b32 s64, s64, 1
    v_mov_b32 v248, s64
    v_mov_b32 v249, 0
    s_mov_b64 exec, 1
    buffer_store_dword v248, v249, s[60:63], 0 offen sc1
    s_mov_b64 exec, -1
Lnn:
    s_and_b32 s36, s2, 7
    s_cmp_eq_u32 s36, 0
    s_cbranch_scc0 Lk1_fold
    s_lshr_b32 s40, s2, 3
    s_lshl_b32 s40, s40, 2
    s_add_u32 s40, s40, s32
    v_bfe_u32 v5, v1, 3, 1
    v_lshlrev_b32 v7, 4, v5
    v_bfe_u32 v5, v1, 1, 1
    v_lshl_add_u32 v7, v5, 2, v7
    v_bfe_u32 v5, v1, 2, 1
    v_lshl_add_u32 v7, v5, 1, v7
    v_and_b32 v5, 1, v1
    v_add_u32 v7, v7, v5
    v_mul_u32_u24 v7, 896, v7
    v_lshl_add_u32 v7, v2, 4, v7
    s_lshr_b32 s36, s40, 1
    s_mul_i32 s37, s36, 28672
    s_and_b32 s38, s40, 1
    s_mul_i32 s39, s38, 7168
    s_add_u32 s37, s37, s39
    buffer_load_dwordx4 v[16:19], v7, s[24:27], s37 offen offset:0
    buffer_load_dwordx4 v[20:23], v7, s[24:27], s37 offen offset:64
    buffer_load_dwordx4 v[24:27], v7, s[24:27], s37 offen offset:128
    buffer_load_dwordx4 v[28:31], v7, s[24:27], s37 offen offset:192
    buffer_load_dwordx4 v[32:35], v7, s[24:27], s37 offen offset:256
    buffer_load_dwordx4 v[36:39], v7, s[24:27], s37 offen offset:320
    buffer_load_dwordx4 v[40:43], v7, s[24:27], s37 offen offset:384
    buffer_load_dwordx4 v[44:47], v7, s[24:27], s37 offen offset:448
    buffer_load_dwordx4 v[48:51], v7, s[24:27], s37 offen offset:512
    buffer_load_dwordx4 v[52:55], v7, s[24:27], s37 offen offset:576
    buffer_load_dwordx4 v[56:59], v7, s[24:27], s37 offen offset:640
    buffer_load_dwordx4 v[60:63], v7, s[24:27], s37 offen offset:704
    buffer_load_dwordx4 v[64:67], v7, s[24:27], s37 offen offset:768
    buffer_load_dwordx4 v[68:71], v7, s[24:27], s37 offen offset:832
    s_mul_i32 s39, s40, 14336
    s_add_u32 s39, s39, 65011712
    s_cmp_lt_u32 s40, 7
    s_cbranch_scc0 Lm0_1
    s_lshl_b32 s41, s40, 6
    v_add_u32 v5, s41, v1
    v_lshlrev_b32 v6, 1, v5
    s_mov_b32 s38, 3584
    buffer_load_ushort v130, v6, s[28:31], 0 offen offset:0
    buffer_load_ushort v131, v6, s[28:31], 0 offen offset:896
    buffer_load_ushort v132, v6, s[28:31], 0 offen offset:1792
    buffer_load_ushort v133, v6, s[28:31], 0 offen offset:2688
    buffer_load_ushort v134, v6, s[28:31], 0 offen offset:3584
    buffer_load_ushort v135, v6, s[28:31], s38 offen offset:896
    buffer_load_ushort v136, v6, s[28:31], s38 offen offset:1792
    buffer_load_ushort v137, v6, s[28:31], s38 offen offset:2688
    s_waitcnt vmcnt(0)
    v_lshl_or_b32 v140, v131, 16, v130
    v_lshl_or_b32 v141, v133, 16, v132
    v_lshl_or_b32 v142, v135, 16, v134
    v_lshl_or_b32 v143, v137, 16, v136
    v_lshlrev_b32 v5, 4, v5
    s_mov_b32 s38, 13631488
    buffer_store_dwordx4 v[140:143], v5, s[20:23], s38 offen sc1
Lm0_1:
    v_mov_b32 v10, -1
    v_mov_b32 v11, -1
    v_mov_b32 v12, -1
    v_mov_b32 v13, -1
    s_add_u32 s41, s40, 0
    s_cmp_lt_u32 s41, 2041
    s_cbranch_scc0 Lfl_2
    s_lshl_b32 s41, s41, 10
    s_add_u32 s41, s41, 13638656
    buffer_store_dwordx4 v[10:13], v9, s[20:23], s41 offen sc1
Lfl_2:
    s_add_u32 s41, s40, 128
    s_cmp_lt_u32 s41, 2041
    s_cbranch_scc0 Lfl_3
    s_lshl_b32 s41, s41, 10
    s_add_u32 s41, s41, 13638656
    buffer_store_dwordx4 v[10:13], v9, s[20:23], s41 offen sc1
Lfl_3:
    s_add_u32 s41, s40, 256
    s_cmp_lt_u32 s41, 2041
    s_cbranch_scc0 Lfl_4
    s_lshl_b32 s41, s41, 10
    s_add_u32 s41, s41, 13638656
    buffer_store_dwordx4 v[10:13], v9, s[20:23], s41 offen sc1
Lfl_4:
    s_add_u32 s41, s40, 384
    s_cmp_lt_u32 s41, 2041
    s_cbranch_scc0 Lfl_5
    s_lshl_b32 s41, s41, 10
    s_add_u32 s41, s41, 13638656
    buffer_store_dwordx4 v[10:13], v9, s[20:23], s41 offen sc1
Lfl_5:
    s_add_u32 s41, s40, 512
    s_cmp_lt_u32 s41, 2041
    s_cbranch_scc0 Lfl_6
    s_lshl_b32 s41, s41, 10
    s_add_u32 s41, s41, 13638656
    buffer_store_dwordx4 v[10:13], v9, s[20:23], s41 offen sc1
Lfl_6:
    s_add_u32 s41, s40, 640
    s_cmp_lt_u32 s41, 2041
    s_cbranch_scc0 Lfl_7
    s_lshl_b32 s41, s41, 10
    s_add_u32 s41, s41, 13638656
    buffer_store_dwordx4 v[10:13], v9, s[20:23], s41 offen sc1
Lfl_7:
    s_add_u32 s41, s40, 768
    s_cmp_lt_u32 s41, 2041
    s_cbranch_scc0 Lfl_8
    s_lshl_b32 s41, s41, 10
    s_add_u32 s41, s41, 13638656
    buffer_store_dwordx4 v[10:13], v9, s[20:23], s41 offen sc1
Lfl_8:
    s_add_u32 s41, s40, 896
    s_cmp_lt_u32 s41, 2041
    s_cbranch_scc0 Lfl_9
    s_lshl_b32 s41, s41, 10
    s_add_u32 s41, s41, 13638656
    buffer_store_dwordx4 v[10:13], v9, s[20:23], s41 offen sc1
Lfl_9:
    s_add_u32 s41, s40, 1024
    s_cmp_lt_u32 s41, 2041
    s_cbranch_scc0 Lfl_10
    s_lshl_b32 s41, s41, 10
    s_add_u32 s41, s41, 13638656
    buffer_store_dwordx4 v[10:13], v9, s[20:23], s41 offen sc1
Lfl_10:
    s_add_u32 s41, s40, 1152
    s_cmp_lt_u32 s41, 2041
    s_cbranch_scc0 Lfl_11
    s_lshl_b32 s41, s41, 10
    s_add_u32 s41, s41, 13638656
    buffer_store_dwordx4 v[10:13], v9, s[20:23], s41 offen sc1
Lfl_11:
    s_add_u32 s41, s40, 1280
    s_cmp_lt_u32 s41, 2041
    s_cbranch_scc0 Lfl_12
    s_lshl_b32 s41, s41, 10
    s_add_u32 s41, s41, 13638656
    buffer_store_dwordx4 v[10:13], v9, s[20:23], s41 offen sc1
Lfl_12:
    s_add_u32 s41, s40, 1408
    s_cmp_lt_u32 s41, 2041
    s_cbranch_scc0 Lfl_13
    s_lshl_b32 s41, s41, 10
    s_add_u32 s41, s41, 13638656
    buffer_store_dwordx4 v[10:13], v9, s[20:23], s41 offen sc1
Lfl_13:
    s_add_u32 s41, s40, 1536
    s_cmp_lt_u32 s41, 2041
    s_cbranch_scc0 Lfl_14
    s_lshl_b32 s41, s41, 10
    s_add_u32 s41, s41, 13638656
    buffer_store_dwordx4 v[10:13], v9, s[20:23], s41 offen sc1
Lfl_14:
    s_add_u32 s41, s40, 1664
    s_cmp_lt_u32 s41, 2041
    s_cbranch_scc0 Lfl_15
    s_lshl_b32 s41, s41, 10
    s_add_u32 s41, s41, 13638656
    buffer_store_dwordx4 v[10:13], v9, s[20:23], s41 offen sc1
Lfl_15:
    s_add_u32 s41, s40, 1792
    s_cmp_lt_u32 s41, 2041
    s_cbranch_scc0 Lfl_16
    s_lshl_b32 s41, s41, 10
    s_add_u32 s41, s41, 13638656
    buffer_store_dwordx4 v[10:13], v9, s[20:23], s41 offen sc1
Lfl_16:
    s_add_u32 s41, s40, 1920
    s_cmp_lt_u32 s41, 2041
    s_cbranch_scc0 Lfl_17
    s_lshl_b32 s41, s41, 10
    s_add_u32 s41, s41, 13638656
    buffer_store_dwordx4 v[10:13], v9, s[20:23], s41 offen sc1
Lfl_17:
    s_waitcnt vmcnt(0)
    buffer_store_dwordx4 v[16:19], v9, s[20:23], s39 offen offset:0 sc1
    buffer_store_dwordx4 v[20:23], v9, s[20:23], s39 offen offset:1024 sc1
    buffer_store_dwordx4 v[24:27], v9, s[20:23], s39 offen offset:2048 sc1
    buffer_store_dwordx4 v[28:31], v9, s[20:23], s39 offen offset:3072 sc1
    s_add_u32 s39, s39, 4096
    buffer_store_dwordx4 v[32:35], v9, s[20:23], s39 offen offset:0 sc1
    buffer_store_dwordx4 v[36:39], v9, s[20:23], s39 offen offset:1024 sc1
    buffer_store_dwordx4 v[40:43], v9, s[20:23], s39 offen offset:2048 sc1
    buffer_store_dwordx4 v[44:47], v9, s[20:23], s39 offen offset:3072 sc1
    s_add_u32 s39, s39, 4096
    buffer_store_dwordx4 v[48:51], v9, s[20:23], s39 offen offset:0 sc1
    buffer_store_dwordx4 v[52:55], v9, s[20:23], s39 offen offset:1024 sc1
    buffer_store_dwordx4 v[56:59], v9, s[20:23], s39 offen offset:2048 sc1
    buffer_store_dwordx4 v[60:63], v9, s[20:23], s39 offen offset:3072 sc1
    s_add_u32 s39, s39, 4096
    buffer_store_dwordx4 v[64:67], v9, s[20:23], s39 offen offset:0 sc1
    buffer_store_dwordx4 v[68:71], v9, s[20:23], s39 offen offset:1024 sc1
    s_lshr_b32 s66, s2, 3
    s_add_u32 s66, s66, 224
    s_branch Lk1_fin
Lk1_fold:
    s_and_b32 s36, s2, 7
    s_sub_u32 s36, s36, 1
    s_lshl_b32 s36, s36, 5
    s_lshr_b32 s37, s2, 3
    s_add_u32 s36, s36, s37
    s_mul_i32 s37, s36, 9363
    s_lshr_b32 s37, s37, 16
    s_mul_i32 s38, s37, 7
    s_sub_u32 s35, s36, s38
    s_lshr_b32 s33, s37, 4
    s_and_b32 s34, s37, 15
    s_cmp_eq_u32 s33, 0
    s_cselect_b32 s12, s44, s48
    s_cselect_b32 s13, s45, s49
    s_cselect_b32 s16, s46, s50
    s_cselect_b32 s17, s47, s51
    s_mov_b32 s14, 3670016
    s_mov_b32 s15, 0x00020000
    s_mov_b32 s18, 3670016
    s_mov_b32 s19, 0x00020000
    v_lshrrev_b32 v5, 5, v1
    s_lshl_b32 s36, s32, 4
    v_add_u32 v5, s36, v5
    v_and_b32 v6, 31, v1
    v_mul_u32_u24 v11, 528, v5
    v_lshl_add_u32 v11, v6, 4, v11
    v_lshlrev_b32 v10, 13, v5
    v_lshl_add_u32 v10, v6, 4, v10
    s_lshl_b32 s42, s35, 19
    s_lshl_b32 s36, s34, 9
    s_add_u32 s42, s42, s36
    buffer_load_dwordx4 a[224:227], v10, s[12:15], s42 offen
    s_add_u32 s42, s42, 16384
    buffer_load_dwordx4 a[228:231], v10, s[12:15], s42 offen
    s_add_u32 s42, s42, 16384
    buffer_load_dwordx4 a[232:235], v10, s[12:15], s42 offen
    s_add_u32 s42, s42, 16384
    buffer_load_dwordx4 a[236:239], v10, s[12:15], s42 offen
    s_add_u32 s42, s42, 16384
    buffer_load_dwordx4 a[240:243], v10, s[12:15], s42 offen
    s_add_u32 s42, s42, 16384
    buffer_load_dwordx4 a[244:247], v10, s[12:15], s42 offen
    s_add_u32 s42, s42, 16384
    buffer_load_dwordx4 a[248:251], v10, s[12:15], s42 offen
    s_add_u32 s42, s42, 16384
    buffer_load_dwordx4 a[252:255], v10, s[12:15], s42 offen
    s_add_u32 s42, s42, 16384
    s_mul_i32 s36, s32, 16128
    s_add_u32 s36, s36, 33792
    s_cmp_eq_u32 s33, 0
    s_cbranch_scc0 Lk1_B
    v_bfe_u32 v5, v1, 2, 2
    v_lshlrev_b32 v5, 3, v5
    v_and_b32 v6, 3, v1
    v_add_u32 v5, v5, v6
    v_mul_u32_u24 v12, 528, v5
    v_lshl_add_u32 v12, v2, 4, v12
    v_lshrrev_b32 v5, 3, v1
    v_and_b32 v6, 7, v1
    v_mul_u32_u24 v14, 144, v5
    v_lshl_add_u32 v14, v6, 4, v14
    v_add_u32 v14, s36, v14
    s_mul_i32 s37, s32, 112
    v_add_u32 v5, s37, v5
    v_lshlrev_b32 v13, 13, v5
    v_lshl_add_u32 v13, v6, 4, v13
    v_and_b32 v5, 15, v1
    v_mul_u32_u24 v15, 144, v5
    v_lshl_add_u32 v15, v2, 4, v15
    v_add_u32 v15, s36, v15
    s_mov_b32 s54, 0x3db8aa3b
    s_mov_b32 s55, 0x3db8aa3b
    s_lshl_b32 s43, s34, 9
    s_add_u32 s43, s43, 0
    buffer_load_dwordx4 a[0:3], v13, s[16:19], s43 offen
    s_add_u32 s43, s43, 65536
    buffer_load_dwordx4 a[4:7], v13, s[16:19], s43 offen
    s_add_u32 s43, s43, 65536
    buffer_load_dwordx4 a[8:11], v13, s[16:19], s43 offen
    s_add_u32 s43, s43, 65536
    buffer_load_dwordx4 a[12:15], v13, s[16:19], s43 offen
    s_add_u32 s43, s43, 65536
    buffer_load_dwordx4 a[16:19], v13, s[16:19], s43 offen
    s_add_u32 s43, s43, 65536
    buffer_load_dwordx4 a[20:23], v13, s[16:19], s43 offen
    s_add_u32 s43, s43, 65536
    buffer_load_dwordx4 a[24:27], v13, s[16:19], s43 offen
    s_add_u32 s43, s43, 65536
    buffer_load_dwordx4 a[28:31], v13, s[16:19], s43 offen
    s_add_u32 s43, s43, 65536
    buffer_load_dwordx4 a[32:35], v13, s[16:19], s43 offen
    s_add_u32 s43, s43, 65536
    buffer_load_dwordx4 a[36:39], v13, s[16:19], s43 offen
    s_add_u32 s43, s43, 65536
    buffer_load_dwordx4 a[40:43], v13, s[16:19], s43 offen
    s_add_u32 s43, s43, 65536
    buffer_load_dwordx4 a[44:47], v13, s[16:19], s43 offen
    s_add_u32 s43, s43, 65536
    buffer_load_dwordx4 a[48:51], v13, s[16:19], s43 offen
    s_add_u32 s43, s43, 65536
    buffer_load_dwordx4 a[52:55], v13, s[16:19], s43 offen
    s_lshl_b32 s43, s34, 9
    s_add_u32 s43, s43, 128
    buffer_load_dwordx4 a[56:59], v13, s[16:19], s43 offen
    s_add_u32 s43, s43, 65536
    buffer_load_dwordx4 a[60:63], v13, s[16:19], s43 offen
    s_add_u32 s43, s43, 65536
    buffer_load_dwordx4 a[64:67], v13, s[16:19], s43 offen
    s_add_u32 s43, s43, 65536
    buffer_load_dwordx4 a[68:71], v13, s[16:19], s43 offen
    s_add_u32 s43, s43, 65536
    buffer_load_dwordx4 a[72:75], v13, s[16:19], s43 offen
    s_add_u32 s43, s43, 65536
    buffer_load_dwordx4 a[76:79], v13, s[16:19], s43 offen
    s_add_u32 s43, s43, 65536
    buffer_load_dwordx4 a[80:83], v13, s[16:19], s43 offen
    s_add_u32 s43, s43, 65536
    buffer_load_dwordx4 a[84:87], v13, s[16:19], s43 offen
    s_add_u32 s43, s43, 65536
    buffer_load_dwordx4 a[88:91], v13, s[16:19], s43 offen
    s_add_u32 s43, s43, 65536
    buffer_load_dwordx4 a[92:95], v13, s[16:19], s43 offen
    s_add_u32 s43, s43, 65536
    buffer_load_dwordx4 a[96:99], v13, s[16:19], s43 offen
    s_add_u32 s43, s43, 65536
    buffer_load_dwordx4 a[100:103], v13, s[16:19], s43 offen
    s_add_u32 s43, s43, 65536
    buffer_load_dwordx4 a[104:107], v13, s[16:19], s43 offen
    s_add_u32 s43, s43, 65536
    buffer_load_dwordx4 a[108:111], v13, s[16:19], s43 offen
    s_waitcnt vmcnt(35)
    ds_write_b128 v11, a[224:227] offset:0
    s_waitcnt vmcnt(34)
    ds_write_b128 v11, a[228:231] offset:1056
    s_waitcnt vmcnt(33)
    ds_write_b128 v11, a[232:235] offset:2112
    s_waitcnt vmcnt(32)
    ds_write_b128 v11, a[236:239] offset:3168
    s_waitcnt vmcnt(31)
    ds_write_b128 v11, a[240:243] offset:4224
    s_waitcnt vmcnt(30)
    ds_write_b128 v11, a[244:247] offset:5280
    s_waitcnt vmcnt(29)
    ds_write_b128 v11, a[248:251] offset:6336
    s_waitcnt vmcnt(28)
    ds_write_b128 v11, a[252:255] offset:7392
    s_waitcnt vmcnt(27)
    ds_write_b128 v14, a[0:3] offset:0
    s_waitcnt vmcnt(26)
    ds_write_b128 v14, a[4:7] offset:1152
    s_waitcnt vmcnt(25)
    ds_write_b128 v14, a[8:11] offset:2304
    s_waitcnt vmcnt(24)
    ds_write_b128 v14, a[12:15] offset:3456
    s_waitcnt vmcnt(23)
    ds_write_b128 v14, a[16:19] offset:4608
    s_waitcnt vmcnt(22)
    ds_write_b128 v14, a[20:23] offset:5760
    s_waitcnt vmcnt(21)
    ds_write_b128 v14, a[24:27] offset:6912
    s_waitcnt vmcnt(20)
    ds_write_b128 v14, a[28:31] offset:8064
    s_waitcnt vmcnt(19)
    ds_write_b128 v14, a[32:35] offset:9216
    s_waitcnt vmcnt(18)
    ds_write_b128 v14, a[36:39] offset:10368
    s_waitcnt vmcnt(17)
    ds_write_b128 v14, a[40:43] offset:11520
    s_waitcnt vmcnt(16)
    ds_write_b128 v14, a[44:47] offset:12672
    s_waitcnt vmcnt(15)
    ds_write_b128 v14, a[48:51] offset:13824
    s_waitcnt vmcnt(14)
    ds_write_b128 v14, a[52:55] offset:14976
    s_waitcnt lgkmcnt(0)
    s_barrier
    ds_read_b128 v[128:131], v12 offset:0
    ds_read_b128 v[132:135], v12 offset:2112
    ds_read_b128 v[136:139], v12 offset:16896
    ds_read_b128 v[140:143], v12 offset:19008
    ds_read_b128 v[160:163], v15 offset:0
    ds_read_b128 v[164:167], v15 offset:2304
    ds_read_b128 v[168:171], v15 offset:4608
    ds_read_b128 v[172:175], v15 offset:6912
    ds_read_b128 v[176:179], v15 offset:9216
    ds_read_b128 v[180:183], v15 offset:11520
    ds_read_b128 v[184:187], v15 offset:13824
    s_waitcnt lgkmcnt(6)
    v_mfma_f32_16x16x32_bf16 v[16:19], v[128:131], v[160:163], 0
    s_lshl_b32 s43, s34, 9
    v_mfma_f32_16x16x32_bf16 v[44:47], v[132:135], v[160:163], 0
    s_add_u32 s43, s43, 256
    v_mfma_f32_16x16x32_bf16 v[72:75], v[136:139], v[160:163], 0
    buffer_load_dwordx4 a[112:115], v13, s[16:19], s43 offen
    v_mfma_f32_16x16x32_bf16 v[100:103], v[140:143], v[160:163], 0
    s_add_u32 s43, s43, 65536
    s_waitcnt lgkmcnt(5)
    v_mfma_f32_16x16x32_bf16 v[20:23], v[128:131], v[164:167], 0
    buffer_load_dwordx4 a[116:119], v13, s[16:19], s43 offen
    v_mfma_f32_16x16x32_bf16 v[48:51], v[132:135], v[164:167], 0
    s_add_u32 s43, s43, 65536
    v_mfma_f32_16x16x32_bf16 v[76:79], v[136:139], v[164:167], 0
    buffer_load_dwordx4 a[120:123], v13, s[16:19], s43 offen
    v_mfma_f32_16x16x32_bf16 v[104:107], v[140:143], v[164:167], 0
    s_add_u32 s43, s43, 65536
    s_waitcnt lgkmcnt(4)
    v_mfma_f32_16x16x32_bf16 v[24:27], v[128:131], v[168:171], 0
    buffer_load_dwordx4 a[124:127], v13, s[16:19], s43 offen
    v_mfma_f32_16x16x32_bf16 v[52:55], v[132:135], v[168:171], 0
    s_add_u32 s43, s43, 65536
    v_mfma_f32_16x16x32_bf16 v[80:83], v[136:139], v[168:171], 0
    buffer_load_dwordx4 a[128:131], v13, s[16:19], s43 offen
    v_mfma_f32_16x16x32_bf16 v[108:111], v[140:143], v[168:171], 0
    s_add_u32 s43, s43, 65536
    s_waitcnt lgkmcnt(3)
    v_mfma_f32_16x16x32_bf16 v[28:31], v[128:131], v[172:175], 0
    buffer_load_dwordx4 a[132:135], v13, s[16:19], s43 offen
    v_mfma_f32_16x16x32_bf16 v[56:59], v[132:135], v[172:175], 0
    s_add_u32 s43, s43, 65536
    v_mfma_f32_16x16x32_bf16 v[84:87], v[136:139], v[172:175], 0
    buffer_load_dwordx4 a[136:139], v13, s[16:19], s43 offen
    v_mfma_f32_16x16x32_bf16 v[112:115], v[140:143], v[172:175], 0
    ds_read_b128 v[144:147], v12 offset:64
    s_waitcnt lgkmcnt(3)
    v_mfma_f32_16x16x32_bf16 v[32:35], v[128:131], v[176:179], 0
    ds_read_b128 v[148:151], v12 offset:2176
    v_mfma_f32_16x16x32_bf16 v[60:63], v[132:135], v[176:179], 0
    ds_read_b128 v[152:155], v12 offset:16960
    v_mfma_f32_16x16x32_bf16 v[88:91], v[136:139], v[176:179], 0
    ds_read_b128 v[156:159], v12 offset:19072
    v_mfma_f32_16x16x32_bf16 v[116:119], v[140:143], v[176:179], 0
    ds_read_b128 v[188:191], v15 offset:64
    s_waitcnt lgkmcnt(6)
    v_mfma_f32_16x16x32_bf16 v[36:39], v[128:131], v[180:183], 0
    ds_read_b128 v[192:195], v15 offset:2368
    v_mfma_f32_16x16x32_bf16 v[64:67], v[132:135], v[180:183], 0
    ds_read_b128 v[196:199], v15 offset:4672
    v_mfma_f32_16x16x32_bf16 v[92:95], v[136:139], v[180:183], 0
    ds_read_b128 v[200:203], v15 offset:6976
    v_mfma_f32_16x16x32_bf16 v[120:123], v[140:143], v[180:183], 0
    ds_read_b128 v[204:207], v15 offset:9280
    s_waitcnt lgkmcnt(9)
    v_mfma_f32_16x16x32_bf16 v[40:43], v[128:131], v[184:187], 0
    ds_read_b128 v[208:211], v15 offset:11584
    v_mfma_f32_16x16x32_bf16 v[68:71], v[132:135], v[184:187], 0
    ds_read_b128 v[212:215], v15 offset:13888
    v_mfma_f32_16x16x32_bf16 v[96:99], v[136:139], v[184:187], 0
    v_mfma_f32_16x16x32_bf16 v[124:127], v[140:143], v[184:187], 0
    s_waitcnt lgkmcnt(6)
    v_mfma_f32_16x16x32_bf16 v[16:19], v[144:147], v[188:191], v[16:19]
    s_add_u32 s43, s43, 65536
    buffer_load_dwordx4 a[140:143], v13, s[16:19], s43 offen
    v_mfma_f32_16x16x32_bf16 v[44:47], v[148:151], v[188:191], v[44:47]
    s_add_u32 s43, s43, 65536
    buffer_load_dwordx4 a[144:147], v13, s[16:19], s43 offen
    v_mfma_f32_16x16x32_bf16 v[72:75], v[152:155], v[188:191], v[72:75]
    s_add_u32 s43, s43, 65536
    buffer_load_dwordx4 a[148:151], v13, s[16:19], s43 offen
    v_mfma_f32_16x16x32_bf16 v[100:103], v[156:159], v[188:191], v[100:103]
    s_add_u32 s43, s43, 65536
    buffer_load_dwordx4 a[152:155], v13, s[16:19], s43 offen
    s_waitcnt lgkmcnt(5)
    v_mfma_f32_16x16x32_bf16 v[20:23], v[144:147], v[192:195], v[20:23]
    s_add_u32 s43, s43, 65536
    buffer_load_dwordx4 a[156:159], v13, s[16:19], s43 offen
    v_mfma_f32_16x16x32_bf16 v[48:51], v[148:151], v[192:195], v[48:51]
    s_add_u32 s43, s43, 65536
    buffer_load_dwordx4 a[160:163], v13, s[16:19], s43 offen
    v_mfma_f32_16x16x32_bf16 v[76:79], v[152:155], v[192:195], v[76:79]
    s_add_u32 s43, s43, 65536
    buffer_load_dwordx4 a[164:167], v13, s[16:19], s43 offen
    v_mfma_f32_16x16x32_bf16 v[104:107], v[156:159], v[192:195], v[104:107]
    s_waitcnt vmcnt(27)
    ds_write_b128 v14, a[56:59] offset:0
    s_waitcnt vmcnt(26)
    ds_write_b128 v14, a[60:63] offset:1152
    s_waitcnt lgkmcnt(6)
    v_mfma_f32_16x16x32_bf16 v[24:27], v[144:147], v[196:199], v[24:27]
    s_waitcnt vmcnt(25)
    ds_write_b128 v14, a[64:67] offset:2304
    s_waitcnt vmcnt(24)
    ds_write_b128 v14, a[68:71] offset:3456
    v_mfma_f32_16x16x32_bf16 v[52:55], v[148:151], v[196:199], v[52:55]
    s_waitcnt vmcnt(23)
    ds_write_b128 v14, a[72:75] offset:4608
    s_waitcnt vmcnt(22)
    ds_write_b128 v14, a[76:79] offset:5760
    v_mfma_f32_16x16x32_bf16 v[80:83], v[152:155], v[196:199], v[80:83]
    s_waitcnt vmcnt(21)
    ds_write_b128 v14, a[80:83] offset:6912
    s_waitcnt vmcnt(20)
    ds_write_b128 v14, a[84:87] offset:8064
    v_mfma_f32_16x16x32_bf16 v[108:111], v[156:159], v[196:199], v[108:111]
    s_waitcnt vmcnt(19)
    ds_write_b128 v14, a[88:91] offset:9216
    s_waitcnt lgkmcnt(12)
    v_mfma_f32_16x16x32_bf16 v[28:31], v[144:147], v[200:203], v[28:31]
    s_waitcnt vmcnt(18)
    ds_write_b128 v14, a[92:95] offset:10368
    v_mfma_f32_16x16x32_bf16 v[56:59], v[148:151], v[200:203], v[56:59]
    s_waitcnt vmcnt(17)
    ds_write_b128 v14, a[96:99] offset:11520
    v_mfma_f32_16x16x32_bf16 v[84:87], v[152:155], v[200:203], v[84:87]
    s_waitcnt vmcnt(16)
    ds_write_b128 v14, a[100:103] offset:12672
    v_mfma_f32_16x16x32_bf16 v[112:115], v[156:159], v[200:203], v[112:115]
    s_waitcnt vmcnt(15)
    ds_write_b128 v14, a[104:107] offset:13824
    s_waitcnt lgkmcnt(15)
    v_mfma_f32_16x16x32_bf16 v[32:35], v[144:147], v[204:207], v[32:35]
    s_waitcnt vmcnt(14)
    ds_write_b128 v14, a[108:111] offset:14976
    v_mfma_f32_16x16x32_bf16 v[60:63], v[148:151], v[204:207], v[60:63]
    ds_read_b128 v[128:131], v12 offset:128
    v_mfma_f32_16x16x32_bf16 v[88:91], v[152:155], v[204:207], v[88:91]
    ds_read_b128 v[132:135], v12 offset:2240
    v_mfma_f32_16x16x32_bf16 v[116:119], v[156:159], v[204:207], v[116:119]
    ds_read_b128 v[136:139], v12 offset:17024
    v_mfma_f32_16x16x32_bf16 v[36:39], v[144:147], v[208:211], v[36:39]
    ds_read_b128 v[140:143], v12 offset:19136
    v_mfma_f32_16x16x32_bf16 v[64:67], v[148:151], v[208:211], v[64:67]
    ds_read_b128 v[160:163], v15 offset:0
    v_mfma_f32_16x16x32_bf16 v[92:95], v[152:155], v[208:211], v[92:95]
    ds_read_b128 v[164:167], v15 offset:2304
    v_mfma_f32_16x16x32_bf16 v[120:123], v[156:159], v[208:211], v[120:123]
    ds_read_b128 v[168:171], v15 offset:4608
    v_mfma_f32_16x16x32_bf16 v[40:43], v[144:147], v[212:215], v[40:43]
    ds_read_b128 v[172:175], v15 offset:6912
    v_mfma_f32_16x16x32_bf16 v[68:71], v[148:151], v[212:215], v[68:71]
    ds_read_b128 v[176:179], v15 offset:9216
    v_mfma_f32_16x16x32_bf16 v[96:99], v[152:155], v[212:215], v[96:99]
    ds_read_b128 v[180:183], v15 offset:11520
    v_mfma_f32_16x16x32_bf16 v[124:127], v[156:159], v[212:215], v[124:127]
    ds_read_b128 v[184:187], v15 offset:13824
    s_waitcnt lgkmcnt(6)
    v_mfma_f32_16x16x32_bf16 v[16:19], v[128:131], v[160:163], v[16:19]
    s_lshl_b32 s43, s34, 9
    v_mfma_f32_16x16x32_bf16 v[44:47], v[132:135], v[160:163], v[44:47]
    s_add_u32 s43, s43, 384
    v_mfma_f32_16x16x32_bf16 v[72:75], v[136:139], v[160:163], v[72:75]
    buffer_load_dwordx4 a[168:171], v13, s[16:19], s43 offen
    v_mfma_f32_16x16x32_bf16 v[100:103], v[140:143], v[160:163], v[100:103]
    s_add_u32 s43, s43, 65536
    s_waitcnt lgkmcnt(5)
    v_mfma_f32_16x16x32_bf16 v[20:23], v[128:131], v[164:167], v[20:23]
    buffer_load_dwordx4 a[172:175], v13, s[16:19], s43 offen
    v_mfma_f32_16x16x32_bf16 v[48:51], v[132:135], v[164:167], v[48:51]
    s_add_u32 s43, s43, 65536
    v_mfma_f32_16x16x32_bf16 v[76:79], v[136:139], v[164:167], v[76:79]
    buffer_load_dwordx4 a[176:179], v13, s[16:19], s43 offen
    v_mfma_f32_16x16x32_bf16 v[104:107], v[140:143], v[164:167], v[104:107]
    s_add_u32 s43, s43, 65536
    s_waitcnt lgkmcnt(4)
    v_mfma_f32_16x16x32_bf16 v[24:27], v[128:131], v[168:171], v[24:27]
    buffer_load_dwordx4 a[180:183], v13, s[16:19], s43 offen
    v_mfma_f32_16x16x32_bf16 v[52:55], v[132:135], v[168:171], v[52:55]
    s_add_u32 s43, s43, 65536
    v_mfma_f32_16x16x32_bf16 v[80:83], v[136:139], v[168:171], v[80:83]
    buffer_load_dwordx4 a[184:187], v13, s[16:19], s43 offen
    v_mfma_f32_16x16x32_bf16 v[108:111], v[140:143], v[168:171], v[108:111]
    s_add_u32 s43, s43, 65536
    s_waitcnt lgkmcnt(3)
    v_mfma_f32_16x16x32_bf16 v[28:31], v[128:131], v[172:175], v[28:31]
    buffer_load_dwordx4 a[188:191], v13, s[16:19], s43 offen
    v_mfma_f32_16x16x32_bf16 v[56:59], v[132:135], v[172:175], v[56:59]
    s_add_u32 s43, s43, 65536
    v_mfma_f32_16x16x32_bf16 v[84:87], v[136:139], v[172:175], v[84:87]
    buffer_load_dwordx4 a[192:195], v13, s[16:19], s43 offen
    v_mfma_f32_16x16x32_bf16 v[112:115], v[140:143], v[172:175], v[112:115]
    ds_read_b128 v[144:147], v12 offset:192
    s_waitcnt lgkmcnt(3)
    v_mfma_f32_16x16x32_bf16 v[32:35], v[128:131], v[176:179], v[32:35]
    ds_read_b128 v[148:151], v12 offset:2304
    v_mfma_f32_16x16x32_bf16 v[60:63], v[132:135], v[176:179], v[60:63]
    ds_read_b128 v[152:155], v12 offset:17088
    v_mfma_f32_16x16x32_bf16 v[88:91], v[136:139], v[176:179], v[88:91]
    ds_read_b128 v[156:159], v12 offset:19200
    v_mfma_f32_16x16x32_bf16 v[116:119], v[140:143], v[176:179], v[116:119]
    ds_read_b128 v[188:191], v15 offset:64
    s_waitcnt lgkmcnt(6)
    v_mfma_f32_16x16x32_bf16 v[36:39], v[128:131], v[180:183], v[36:39]
    ds_read_b128 v[192:195], v15 offset:2368
    v_mfma_f32_16x16x32_bf16 v[64:67], v[132:135], v[180:183], v[64:67]
    ds_read_b128 v[196:199], v15 offset:4672
    v_mfma_f32_16x16x32_bf16 v[92:95], v[136:139], v[180:183], v[92:95]
    ds_read_b128 v[200:203], v15 offset:6976
    v_mfma_f32_16x16x32_bf16 v[120:123], v[140:143], v[180:183], v[120:123]
    ds_read_b128 v[204:207], v15 offset:9280
    s_waitcnt lgkmcnt(9)
    v_mfma_f32_16x16x32_bf16 v[40:43], v[128:131], v[184:187], v[40:43]
    ds_read_b128 v[208:211], v15 offset:11584
    v_mfma_f32_16x16x32_bf16 v[68:71], v[132:135], v[184:187], v[68:71]
    ds_read_b128 v[212:215], v15 offset:13888
    v_mfma_f32_16x16x32_bf16 v[96:99], v[136:139], v[184:187], v[96:99]
    v_mfma_f32_16x16x32_bf16 v[124:127], v[140:143], v[184:187], v[124:127]
    s_waitcnt lgkmcnt(6)
    v_mfma_f32_16x16x32_bf16 v[16:19], v[144:147], v[188:191], v[16:19]
    s_add_u32 s43, s43, 65536
    buffer_load_dwordx4 a[196:199], v13, s[16:19], s43 offen
    v_mfma_f32_16x16x32_bf16 v[44:47], v[148:151], v[188:191], v[44:47]
    s_add_u32 s43, s43, 65536
    buffer_load_dwordx4 a[200:203], v13, s[16:19], s43 offen
    v_mfma_f32_16x16x32_bf16 v[72:75], v[152:155], v[188:191], v[72:75]
    s_add_u32 s43, s43, 65536
    buffer_load_dwordx4 a[204:207], v13, s[16:19], s43 offen
    v_mfma_f32_16x16x32_bf16 v[100:103], v[156:159], v[188:191], v[100:103]
    s_add_u32 s43, s43, 65536
    buffer_load_dwordx4 a[208:211], v13, s[16:19], s43 offen
    s_waitcnt lgkmcnt(5)
    v_mfma_f32_16x16x32_bf16 v[20:23], v[144:147], v[192:195], v[20:23]
    s_add_u32 s43, s43, 65536
    buffer_load_dwordx4 a[212:215], v13, s[16:19], s43 offen
    v_mfma_f32_16x16x32_bf16 v[48:51], v[148:151], v[192:195], v[48:51]
    s_add_u32 s43, s43, 65536
    buffer_load_dwordx4 a[216:219], v13, s[16:19], s43 offen
    v_mfma_f32_16x16x32_bf16 v[76:79], v[152:155], v[192:195], v[76:79]
    s_add_u32 s43, s43, 65536
    buffer_load_dwordx4 a[220:223], v13, s[16:19], s43 offen
    v_mfma_f32_16x16x32_bf16 v[104:107], v[156:159], v[192:195], v[104:107]
    s_waitcnt vmcnt(27)
    ds_write_b128 v14, a[112:115] offset:0
    s_waitcnt vmcnt(26)
    ds_write_b128 v14, a[116:119] offset:1152
    s_waitcnt lgkmcnt(6)
    v_mfma_f32_16x16x32_bf16 v[24:27], v[144:147], v[196:199], v[24:27]
    s_waitcnt vmcnt(25)
    ds_write_b128 v14, a[120:123] offset:2304
    s_waitcnt vmcnt(24)
    ds_write_b128 v14, a[124:127] offset:3456
    v_mfma_f32_16x16x32_bf16 v[52:55], v[148:151], v[196:199], v[52:55]
    s_waitcnt vmcnt(23)
    ds_write_b128 v14, a[128:131] offset:4608
    s_waitcnt vmcnt(22)
    ds_write_b128 v14, a[132:135] offset:5760
    v_mfma_f32_16x16x32_bf16 v[80:83], v[152:155], v[196:199], v[80:83]
    s_waitcnt vmcnt(21)
    ds_write_b128 v14, a[136:139] offset:6912
    s_waitcnt vmcnt(20)
    ds_write_b128 v14, a[140:143] offset:8064
    v_mfma_f32_16x16x32_bf16 v[108:111], v[156:159], v[196:199], v[108:111]
    s_waitcnt vmcnt(19)
    ds_write_b128 v14, a[144:147] offset:9216
    s_waitcnt lgkmcnt(12)
    v_mfma_f32_16x16x32_bf16 v[28:31], v[144:147], v[200:203], v[28:31]
    s_waitcnt vmcnt(18)
    ds_write_b128 v14, a[148:151] offset:10368
    v_mfma_f32_16x16x32_bf16 v[56:59], v[148:151], v[200:203], v[56:59]
    s_waitcnt vmcnt(17)
    ds_write_b128 v14, a[152:155] offset:11520
    v_mfma_f32_16x16x32_bf16 v[84:87], v[152:155], v[200:203], v[84:87]
    s_waitcnt vmcnt(16)
    ds_write_b128 v14, a[156:159] offset:12672
    v_mfma_f32_16x16x32_bf16 v[112:115], v[156:159], v[200:203], v[112:115]
    s_waitcnt vmcnt(15)
    ds_write_b128 v14, a[160:163] offset:13824
    s_waitcnt lgkmcnt(15)
    v_mfma_f32_16x16x32_bf16 v[32:35], v[144:147], v[204:207], v[32:35]
    s_waitcnt vmcnt(14)
    ds_write_b128 v14, a[164:167] offset:14976
    v_mfma_f32_16x16x32_bf16 v[60:63], v[148:151], v[204:207], v[60:63]
    ds_read_b128 v[128:131], v12 offset:256
    v_mfma_f32_16x16x32_bf16 v[88:91], v[152:155], v[204:207], v[88:91]
    ds_read_b128 v[132:135], v12 offset:2368
    v_mfma_f32_16x16x32_bf16 v[116:119], v[156:159], v[204:207], v[116:119]
    ds_read_b128 v[136:139], v12 offset:17152
    v_mfma_f32_16x16x32_bf16 v[36:39], v[144:147], v[208:211], v[36:39]
    ds_read_b128 v[140:143], v12 offset:19264
    v_mfma_f32_16x16x32_bf16 v[64:67], v[148:151], v[208:211], v[64:67]
    ds_read_b128 v[160:163], v15 offset:0
    v_mfma_f32_16x16x32_bf16 v[92:95], v[152:155], v[208:211], v[92:95]
    ds_read_b128 v[164:167], v15 offset:2304
    v_mfma_f32_16x16x32_bf16 v[120:123], v[156:159], v[208:211], v[120:123]
    ds_read_b128 v[168:171], v15 offset:4608
    v_mfma_f32_16x16x32_bf16 v[40:43], v[144:147], v[212:215], v[40:43]
    ds_read_b128 v[172:175], v15 offset:6912
    v_mfma_f32_16x16x32_bf16 v[68:71], v[148:151], v[212:215], v[68:71]
    ds_read_b128 v[176:179], v15 offset:9216
    v_mfma_f32_16x16x32_bf16 v[96:99], v[152:155], v[212:215], v[96:99]
    ds_read_b128 v[180:183], v15 offset:11520
    v_mfma_f32_16x16x32_bf16 v[124:127], v[156:159], v[212:215], v[124:127]
    ds_read_b128 v[184:187], v15 offset:13824
    s_waitcnt lgkmcnt(6)
    v_mfma_f32_16x16x32_bf16 v[16:19], v[128:131], v[160:163], v[16:19]
    ds_read_b128 v[144:147], v12 offset:320
    v_mfma_f32_16x16x32_bf16 v[44:47], v[132:135], v[160:163], v[44:47]
    ds_read_b128 v[148:151], v12 offset:2432
    v_mfma_f32_16x16x32_bf16 v[72:75], v[136:139], v[160:163], v[72:75]
    ds_read_b128 v[152:155], v12 offset:17216
    v_mfma_f32_16x16x32_bf16 v[100:103], v[140:143], v[160:163], v[100:103]
    ds_read_b128 v[156:159], v12 offset:19328
    s_waitcnt lgkmcnt(9)
    v_mfma_f32_16x16x32_bf16 v[20:23], v[128:131], v[164:167], v[20:23]
    ds_read_b128 v[188:191], v15 offset:64
    v_mfma_f32_16x16x32_bf16 v[48:51], v[132:135], v[164:167], v[48:51]
    ds_read_b128 v[192:195], v15 offset:2368
    v_mfma_f32_16x16x32_bf16 v[76:79], v[136:139], v[164:167], v[76:79]
    ds_read_b128 v[196:199], v15 offset:4672
    v_mfma_f32_16x16x32_bf16 v[104:107], v[140:143], v[164:167], v[104:107]
    ds_read_b128 v[200:203], v15 offset:6976
    s_waitcnt lgkmcnt(12)
    v_mfma_f32_16x16x32_bf16 v[24:27], v[128:131], v[168:171], v[24:27]
    ds_read_b128 v[204:207], v15 offset:9280
    v_mfma_f32_16x16x32_bf16 v[52:55], v[132:135], v[168:171], v[52:55]
    ds_read_b128 v[208:211], v15 offset:11584
    v_mfma_f32_16x16x32_bf16 v[80:83], v[136:139], v[168:171], v[80:83]
    ds_read_b128 v[212:215], v15 offset:13888
    v_mfma_f32_16x16x32_bf16 v[108:111], v[140:143], v[168:171], v[108:111]
    s_waitcnt lgkmcnt(14)
    v_mfma_f32_16x16x32_bf16 v[28:31], v[128:131], v[172:175], v[28:31]
    v_mfma_f32_16x16x32_bf16 v[56:59], v[132:135], v[172:175], v[56:59]
    v_mfma_f32_16x16x32_bf16 v[84:87], v[136:139], v[172:175], v[84:87]
    v_mfma_f32_16x16x32_bf16 v[112:115], v[140:143], v[172:175], v[112:115]
    s_waitcnt lgkmcnt(13)
    v_mfma_f32_16x16x32_bf16 v[32:35], v[128:131], v[176:179], v[32:35]
    v_mfma_f32_16x16x32_bf16 v[60:63], v[132:135], v[176:179], v[60:63]
    v_mfma_f32_16x16x32_bf16 v[88:91], v[136:139], v[176:179], v[88:91]
    v_mfma_f32_16x16x32_bf16 v[116:119], v[140:143], v[176:179], v[116:119]
    s_waitcnt lgkmcnt(12)
    v_mfma_f32_16x16x32_bf16 v[36:39], v[128:131], v[180:183], v[36:39]
    v_mfma_f32_16x16x32_bf16 v[64:67], v[132:135], v[180:183], v[64:67]
    v_mfma_f32_16x16x32_bf16 v[92:95], v[136:139], v[180:183], v[92:95]
    v_mfma_f32_16x16x32_bf16 v[120:123], v[140:143], v[180:183], v[120:123]
    s_waitcnt lgkmcnt(11)
    v_mfma_f32_16x16x32_bf16 v[40:43], v[128:131], v[184:187], v[40:43]
    v_mfma_f32_16x16x32_bf16 v[68:71], v[132:135], v[184:187], v[68:71]
    v_mfma_f32_16x16x32_bf16 v[96:99], v[136:139], v[184:187], v[96:99]
    v_mfma_f32_16x16x32_bf16 v[124:127], v[140:143], v[184:187], v[124:127]
    s_waitcnt lgkmcnt(6)
    v_mfma_f32_16x16x32_bf16 v[16:19], v[144:147], v[188:191], v[16:19]
    s_waitcnt vmcnt(13)
    ds_write_b128 v14, a[168:171] offset:0
    v_mfma_f32_16x16x32_bf16 v[44:47], v[148:151], v[188:191], v[44:47]
    s_waitcnt vmcnt(12)
    ds_write_b128 v14, a[172:175] offset:1152
    v_mfma_f32_16x16x32_bf16 v[72:75], v[152:155], v[188:191], v[72:75]
    s_waitcnt vmcnt(11)
    ds_write_b128 v14, a[176:179] offset:2304
    v_mfma_f32_16x16x32_bf16 v[100:103], v[156:159], v[188:191], v[100:103]
    s_waitcnt vmcnt(10)
    ds_write_b128 v14, a[180:183] offset:3456
    s_waitcnt lgkmcnt(9)
    v_mfma_f32_16x16x32_bf16 v[20:23], v[144:147], v[192:195], v[20:23]
    s_waitcnt vmcnt(9)
    ds_write_b128 v14, a[184:187] offset:4608
    v_mfma_f32_16x16x32_bf16 v[48:51], v[148:151], v[192:195], v[48:51]
    s_waitcnt vmcnt(8)
    ds_write_b128 v14, a[188:191] offset:5760
    v_mfma_f32_16x16x32_bf16 v[76:79], v[152:155], v[192:195], v[76:79]
    s_waitcnt vmcnt(7)
    ds_write_b128 v14, a[192:195] offset:6912
    v_mfma_f32_16x16x32_bf16 v[104:107], v[156:159], v[192:195], v[104:107]
    s_waitcnt vmcnt(6)
    ds_write_b128 v14, a[196:199] offset:8064
    s_waitcnt lgkmcnt(12)
    v_mfma_f32_16x16x32_bf16 v[24:27], v[144:147], v[196:199], v[24:27]
    s_waitcnt vmcnt(5)
    ds_write_b128 v14, a[200:203] offset:9216
    v_mfma_f32_16x16x32_bf16 v[52:55], v[148:151], v[196:199], v[52:55]
    s_waitcnt vmcnt(4)
    ds_write_b128 v14, a[204:207] offset:10368
    v_mfma_f32_16x16x32_bf16 v[80:83], v[152:155], v[196:199], v[80:83]
    s_waitcnt vmcnt(3)
    ds_write_b128 v14, a[208:211] offset:11520
    v_mfma_f32_16x16x32_bf16 v[108:111], v[156:159], v[196:199], v[108:111]
    s_waitcnt vmcnt(2)
    ds_write_b128 v14, a[212:215] offset:12672
    s_waitcnt lgkmcnt(15)
    v_mfma_f32_16x16x32_bf16 v[28:31], v[144:147], v[200:203], v[28:31]
    s_waitcnt vmcnt(1)
    ds_write_b128 v14, a[216:219] offset:13824
    v_mfma_f32_16x16x32_bf16 v[56:59], v[148:151], v[200:203], v[56:59]
    s_waitcnt vmcnt(0)
    ds_write_b128 v14, a[220:223] offset:14976
    v_mfma_f32_16x16x32_bf16 v[84:87], v[152:155], v[200:203], v[84:87]
    ds_read_b128 v[128:131], v12 offset:384
    v_mfma_f32_16x16x32_bf16 v[112:115], v[156:159], v[200:203], v[112:115]
    ds_read_b128 v[132:135], v12 offset:2496
    v_mfma_f32_16x16x32_bf16 v[32:35], v[144:147], v[204:207], v[32:35]
    ds_read_b128 v[136:139], v12 offset:17280
    v_mfma_f32_16x16x32_bf16 v[60:63], v[148:151], v[204:207], v[60:63]
    ds_read_b128 v[140:143], v12 offset:19392
    v_mfma_f32_16x16x32_bf16 v[88:91], v[152:155], v[204:207], v[88:91]
    ds_read_b128 v[160:163], v15 offset:0
    v_mfma_f32_16x16x32_bf16 v[116:119], v[156:159], v[204:207], v[116:119]
    ds_read_b128 v[164:167], v15 offset:2304
    v_mfma_f32_16x16x32_bf16 v[36:39], v[144:147], v[208:211], v[36:39]
    ds_read_b128 v[168:171], v15 offset:4608
    v_mfma_f32_16x16x32_bf16 v[64:67], v[148:151], v[208:211], v[64:67]
    ds_read_b128 v[172:175], v15 offset:6912
    v_mfma_f32_16x16x32_bf16 v[92:95], v[152:155], v[208:211], v[92:95]
    ds_read_b128 v[176:179], v15 offset:9216
    v_mfma_f32_16x16x32_bf16 v[120:123], v[156:159], v[208:211], v[120:123]
    ds_read_b128 v[180:183], v15 offset:11520
    v_mfma_f32_16x16x32_bf16 v[40:43], v[144:147], v[212:215], v[40:43]
    ds_read_b128 v[184:187], v15 offset:13824
    v_mfma_f32_16x16x32_bf16 v[68:71], v[148:151], v[212:215], v[68:71]
    v_mfma_f32_16x16x32_bf16 v[96:99], v[152:155], v[212:215], v[96:99]
    v_mfma_f32_16x16x32_bf16 v[124:127], v[156:159], v[212:215], v[124:127]
    s_waitcnt lgkmcnt(6)
    v_mfma_f32_16x16x32_bf16 v[16:19], v[128:131], v[160:163], v[16:19]
    ds_read_b128 v[144:147], v12 offset:448
    v_mfma_f32_16x16x32_bf16 v[44:47], v[132:135], v[160:163], v[44:47]
    ds_read_b128 v[148:151], v12 offset:2560
    v_mfma_f32_16x16x32_bf16 v[72:75], v[136:139], v[160:163], v[72:75]
    ds_read_b128 v[152:155], v12 offset:17344
    v_mfma_f32_16x16x32_bf16 v[100:103], v[140:143], v[160:163], v[100:103]
    ds_read_b128 v[156:159], v12 offset:19456
    s_waitcnt lgkmcnt(9)
    v_mfma_f32_16x16x32_bf16 v[20:23], v[128:131], v[164:167], v[20:23]
    ds_read_b128 v[188:191], v15 offset:64
    v_mfma_f32_16x16x32_bf16 v[48:51], v[132:135], v[164:167], v[48:51]
    ds_read_b128 v[192:195], v15 offset:2368
    v_mfma_f32_16x16x32_bf16 v[76:79], v[136:139], v[164:167], v[76:79]
    ds_read_b128 v[196:199], v15 offset:4672
    v_mfma_f32_16x16x32_bf16 v[104:107], v[140:143], v[164:167], v[104:107]
    ds_read_b128 v[200:203], v15 offset:6976
    s_waitcnt lgkmcnt(12)
    v_mfma_f32_16x16x32_bf16 v[24:27], v[128:131], v[168:171], v[24:27]
    ds_read_b128 v[204:207], v15 offset:9280
    v_mfma_f32_16x16x32_bf16 v[52:55], v[132:135], v[168:171], v[52:55]
    ds_read_b128 v[208:211], v15 offset:11584
    v_mfma_f32_16x16x32_bf16 v[80:83], v[136:139], v[168:171], v[80:83]
    ds_read_b128 v[212:215], v15 offset:13888
    v_mfma_f32_16x16x32_bf16 v[108:111], v[140:143], v[168:171], v[108:111]
    s_waitcnt lgkmcnt(14)
    v_mfma_f32_16x16x32_bf16 v[28:31], v[128:131], v[172:175], v[28:31]
    v_mfma_f32_16x16x32_bf16 v[56:59], v[132:135], v[172:175], v[56:59]
    v_mfma_f32_16x16x32_bf16 v[84:87], v[136:139], v[172:175], v[84:87]
    v_mfma_f32_16x16x32_bf16 v[112:115], v[140:143], v[172:175], v[112:115]
    s_waitcnt lgkmcnt(13)
    v_mfma_f32_16x16x32_bf16 v[32:35], v[128:131], v[176:179], v[32:35]
    v_mfma_f32_16x16x32_bf16 v[60:63], v[132:135], v[176:179], v[60:63]
    v_mfma_f32_16x16x32_bf16 v[88:91], v[136:139], v[176:179], v[88:91]
    v_mfma_f32_16x16x32_bf16 v[116:119], v[140:143], v[176:179], v[116:119]
    s_waitcnt lgkmcnt(12)
    v_mfma_f32_16x16x32_bf16 v[36:39], v[128:131], v[180:183], v[36:39]
    v_mfma_f32_16x16x32_bf16 v[64:67], v[132:135], v[180:183], v[64:67]
    v_mfma_f32_16x16x32_bf16 v[92:95], v[136:139], v[180:183], v[92:95]
    v_mfma_f32_16x16x32_bf16 v[120:123], v[140:143], v[180:183], v[120:123]
    s_waitcnt lgkmcnt(11)
    v_mfma_f32_16x16x32_bf16 v[40:43], v[128:131], v[184:187], v[40:43]
    v_mfma_f32_16x16x32_bf16 v[68:71], v[132:135], v[184:187], v[68:71]
    v_mfma_f32_16x16x32_bf16 v[96:99], v[136:139], v[184:187], v[96:99]
    v_mfma_f32_16x16x32_bf16 v[124:127], v[140:143], v[184:187], v[124:127]
    s_waitcnt lgkmcnt(6)
    v_mfma_f32_16x16x32_bf16 v[16:19], v[144:147], v[188:191], v[16:19]
    v_mfma_f32_16x16x32_bf16 v[44:47], v[148:151], v[188:191], v[44:47]
    v_mfma_f32_16x16x32_bf16 v[72:75], v[152:155], v[188:191], v[72:75]
    v_mfma_f32_16x16x32_bf16 v[100:103], v[156:159], v[188:191], v[100:103]
    s_waitcnt lgkmcnt(5)
    v_mfma_f32_16x16x32_bf16 v[20:23], v[144:147], v[192:195], v[20:23]
    v_mfma_f32_16x16x32_bf16 v[48:51], v[148:151], v[192:195], v[48:51]
    v_mfma_f32_16x16x32_bf16 v[76:79], v[152:155], v[192:195], v[76:79]
    v_mfma_f32_16x16x32_bf16 v[104:107], v[156:159], v[192:195], v[104:107]
    s_waitcnt lgkmcnt(4)
    v_mfma_f32_16x16x32_bf16 v[24:27], v[144:147], v[196:199], v[24:27]
    v_mfma_f32_16x16x32_bf16 v[52:55], v[148:151], v[196:199], v[52:55]
    v_mfma_f32_16x16x32_bf16 v[80:83], v[152:155], v[196:199], v[80:83]
    v_mfma_f32_16x16x32_bf16 v[108:111], v[156:159], v[196:199], v[108:111]
    s_waitcnt lgkmcnt(3)
    v_mfma_f32_16x16x32_bf16 v[28:31], v[144:147], v[200:203], v[28:31]
    v_mfma_f32_16x16x32_bf16 v[56:59], v[148:151], v[200:203], v[56:59]
    v_mfma_f32_16x16x32_bf16 v[84:87], v[152:155], v[200:203], v[84:87]
    v_mfma_f32_16x16x32_bf16 v[112:115], v[156:159], v[200:203], v[112:115]
    s_waitcnt lgkmcnt(2)
    v_mfma_f32_16x16x32_bf16 v[32:35], v[144:147], v[204:207], v[32:35]
    v_mfma_f32_16x16x32_bf16 v[60:63], v[148:151], v[204:207], v[60:63]
    v_mfma_f32_16x16x32_bf16 v[88:91], v[152:155], v[204:207], v[88:91]
    v_mfma_f32_16x16x32_bf16 v[116:119], v[156:159], v[204:207], v[116:119]
    s_waitcnt lgkmcnt(1)
    v_mfma_f32_16x16x32_bf16 v[36:39], v[144:147], v[208:211], v[36:39]
    v_mfma_f32_16x16x32_bf16 v[64:67], v[148:151], v[208:211], v[64:67]
    v_mfma_f32_16x16x32_bf16 v[92:95], v[152:155], v[208:211], v[92:95]
    v_mfma_f32_16x16x32_bf16 v[120:123], v[156:159], v[208:211], v[120:123]
    s_waitcnt lgkmcnt(0)
    v_mfma_f32_16x16x32_bf16 v[40:43], v[144:147], v[212:215], v[40:43]
    v_mfma_f32_16x16x32_bf16 v[68:71], v[148:151], v[212:215], v[68:71]
    v_mfma_f32_16x16x32_bf16 v[96:99], v[152:155], v[212:215], v[96:99]
    v_mfma_f32_16x16x32_bf16 v[124:127], v[156:159], v[212:215], v[124:127]
    s_lshl_b32 s38, s34, 2
    s_add_u32 s38, s38, s32
    s_mul_i32 s38, s38, 7
    s_add_u32 s38, s38, 0
    s_mul_i32 s38, s38, 7
    s_add_u32 s38, s38, s35
    s_lshl_b32 s38, s38, 11
    s_add_u32 s38, s38, 0
    v_pk_mul_f32 v[16:17], v[16:17], s[54:55]
    v_pk_mul_f32 v[18:19], v[18:19], s[54:55]
    v_cvt_pk_bf16_f32 v232, v16, v17
    v_cvt_pk_bf16_f32 v233, v18, v19
    v_pk_mul_f32 v[44:45], v[44:45], s[54:55]
    v_pk_mul_f32 v[46:47], v[46:47], s[54:55]
    v_cvt_pk_bf16_f32 v234, v44, v45
    v_cvt_pk_bf16_f32 v235, v46, v47
    buffer_store_dwordx4 v[232:235], v9, s[20:23], s38 offen offset:0 sc1
    v_pk_mul_f32 v[72:73], v[72:73], s[54:55]
    v_pk_mul_f32 v[74:75], v[74:75], s[54:55]
    v_cvt_pk_bf16_f32 v236, v72, v73
    v_cvt_pk_bf16_f32 v237, v74, v75
    v_pk_mul_f32 v[100:101], v[100:101], s[54:55]
    v_pk_mul_f32 v[102:103], v[102:103], s[54:55]
    v_cvt_pk_bf16_f32 v238, v100, v101
    v_cvt_pk_bf16_f32 v239, v102, v103
    buffer_store_dwordx4 v[236:239], v9, s[20:23], s38 offen offset:1024 sc1
    s_lshl_b32 s38, s34, 2
    s_add_u32 s38, s38, s32
    s_mul_i32 s38, s38, 7
    s_add_u32 s38, s38, 1
    s_mul_i32 s38, s38, 7
    s_add_u32 s38, s38, s35
    s_lshl_b32 s38, s38, 11
    s_add_u32 s38, s38, 0
    v_pk_mul_f32 v[20:21], v[20:21], s[54:55]
    v_pk_mul_f32 v[22:23], v[22:23], s[54:55]
    v_cvt_pk_bf16_f32 v240, v20, v21
    v_cvt_pk_bf16_f32 v241, v22, v23
    v_pk_mul_f32 v[48:49], v[48:49], s[54:55]
    v_pk_mul_f32 v[50:51], v[50:51], s[54:55]
    v_cvt_pk_bf16_f32 v242, v48, v49
    v_cvt_pk_bf16_f32 v243, v50, v51
    buffer_store_dwordx4 v[240:243], v9, s[20:23], s38 offen offset:0 sc1
    v_pk_mul_f32 v[76:77], v[76:77], s[54:55]
    v_pk_mul_f32 v[78:79], v[78:79], s[54:55]
    v_cvt_pk_bf16_f32 v244, v76, v77
    v_cvt_pk_bf16_f32 v245, v78, v79
    v_pk_mul_f32 v[104:105], v[104:105], s[54:55]
    v_pk_mul_f32 v[106:107], v[106:107], s[54:55]
    v_cvt_pk_bf16_f32 v246, v104, v105
    v_cvt_pk_bf16_f32 v247, v106, v107
    buffer_store_dwordx4 v[244:247], v9, s[20:23], s38 offen offset:1024 sc1
    s_lshl_b32 s38, s34, 2
    s_add_u32 s38, s38, s32
    s_mul_i32 s38, s38, 7
    s_add_u32 s38, s38, 2
    s_mul_i32 s38, s38, 7
    s_add_u32 s38, s38, s35
    s_lshl_b32 s38, s38, 11
    s_add_u32 s38, s38, 0
    v_pk_mul_f32 v[24:25], v[24:25], s[54:55]
    v_pk_mul_f32 v[26:27], v[26:27], s[54:55]
    v_cvt_pk_bf16_f32 v232, v24, v25
    v_cvt_pk_bf16_f32 v233, v26, v27
    v_pk_mul_f32 v[52:53], v[52:53], s[54:55]
    v_pk_mul_f32 v[54:55], v[54:55], s[54:55]
    v_cvt_pk_bf16_f32 v234, v52, v53
    v_cvt_pk_bf16_f32 v235, v54, v55
    buffer_store_dwordx4 v[232:235], v9, s[20:23], s38 offen offset:0 sc1
    v_pk_mul_f32 v[80:81], v[80:81], s[54:55]
    v_pk_mul_f32 v[82:83], v[82:83], s[54:55]
    v_cvt_pk_bf16_f32 v236, v80, v81
    v_cvt_pk_bf16_f32 v237, v82, v83
    v_pk_mul_f32 v[108:109], v[108:109], s[54:55]
    v_pk_mul_f32 v[110:111], v[110:111], s[54:55]
    v_cvt_pk_bf16_f32 v238, v108, v109
    v_cvt_pk_bf16_f32 v239, v110, v111
    buffer_store_dwordx4 v[236:239], v9, s[20:23], s38 offen offset:1024 sc1
    s_lshl_b32 s38, s34, 2
    s_add_u32 s38, s38, s32
    s_mul_i32 s38, s38, 7
    s_add_u32 s38, s38, 3
    s_mul_i32 s38, s38, 7
    s_add_u32 s38, s38, s35
    s_lshl_b32 s38, s38, 11
    s_add_u32 s38, s38, 0
    v_pk_mul_f32 v[28:29], v[28:29], s[54:55]
    v_pk_mul_f32 v[30:31], v[30:31], s[54:55]
    v_cvt_pk_bf16_f32 v240, v28, v29
    v_cvt_pk_bf16_f32 v241, v30, v31
    v_pk_mul_f32 v[56:57], v[56:57], s[54:55]
    v_pk_mul_f32 v[58:59], v[58:59], s[54:55]
    v_cvt_pk_bf16_f32 v242, v56, v57
    v_cvt_pk_bf16_f32 v243, v58, v59
    buffer_store_dwordx4 v[240:243], v9, s[20:23], s38 offen offset:0 sc1
    v_pk_mul_f32 v[84:85], v[84:85], s[54:55]
    v_pk_mul_f32 v[86:87], v[86:87], s[54:55]
    v_cvt_pk_bf16_f32 v244, v84, v85
    v_cvt_pk_bf16_f32 v245, v86, v87
    v_pk_mul_f32 v[112:113], v[112:113], s[54:55]
    v_pk_mul_f32 v[114:115], v[114:115], s[54:55]
    v_cvt_pk_bf16_f32 v246, v112, v113
    v_cvt_pk_bf16_f32 v247, v114, v115
    buffer_store_dwordx4 v[244:247], v9, s[20:23], s38 offen offset:1024 sc1
    s_lshl_b32 s38, s34, 2
    s_add_u32 s38, s38, s32
    s_mul_i32 s38, s38, 7
    s_add_u32 s38, s38, 4
    s_mul_i32 s38, s38, 7
    s_add_u32 s38, s38, s35
    s_lshl_b32 s38, s38, 11
    s_add_u32 s38, s38, 0
    v_pk_mul_f32 v[32:33], v[32:33], s[54:55]
    v_pk_mul_f32 v[34:35], v[34:35], s[54:55]
    v_cvt_pk_bf16_f32 v232, v32, v33
    v_cvt_pk_bf16_f32 v233, v34, v35
    v_pk_mul_f32 v[60:61], v[60:61], s[54:55]
    v_pk_mul_f32 v[62:63], v[62:63], s[54:55]
    v_cvt_pk_bf16_f32 v234, v60, v61
    v_cvt_pk_bf16_f32 v235, v62, v63
    buffer_store_dwordx4 v[232:235], v9, s[20:23], s38 offen offset:0 sc1
    v_pk_mul_f32 v[88:89], v[88:89], s[54:55]
    v_pk_mul_f32 v[90:91], v[90:91], s[54:55]
    v_cvt_pk_bf16_f32 v236, v88, v89
    v_cvt_pk_bf16_f32 v237, v90, v91
    v_pk_mul_f32 v[116:117], v[116:117], s[54:55]
    v_pk_mul_f32 v[118:119], v[118:119], s[54:55]
    v_cvt_pk_bf16_f32 v238, v116, v117
    v_cvt_pk_bf16_f32 v239, v118, v119
    buffer_store_dwordx4 v[236:239], v9, s[20:23], s38 offen offset:1024 sc1
    s_lshl_b32 s38, s34, 2
    s_add_u32 s38, s38, s32
    s_mul_i32 s38, s38, 7
    s_add_u32 s38, s38, 5
    s_mul_i32 s38, s38, 7
    s_add_u32 s38, s38, s35
    s_lshl_b32 s38, s38, 11
    s_add_u32 s38, s38, 0
    v_pk_mul_f32 v[36:37], v[36:37], s[54:55]
    v_pk_mul_f32 v[38:39], v[38:39], s[54:55]
    v_cvt_pk_bf16_f32 v240, v36, v37
    v_cvt_pk_bf16_f32 v241, v38, v39
    v_pk_mul_f32 v[64:65], v[64:65], s[54:55]
    v_pk_mul_f32 v[66:67], v[66:67], s[54:55]
    v_cvt_pk_bf16_f32 v242, v64, v65
    v_cvt_pk_bf16_f32 v243, v66, v67
    buffer_store_dwordx4 v[240:243], v9, s[20:23], s38 offen offset:0 sc1
    v_pk_mul_f32 v[92:93], v[92:93], s[54:55]
    v_pk_mul_f32 v[94:95], v[94:95], s[54:55]
    v_cvt_pk_bf16_f32 v244, v92, v93
    v_cvt_pk_bf16_f32 v245, v94, v95
    v_pk_mul_f32 v[120:121], v[120:121], s[54:55]
    v_pk_mul_f32 v[122:123], v[122:123], s[54:55]
    v_cvt_pk_bf16_f32 v246, v120, v121
    v_cvt_pk_bf16_f32 v247, v122, v123
    buffer_store_dwordx4 v[244:247], v9, s[20:23], s38 offen offset:1024 sc1
    s_lshl_b32 s38, s34, 2
    s_add_u32 s38, s38, s32
    s_mul_i32 s38, s38, 7
    s_add_u32 s38, s38, 6
    s_mul_i32 s38, s38, 7
    s_add_u32 s38, s38, s35
    s_lshl_b32 s38, s38, 11
    s_add_u32 s38, s38, 0
    v_pk_mul_f32 v[40:41], v[40:41], s[54:55]
    v_pk_mul_f32 v[42:43], v[42:43], s[54:55]
    v_cvt_pk_bf16_f32 v232, v40, v41
    v_cvt_pk_bf16_f32 v233, v42, v43
    v_pk_mul_f32 v[68:69], v[68:69], s[54:55]
    v_pk_mul_f32 v[70:71], v[70:71], s[54:55]
    v_cvt_pk_bf16_f32 v234, v68, v69
    v_cvt_pk_bf16_f32 v235, v70, v71
    buffer_store_dwordx4 v[232:235], v9, s[20:23], s38 offen offset:0 sc1
    v_pk_mul_f32 v[96:97], v[96:97], s[54:55]
    v_pk_mul_f32 v[98:99], v[98:99], s[54:55]
    v_cvt_pk_bf16_f32 v236, v96, v97
    v_cvt_pk_bf16_f32 v237, v98, v99
    v_pk_mul_f32 v[124:125], v[124:125], s[54:55]
    v_pk_mul_f32 v[126:127], v[126:127], s[54:55]
    v_cvt_pk_bf16_f32 v238, v124, v125
    v_cvt_pk_bf16_f32 v239, v126, v127
    buffer_store_dwordx4 v[236:239], v9, s[20:23], s38 offen offset:1024 sc1
    s_branch Lk1_done
Lk1_B:
    v_bfe_u32 v5, v1, 2, 2
    v_lshlrev_b32 v5, 3, v5
    v_and_b32 v6, 3, v1
    v_add_u32 v5, v5, v6
    v_mul_u32_u24 v12, 528, v5
    v_lshl_add_u32 v12, v2, 4, v12
    s_mul_i32 s37, s32, 224
    v_add_u32 v5, 0, v1
    v_mul_u32_u24 v6, 4682, v5
    v_lshrrev_b32 v6, 16, v6
    v_mul_u32_u24 v3, 14, v6
    v_sub_u32 v3, v5, v3
    v_mul_u32_u24 v216, 896, v6
    v_lshl_add_u32 v216, v3, 4, v216
    v_add_u32 v216, s37, v216
    v_mul_u32_u24 v223, 224, v6
    v_lshrrev_b32 v5, 3, v6
    v_lshl_add_u32 v223, v5, 7, v223
    v_lshl_add_u32 v223, v3, 4, v223
    v_add_u32 v223, s36, v223
    v_add_u32 v5, 64, v1
    v_mul_u32_u24 v6, 4682, v5
    v_lshrrev_b32 v6, 16, v6
    v_mul_u32_u24 v3, 14, v6
    v_sub_u32 v3, v5, v3
    v_mul_u32_u24 v217, 896, v6
    v_lshl_add_u32 v217, v3, 4, v217
    v_add_u32 v217, s37, v217
    v_mul_u32_u24 v224, 224, v6
    v_lshrrev_b32 v5, 3, v6
    v_lshl_add_u32 v224, v5, 7, v224
    v_lshl_add_u32 v224, v3, 4, v224
    v_add_u32 v224, s36, v224
    v_add_u32 v5, 128, v1
    v_mul_u32_u24 v6, 4682, v5
    v_lshrrev_b32 v6, 16, v6
    v_mul_u32_u24 v3, 14, v6
    v_sub_u32 v3, v5, v3
    v_mul_u32_u24 v218, 896, v6
    v_lshl_add_u32 v218, v3, 4, v218
    v_add_u32 v218, s37, v218
    v_mul_u32_u24 v225, 224, v6
    v_lshrrev_b32 v5, 3, v6
    v_lshl_add_u32 v225, v5, 7, v225
    v_lshl_add_u32 v225, v3, 4, v225
    v_add_u32 v225, s36, v225
    v_add_u32 v5, 192, v1
    v_mul_u32_u24 v6, 4682, v5
    v_lshrrev_b32 v6, 16, v6
    v_mul_u32_u24 v3, 14, v6
    v_sub_u32 v3, v5, v3
    v_mul_u32_u24 v219, 896, v6
    v_lshl_add_u32 v219, v3, 4, v219
    v_add_u32 v219, s37, v219
    v_mul_u32_u24 v226, 224, v6
    v_lshrrev_b32 v5, 3, v6
    v_lshl_add_u32 v226, v5, 7, v226
    v_lshl_add_u32 v226, v3, 4, v226
    v_add_u32 v226, s36, v226
    v_add_u32 v5, 256, v1
    v_mul_u32_u24 v6, 4682, v5
    v_lshrrev_b32 v6, 16, v6
    v_mul_u32_u24 v3, 14, v6
    v_sub_u32 v3, v5, v3
    v_mul_u32_u24 v220, 896, v6
    v_lshl_add_u32 v220, v3, 4, v220
    v_add_u32 v220, s37, v220
    v_mul_u32_u24 v227, 224, v6
    v_lshrrev_b32 v5, 3, v6
    v_lshl_add_u32 v227, v5, 7, v227
    v_lshl_add_u32 v227, v3, 4, v227
    v_add_u32 v227, s36, v227
    v_add_u32 v5, 320, v1
    v_mul_u32_u24 v6, 4682, v5
    v_lshrrev_b32 v6, 16, v6
    v_mul_u32_u24 v3, 14, v6
    v_sub_u32 v3, v5, v3
    v_mul_u32_u24 v221, 896, v6
    v_lshl_add_u32 v221, v3, 4, v221
    v_add_u32 v221, s37, v221
    v_mul_u32_u24 v228, 224, v6
    v_lshrrev_b32 v5, 3, v6
    v_lshl_add_u32 v228, v5, 7, v228
    v_lshl_add_u32 v228, v3, 4, v228
    v_add_u32 v228, s36, v228
    v_add_u32 v5, 384, v1
    v_mul_u32_u24 v6, 4682, v5
    v_lshrrev_b32 v6, 16, v6
    v_mul_u32_u24 v3, 14, v6
    v_sub_u32 v3, v5, v3
    v_mul_u32_u24 v222, 896, v6
    v_lshl_add_u32 v222, v3, 4, v222
    v_add_u32 v222, s37, v222
    v_mul_u32_u24 v229, 224, v6
    v_lshrrev_b32 v5, 3, v6
    v_lshl_add_u32 v229, v5, 7, v229
    v_lshl_add_u32 v229, v3, 4, v229
    v_add_u32 v229, s36, v229
    v_bfe_u32 v5, v1, 2, 2
    v_lshl_add_u32 v5, v2, 3, v5
    v_mul_u32_u24 v15, 224, v5
    v_lshl_add_u32 v15, v2, 7, v15
    v_and_b32 v5, 3, v1
    v_lshl_add_u32 v15, v5, 3, v15
    v_add_u32 v15, s36, v15
    s_mul_i32 s43, s34, 229376
    s_add_u32 s43, s43, 0
    buffer_load_dwordx4 a[0:3], v216, s[16:19], s43 offen
    buffer_load_dwordx4 a[4:7], v217, s[16:19], s43 offen
    buffer_load_dwordx4 a[8:11], v218, s[16:19], s43 offen
    buffer_load_dwordx4 a[12:15], v219, s[16:19], s43 offen
    buffer_load_dwordx4 a[16:19], v220, s[16:19], s43 offen
    buffer_load_dwordx4 a[20:23], v221, s[16:19], s43 offen
    buffer_load_dwordx4 a[24:27], v222, s[16:19], s43 offen
    s_add_u32 s43, s43, 28672
    buffer_load_dwordx4 a[28:31], v216, s[16:19], s43 offen
    buffer_load_dwordx4 a[32:35], v217, s[16:19], s43 offen
    buffer_load_dwordx4 a[36:39], v218, s[16:19], s43 offen
    buffer_load_dwordx4 a[40:43], v219, s[16:19], s43 offen
    buffer_load_dwordx4 a[44:47], v220, s[16:19], s43 offen
    buffer_load_dwordx4 a[48:51], v221, s[16:19], s43 offen
    buffer_load_dwordx4 a[52:55], v222, s[16:19], s43 offen
    s_mul_i32 s43, s34, 229376
    s_add_u32 s43, s43, 57344
    buffer_load_dwordx4 a[56:59], v216, s[16:19], s43 offen
    buffer_load_dwordx4 a[60:63], v217, s[16:19], s43 offen
    buffer_load_dwordx4 a[64:67], v218, s[16:19], s43 offen
    buffer_load_dwordx4 a[68:71], v219, s[16:19], s43 offen
    buffer_load_dwordx4 a[72:75], v220, s[16:19], s43 offen
    buffer_load_dwordx4 a[76:79], v221, s[16:19], s43 offen
    buffer_load_dwordx4 a[80:83], v222, s[16:19], s43 offen
    s_add_u32 s43, s43, 28672
    buffer_load_dwordx4 a[84:87], v216, s[16:19], s43 offen
    buffer_load_dwordx4 a[88:91], v217, s[16:19], s43 offen
    buffer_load_dwordx4 a[92:95], v218, s[16:19], s43 offen
    buffer_load_dwordx4 a[96:99], v219, s[16:19], s43 offen
    buffer_load_dwordx4 a[100:103], v220, s[16:19], s43 offen
    buffer_load_dwordx4 a[104:107], v221, s[16:19], s43 offen
    buffer_load_dwordx4 a[108:111], v222, s[16:19], s43 offen
    s_waitcnt vmcnt(35)
    ds_write_b128 v11, a[224:227] offset:0
    s_waitcnt vmcnt(34)
    ds_write_b128 v11, a[228:231] offset:1056
    s_waitcnt vmcnt(33)
    ds_write_b128 v11, a[232:235] offset:2112
    s_waitcnt vmcnt(32)
    ds_write_b128 v11, a[236:239] offset:3168
    s_waitcnt vmcnt(31)
    ds_write_b128 v11, a[240:243] offset:4224
    s_waitcnt vmcnt(30)
    ds_write_b128 v11, a[244:247] offset:5280
    s_waitcnt vmcnt(29)
    ds_write_b128 v11, a[248:251] offset:6336
    s_waitcnt vmcnt(28)
    ds_write_b128 v11, a[252:255] offset:7392
    s_waitcnt vmcnt(27)
    ds_write_b128 v223, a[0:3] offset:0
    s_waitcnt vmcnt(26)
    ds_write_b128 v224, a[4:7] offset:0
    s_waitcnt vmcnt(25)
    ds_write_b128 v225, a[8:11] offset:0
    s_waitcnt vmcnt(24)
    ds_write_b128 v226, a[12:15] offset:0
    s_waitcnt vmcnt(23)
    ds_write_b128 v227, a[16:19] offset:0
    s_waitcnt vmcnt(22)
    ds_write_b128 v228, a[20:23] offset:0
    s_waitcnt vmcnt(21)
    ds_write_b128 v229, a[24:27] offset:0
    s_waitcnt vmcnt(20)
    ds_write_b128 v223, a[28:31] offset:7680
    s_waitcnt vmcnt(19)
    ds_write_b128 v224, a[32:35] offset:7680
    s_waitcnt vmcnt(18)
    ds_write_b128 v225, a[36:39] offset:7680
    s_waitcnt vmcnt(17)
    ds_write_b128 v226, a[40:43] offset:7680
    s_waitcnt vmcnt(16)
    ds_write_b128 v227, a[44:47] offset:7680
    s_waitcnt vmcnt(15)
    ds_write_b128 v228, a[48:51] offset:7680
    s_waitcnt vmcnt(14)
    ds_write_b128 v229, a[52:55] offset:7680
    s_waitcnt lgkmcnt(0)
    s_barrier
    ds_read_b128 v[128:131], v12 offset:0
    ds_read_b128 v[132:135], v12 offset:2112
    ds_read_b128 v[136:139], v12 offset:16896
    ds_read_b128 v[140:143], v12 offset:19008
    ds_read_b64_tr_b16 v[160:161], v15 offset:0
    ds_read_b64_tr_b16 v[162:163], v15 offset:896
    ds_read_b64_tr_b16 v[164:165], v15 offset:32
    ds_read_b64_tr_b16 v[166:167], v15 offset:928
    ds_read_b64_tr_b16 v[168:169], v15 offset:64
    ds_read_b64_tr_b16 v[170:171], v15 offset:960
    ds_read_b64_tr_b16 v[172:173], v15 offset:96
    ds_read_b64_tr_b16 v[174:175], v15 offset:992
    ds_read_b64_tr_b16 v[176:177], v15 offset:128
    ds_read_b64_tr_b16 v[178:179], v15 offset:1024
    ds_read_b64_tr_b16 v[180:181], v15 offset:160
    ds_read_b64_tr_b16 v[182:183], v15 offset:1056
    ds_read_b64_tr_b16 v[184:185], v15 offset:192
    ds_read_b64_tr_b16 v[186:187], v15 offset:1088
    s_waitcnt lgkmcnt(12)
    v_mfma_f32_16x16x32_bf16 v[16:19], v[128:131], v[160:163], 0
    s_mul_i32 s43, s34, 229376
    v_mfma_f32_16x16x32_bf16 v[44:47], v[132:135], v[160:163], 0
    s_add_u32 s43, s43, 114688
    v_mfma_f32_16x16x32_bf16 v[72:75], v[136:139], v[160:163], 0
    buffer_load_dwordx4 a[112:115], v216, s[16:19], s43 offen
    v_mfma_f32_16x16x32_bf16 v[100:103], v[140:143], v[160:163], 0
    buffer_load_dwordx4 a[116:119], v217, s[16:19], s43 offen
    s_waitcnt lgkmcnt(10)
    v_mfma_f32_16x16x32_bf16 v[20:23], v[128:131], v[164:167], 0
    buffer_load_dwordx4 a[120:123], v218, s[16:19], s43 offen
    v_mfma_f32_16x16x32_bf16 v[48:51], v[132:135], v[164:167], 0
    buffer_load_dwordx4 a[124:127], v219, s[16:19], s43 offen
    v_mfma_f32_16x16x32_bf16 v[76:79], v[136:139], v[164:167], 0
    buffer_load_dwordx4 a[128:131], v220, s[16:19], s43 offen
    v_mfma_f32_16x16x32_bf16 v[104:107], v[140:143], v[164:167], 0
    buffer_load_dwordx4 a[132:135], v221, s[16:19], s43 offen
    s_waitcnt lgkmcnt(8)
    v_mfma_f32_16x16x32_bf16 v[24:27], v[128:131], v[168:171], 0
    buffer_load_dwordx4 a[136:139], v222, s[16:19], s43 offen
    v_mfma_f32_16x16x32_bf16 v[52:55], v[132:135], v[168:171], 0
    ds_read_b128 v[144:147], v12 offset:64
    v_mfma_f32_16x16x32_bf16 v[80:83], v[136:139], v[168:171], 0
    ds_read_b128 v[148:151], v12 offset:2176
    v_mfma_f32_16x16x32_bf16 v[108:111], v[140:143], v[168:171], 0
    ds_read_b128 v[152:155], v12 offset:16960
    s_waitcnt lgkmcnt(9)
    v_mfma_f32_16x16x32_bf16 v[28:31], v[128:131], v[172:175], 0
    ds_read_b128 v[156:159], v12 offset:19072
    v_mfma_f32_16x16x32_bf16 v[56:59], v[132:135], v[172:175], 0
    ds_read_b64_tr_b16 v[188:189], v15 offset:7680
    v_mfma_f32_16x16x32_bf16 v[84:87], v[136:139], v[172:175], 0
    ds_read_b64_tr_b16 v[190:191], v15 offset:8576
    v_mfma_f32_16x16x32_bf16 v[112:115], v[140:143], v[172:175], 0
    ds_read_b64_tr_b16 v[192:193], v15 offset:7712
    s_waitcnt lgkmcnt(11)
    v_mfma_f32_16x16x32_bf16 v[32:35], v[128:131], v[176:179], 0
    ds_read_b64_tr_b16 v[194:195], v15 offset:8608
    v_mfma_f32_16x16x32_bf16 v[60:63], v[132:135], v[176:179], 0
    ds_read_b64_tr_b16 v[196:197], v15 offset:7744
    v_mfma_f32_16x16x32_bf16 v[88:91], v[136:139], v[176:179], 0
    ds_read_b64_tr_b16 v[198:199], v15 offset:8640
    v_mfma_f32_16x16x32_bf16 v[116:119], v[140:143], v[176:179], 0
    ds_read_b64_tr_b16 v[200:201], v15 offset:7776
    s_waitcnt lgkmcnt(13)
    v_mfma_f32_16x16x32_bf16 v[36:39], v[128:131], v[180:183], 0
    ds_read_b64_tr_b16 v[202:203], v15 offset:8672
    v_mfma_f32_16x16x32_bf16 v[64:67], v[132:135], v[180:183], 0
    ds_read_b64_tr_b16 v[204:205], v15 offset:7808
    v_mfma_f32_16x16x32_bf16 v[92:95], v[136:139], v[180:183], 0
    ds_read_b64_tr_b16 v[206:207], v15 offset:8704
    v_mfma_f32_16x16x32_bf16 v[120:123], v[140:143], v[180:183], 0
    ds_read_b64_tr_b16 v[208:209], v15 offset:7840
    s_waitcnt lgkmcnt(15)
    v_mfma_f32_16x16x32_bf16 v[40:43], v[128:131], v[184:187], 0
    ds_read_b64_tr_b16 v[210:211], v15 offset:8736
    v_mfma_f32_16x16x32_bf16 v[68:71], v[132:135], v[184:187], 0
    ds_read_b64_tr_b16 v[212:213], v15 offset:7872
    v_mfma_f32_16x16x32_bf16 v[96:99], v[136:139], v[184:187], 0
    ds_read_b64_tr_b16 v[214:215], v15 offset:8768
    v_mfma_f32_16x16x32_bf16 v[124:127], v[140:143], v[184:187], 0
    s_waitcnt lgkmcnt(12)
    v_mfma_f32_16x16x32_bf16 v[16:19], v[144:147], v[188:191], v[16:19]
    s_add_u32 s43, s43, 28672
    buffer_load_dwordx4 a[140:143], v216, s[16:19], s43 offen
    v_mfma_f32_16x16x32_bf16 v[44:47], v[148:151], v[188:191], v[44:47]
    buffer_load_dwordx4 a[144:147], v217, s[16:19], s43 offen
    buffer_load_dwordx4 a[148:151], v218, s[16:19], s43 offen
    v_mfma_f32_16x16x32_bf16 v[72:75], v[152:155], v[188:191], v[72:75]
    buffer_load_dwordx4 a[152:155], v219, s[16:19], s43 offen
    buffer_load_dwordx4 a[156:159], v220, s[16:19], s43 offen
    v_mfma_f32_16x16x32_bf16 v[100:103], v[156:159], v[188:191], v[100:103]
    buffer_load_dwordx4 a[160:163], v221, s[16:19], s43 offen
    buffer_load_dwordx4 a[164:167], v222, s[16:19], s43 offen
    s_waitcnt lgkmcnt(10)
    v_mfma_f32_16x16x32_bf16 v[20:23], v[144:147], v[192:195], v[20:23]
    s_waitcnt vmcnt(27)
    ds_write_b128 v223, a[56:59] offset:0
    s_waitcnt vmcnt(26)
    ds_write_b128 v224, a[60:63] offset:0
    v_mfma_f32_16x16x32_bf16 v[48:51], v[148:151], v[192:195], v[48:51]
    s_waitcnt vmcnt(25)
    ds_write_b128 v225, a[64:67] offset:0
    s_waitcnt vmcnt(24)
    ds_write_b128 v226, a[68:71] offset:0
    v_mfma_f32_16x16x32_bf16 v[76:79], v[152:155], v[192:195], v[76:79]
    s_waitcnt vmcnt(23)
    ds_write_b128 v227, a[72:75] offset:0
    s_waitcnt vmcnt(22)
    ds_write_b128 v228, a[76:79] offset:0
    v_mfma_f32_16x16x32_bf16 v[104:107], v[156:159], v[192:195], v[104:107]
    s_waitcnt vmcnt(21)
    ds_write_b128 v229, a[80:83] offset:0
    s_waitcnt vmcnt(20)
    ds_write_b128 v223, a[84:87] offset:7680
    v_mfma_f32_16x16x32_bf16 v[24:27], v[144:147], v[196:199], v[24:27]
    s_waitcnt vmcnt(19)
    ds_write_b128 v224, a[88:91] offset:7680
    s_waitcnt vmcnt(18)
    ds_write_b128 v225, a[92:95] offset:7680
    v_mfma_f32_16x16x32_bf16 v[52:55], v[148:151], v[196:199], v[52:55]
    s_waitcnt vmcnt(17)
    ds_write_b128 v226, a[96:99] offset:7680
    s_waitcnt vmcnt(16)
    ds_write_b128 v227, a[100:103] offset:7680
    v_mfma_f32_16x16x32_bf16 v[80:83], v[152:155], v[196:199], v[80:83]
    s_waitcnt vmcnt(15)
    ds_write_b128 v228, a[104:107] offset:7680
    s_waitcnt vmcnt(14)
    ds_write_b128 v229, a[108:111] offset:7680
    v_mfma_f32_16x16x32_bf16 v[108:111], v[156:159], v[196:199], v[108:111]
    ds_read_b128 v[128:131], v12 offset:128
    ds_read_b128 v[132:135], v12 offset:2240
    v_mfma_f32_16x16x32_bf16 v[28:31], v[144:147], v[200:203], v[28:31]
    ds_read_b128 v[136:139], v12 offset:17024
    v_mfma_f32_16x16x32_bf16 v[56:59], v[148:151], v[200:203], v[56:59]
    ds_read_b128 v[140:143], v12 offset:19136
    v_mfma_f32_16x16x32_bf16 v[84:87], v[152:155], v[200:203], v[84:87]
    ds_read_b64_tr_b16 v[160:161], v15 offset:0
    v_mfma_f32_16x16x32_bf16 v[112:115], v[156:159], v[200:203], v[112:115]
    ds_read_b64_tr_b16 v[162:163], v15 offset:896
    v_mfma_f32_16x16x32_bf16 v[32:35], v[144:147], v[204:207], v[32:35]
    ds_read_b64_tr_b16 v[164:165], v15 offset:32
    v_mfma_f32_16x16x32_bf16 v[60:63], v[148:151], v[204:207], v[60:63]
    ds_read_b64_tr_b16 v[166:167], v15 offset:928
    v_mfma_f32_16x16x32_bf16 v[88:91], v[152:155], v[204:207], v[88:91]
    ds_read_b64_tr_b16 v[168:169], v15 offset:64
    v_mfma_f32_16x16x32_bf16 v[116:119], v[156:159], v[204:207], v[116:119]
    ds_read_b64_tr_b16 v[170:171], v15 offset:960
    v_mfma_f32_16x16x32_bf16 v[36:39], v[144:147], v[208:211], v[36:39]
    ds_read_b64_tr_b16 v[172:173], v15 offset:96
    v_mfma_f32_16x16x32_bf16 v[64:67], v[148:151], v[208:211], v[64:67]
    ds_read_b64_tr_b16 v[174:175], v15 offset:992
    v_mfma_f32_16x16x32_bf16 v[92:95], v[152:155], v[208:211], v[92:95]
    ds_read_b64_tr_b16 v[176:177], v15 offset:128
    v_mfma_f32_16x16x32_bf16 v[120:123], v[156:159], v[208:211], v[120:123]
    ds_read_b64_tr_b16 v[178:179], v15 offset:1024
    v_mfma_f32_16x16x32_bf16 v[40:43], v[144:147], v[212:215], v[40:43]
    ds_read_b64_tr_b16 v[180:181], v15 offset:160
    v_mfma_f32_16x16x32_bf16 v[68:71], v[148:151], v[212:215], v[68:71]
    ds_read_b64_tr_b16 v[182:183], v15 offset:1056
    v_mfma_f32_16x16x32_bf16 v[96:99], v[152:155], v[212:215], v[96:99]
    ds_read_b64_tr_b16 v[184:185], v15 offset:192
    v_mfma_f32_16x16x32_bf16 v[124:127], v[156:159], v[212:215], v[124:127]
    ds_read_b64_tr_b16 v[186:187], v15 offset:1088
    s_waitcnt lgkmcnt(12)
    v_mfma_f32_16x16x32_bf16 v[16:19], v[128:131], v[160:163], v[16:19]
    s_mul_i32 s43, s34, 229376
    v_mfma_f32_16x16x32_bf16 v[44:47], v[132:135], v[160:163], v[44:47]
    s_add_u32 s43, s43, 172032
    v_mfma_f32_16x16x32_bf16 v[72:75], v[136:139], v[160:163], v[72:75]
    buffer_load_dwordx4 a[168:171], v216, s[16:19], s43 offen
    v_mfma_f32_16x16x32_bf16 v[100:103], v[140:143], v[160:163], v[100:103]
    buffer_load_dwordx4 a[172:175], v217, s[16:19], s43 offen
    s_waitcnt lgkmcnt(10)
    v_mfma_f32_16x16x32_bf16 v[20:23], v[128:131], v[164:167], v[20:23]
    buffer_load_dwordx4 a[176:179], v218, s[16:19], s43 offen
    v_mfma_f32_16x16x32_bf16 v[48:51], v[132:135], v[164:167], v[48:51]
    buffer_load_dwordx4 a[180:183], v219, s[16:19], s43 offen
    v_mfma_f32_16x16x32_bf16 v[76:79], v[136:139], v[164:167], v[76:79]
    buffer_load_dwordx4 a[184:187], v220, s[16:19], s43 offen
    v_mfma_f32_16x16x32_bf16 v[104:107], v[140:143], v[164:167], v[104:107]
    buffer_load_dwordx4 a[188:191], v221, s[16:19], s43 offen
    s_waitcnt lgkmcnt(8)
    v_mfma_f32_16x16x32_bf16 v[24:27], v[128:131], v[168:171], v[24:27]
    buffer_load_dwordx4 a[192:195], v222, s[16:19], s43 offen
    v_mfma_f32_16x16x32_bf16 v[52:55], v[132:135], v[168:171], v[52:55]
    ds_read_b128 v[144:147], v12 offset:192
    v_mfma_f32_16x16x32_bf16 v[80:83], v[136:139], v[168:171], v[80:83]
    ds_read_b128 v[148:151], v12 offset:2304
    v_mfma_f32_16x16x32_bf16 v[108:111], v[140:143], v[168:171], v[108:111]
    ds_read_b128 v[152:155], v12 offset:17088
    s_waitcnt lgkmcnt(9)
    v_mfma_f32_16x16x32_bf16 v[28:31], v[128:131], v[172:175], v[28:31]
    ds_read_b128 v[156:159], v12 offset:19200
    v_mfma_f32_16x16x32_bf16 v[56:59], v[132:135], v[172:175], v[56:59]
    ds_read_b64_tr_b16 v[188:189], v15 offset:7680
    v_mfma_f32_16x16x32_bf16 v[84:87], v[136:139], v[172:175], v[84:87]
    ds_read_b64_tr_b16 v[190:191], v15 offset:8576
    v_mfma_f32_16x16x32_bf16 v[112:115], v[140:143], v[172:175], v[112:115]
    ds_read_b64_tr_b16 v[192:193], v15 offset:7712
    s_waitcnt lgkmcnt(11)
    v_mfma_f32_16x16x32_bf16 v[32:35], v[128:131], v[176:179], v[32:35]
    ds_read_b64_tr_b16 v[194:195], v15 offset:8608
    v_mfma_f32_16x16x32_bf16 v[60:63], v[132:135], v[176:179], v[60:63]
    ds_read_b64_tr_b16 v[196:197], v15 offset:7744
    v_mfma_f32_16x16x32_bf16 v[88:91], v[136:139], v[176:179], v[88:91]
    ds_read_b64_tr_b16 v[198:199], v15 offset:8640
    v_mfma_f32_16x16x32_bf16 v[116:119], v[140:143], v[176:179], v[116:119]
    ds_read_b64_tr_b16 v[200:201], v15 offset:7776
    s_waitcnt lgkmcnt(13)
    v_mfma_f32_16x16x32_bf16 v[36:39], v[128:131], v[180:183], v[36:39]
    ds_read_b64_tr_b16 v[202:203], v15 offset:8672
    v_mfma_f32_16x16x32_bf16 v[64:67], v[132:135], v[180:183], v[64:67]
    ds_read_b64_tr_b16 v[204:205], v15 offset:7808
    v_mfma_f32_16x16x32_bf16 v[92:95], v[136:139], v[180:183], v[92:95]
    ds_read_b64_tr_b16 v[206:207], v15 offset:8704
    v_mfma_f32_16x16x32_bf16 v[120:123], v[140:143], v[180:183], v[120:123]
    ds_read_b64_tr_b16 v[208:209], v15 offset:7840
    s_waitcnt lgkmcnt(15)
    v_mfma_f32_16x16x32_bf16 v[40:43], v[128:131], v[184:187], v[40:43]
    ds_read_b64_tr_b16 v[210:211], v15 offset:8736
    v_mfma_f32_16x16x32_bf16 v[68:71], v[132:135], v[184:187], v[68:71]
    ds_read_b64_tr_b16 v[212:213], v15 offset:7872
    v_mfma_f32_16x16x32_bf16 v[96:99], v[136:139], v[184:187], v[96:99]
    ds_read_b64_tr_b16 v[214:215], v15 offset:8768
    v_mfma_f32_16x16x32_bf16 v[124:127], v[140:143], v[184:187], v[124:127]
    s_waitcnt lgkmcnt(12)
    v_mfma_f32_16x16x32_bf16 v[16:19], v[144:147], v[188:191], v[16:19]
    s_add_u32 s43, s43, 28672
    buffer_load_dwordx4 a[196:199], v216, s[16:19], s43 offen
    v_mfma_f32_16x16x32_bf16 v[44:47], v[148:151], v[188:191], v[44:47]
    buffer_load_dwordx4 a[200:203], v217, s[16:19], s43 offen
    buffer_load_dwordx4 a[204:207], v218, s[16:19], s43 offen
    v_mfma_f32_16x16x32_bf16 v[72:75], v[152:155], v[188:191], v[72:75]
    buffer_load_dwordx4 a[208:211], v219, s[16:19], s43 offen
    buffer_load_dwordx4 a[212:215], v220, s[16:19], s43 offen
    v_mfma_f32_16x16x32_bf16 v[100:103], v[156:159], v[188:191], v[100:103]
    buffer_load_dwordx4 a[216:219], v221, s[16:19], s43 offen
    buffer_load_dwordx4 a[220:223], v222, s[16:19], s43 offen
    s_waitcnt lgkmcnt(10)
    v_mfma_f32_16x16x32_bf16 v[20:23], v[144:147], v[192:195], v[20:23]
    s_waitcnt vmcnt(27)
    ds_write_b128 v223, a[112:115] offset:0
    s_waitcnt vmcnt(26)
    ds_write_b128 v224, a[116:119] offset:0
    v_mfma_f32_16x16x32_bf16 v[48:51], v[148:151], v[192:195], v[48:51]
    s_waitcnt vmcnt(25)
    ds_write_b128 v225, a[120:123] offset:0
    s_waitcnt vmcnt(24)
    ds_write_b128 v226, a[124:127] offset:0
    v_mfma_f32_16x16x32_bf16 v[76:79], v[152:155], v[192:195], v[76:79]
    s_waitcnt vmcnt(23)
    ds_write_b128 v227, a[128:131] offset:0
    s_waitcnt vmcnt(22)
    ds_write_b128 v228, a[132:135] offset:0
    v_mfma_f32_16x16x32_bf16 v[104:107], v[156:159], v[192:195], v[104:107]
    s_waitcnt vmcnt(21)
    ds_write_b128 v229, a[136:139] offset:0
    s_waitcnt vmcnt(20)
    ds_write_b128 v223, a[140:143] offset:7680
    v_mfma_f32_16x16x32_bf16 v[24:27], v[144:147], v[196:199], v[24:27]
    s_waitcnt vmcnt(19)
    ds_write_b128 v224, a[144:147] offset:7680
    s_waitcnt vmcnt(18)
    ds_write_b128 v225, a[148:151] offset:7680
    v_mfma_f32_16x16x32_bf16 v[52:55], v[148:151], v[196:199], v[52:55]
    s_waitcnt vmcnt(17)
    ds_write_b128 v226, a[152:155] offset:7680
    s_waitcnt vmcnt(16)
    ds_write_b128 v227, a[156:159] offset:7680
    v_mfma_f32_16x16x32_bf16 v[80:83], v[152:155], v[196:199], v[80:83]
    s_waitcnt vmcnt(15)
    ds_write_b128 v228, a[160:163] offset:7680
    s_waitcnt vmcnt(14)
    ds_write_b128 v229, a[164:167] offset:7680
    v_mfma_f32_16x16x32_bf16 v[108:111], v[156:159], v[196:199], v[108:111]
    ds_read_b128 v[128:131], v12 offset:256
    ds_read_b128 v[132:135], v12 offset:2368
    v_mfma_f32_16x16x32_bf16 v[28:31], v[144:147], v[200:203], v[28:31]
    ds_read_b128 v[136:139], v12 offset:17152
    v_mfma_f32_16x16x32_bf16 v[56:59], v[148:151], v[200:203], v[56:59]
    ds_read_b128 v[140:143], v12 offset:19264
    v_mfma_f32_16x16x32_bf16 v[84:87], v[152:155], v[200:203], v[84:87]
    ds_read_b64_tr_b16 v[160:161], v15 offset:0
    v_mfma_f32_16x16x32_bf16 v[112:115], v[156:159], v[200:203], v[112:115]
    ds_read_b64_tr_b16 v[162:163], v15 offset:896
    v_mfma_f32_16x16x32_bf16 v[32:35], v[144:147], v[204:207], v[32:35]
    ds_read_b64_tr_b16 v[164:165], v15 offset:32
    v_mfma_f32_16x16x32_bf16 v[60:63], v[148:151], v[204:207], v[60:63]
    ds_read_b64_tr_b16 v[166:167], v15 offset:928
    v_mfma_f32_16x16x32_bf16 v[88:91], v[152:155], v[204:207], v[88:91]
    ds_read_b64_tr_b16 v[168:169], v15 offset:64
    v_mfma_f32_16x16x32_bf16 v[116:119], v[156:159], v[204:207], v[116:119]
    ds_read_b64_tr_b16 v[170:171], v15 offset:960
    v_mfma_f32_16x16x32_bf16 v[36:39], v[144:147], v[208:211], v[36:39]
    ds_read_b64_tr_b16 v[172:173], v15 offset:96
    v_mfma_f32_16x16x32_bf16 v[64:67], v[148:151], v[208:211], v[64:67]
    ds_read_b64_tr_b16 v[174:175], v15 offset:992
    v_mfma_f32_16x16x32_bf16 v[92:95], v[152:155], v[208:211], v[92:95]
    ds_read_b64_tr_b16 v[176:177], v15 offset:128
    v_mfma_f32_16x16x32_bf16 v[120:123], v[156:159], v[208:211], v[120:123]
    ds_read_b64_tr_b16 v[178:179], v15 offset:1024
    v_mfma_f32_16x16x32_bf16 v[40:43], v[144:147], v[212:215], v[40:43]
    ds_read_b64_tr_b16 v[180:181], v15 offset:160
    v_mfma_f32_16x16x32_bf16 v[68:71], v[148:151], v[212:215], v[68:71]
    ds_read_b64_tr_b16 v[182:183], v15 offset:1056
    v_mfma_f32_16x16x32_bf16 v[96:99], v[152:155], v[212:215], v[96:99]
    ds_read_b64_tr_b16 v[184:185], v15 offset:192
    v_mfma_f32_16x16x32_bf16 v[124:127], v[156:159], v[212:215], v[124:127]
    ds_read_b64_tr_b16 v[186:187], v15 offset:1088
    s_waitcnt lgkmcnt(12)
    v_mfma_f32_16x16x32_bf16 v[16:19], v[128:131], v[160:163], v[16:19]
    ds_read_b128 v[144:147], v12 offset:320
    v_mfma_f32_16x16x32_bf16 v[44:47], v[132:135], v[160:163], v[44:47]
    ds_read_b128 v[148:151], v12 offset:2432
    v_mfma_f32_16x16x32_bf16 v[72:75], v[136:139], v[160:163], v[72:75]
    ds_read_b128 v[152:155], v12 offset:17216
    v_mfma_f32_16x16x32_bf16 v[100:103], v[140:143], v[160:163], v[100:103]
    ds_read_b128 v[156:159], v12 offset:19328
    s_waitcnt lgkmcnt(14)
    v_mfma_f32_16x16x32_bf16 v[20:23], v[128:131], v[164:167], v[20:23]
    ds_read_b64_tr_b16 v[188:189], v15 offset:7680
    v_mfma_f32_16x16x32_bf16 v[48:51], v[132:135], v[164:167], v[48:51]
    ds_read_b64_tr_b16 v[190:191], v15 offset:8576
    v_mfma_f32_16x16x32_bf16 v[76:79], v[136:139], v[164:167], v[76:79]
    ds_read_b64_tr_b16 v[192:193], v15 offset:7712
    v_mfma_f32_16x16x32_bf16 v[104:107], v[140:143], v[164:167], v[104:107]
    ds_read_b64_tr_b16 v[194:195], v15 offset:8608
    v_mfma_f32_16x16x32_bf16 v[24:27], v[128:131], v[168:171], v[24:27]
    ds_read_b64_tr_b16 v[196:197], v15 offset:7744
    v_mfma_f32_16x16x32_bf16 v[52:55], v[132:135], v[168:171], v[52:55]
    ds_read_b64_tr_b16 v[198:199], v15 offset:8640
    v_mfma_f32_16x16x32_bf16 v[80:83], v[136:139], v[168:171], v[80:83]
    ds_read_b64_tr_b16 v[200:201], v15 offset:7776
    v_mfma_f32_16x16x32_bf16 v[108:111], v[140:143], v[168:171], v[108:111]
    ds_read_b64_tr_b16 v[202:203], v15 offset:8672
    v_mfma_f32_16x16x32_bf16 v[28:31], v[128:131], v[172:175], v[28:31]
    ds_read_b64_tr_b16 v[204:205], v15 offset:7808
    v_mfma_f32_16x16x32_bf16 v[56:59], v[132:135], v[172:175], v[56:59]
    ds_read_b64_tr_b16 v[206:207], v15 offset:8704
    v_mfma_f32_16x16x32_bf16 v[84:87], v[136:139], v[172:175], v[84:87]
    ds_read_b64_tr_b16 v[208:209], v15 offset:7840
    v_mfma_f32_16x16x32_bf16 v[112:115], v[140:143], v[172:175], v[112:115]
    ds_read_b64_tr_b16 v[210:211], v15 offset:8736
    v_mfma_f32_16x16x32_bf16 v[32:35], v[128:131], v[176:179], v[32:35]
    ds_read_b64_tr_b16 v[212:213], v15 offset:7872
    v_mfma_f32_16x16x32_bf16 v[60:63], v[132:135], v[176:179], v[60:63]
    ds_read_b64_tr_b16 v[214:215], v15 offset:8768
    v_mfma_f32_16x16x32_bf16 v[88:91], v[136:139], v[176:179], v[88:91]
    v_mfma_f32_16x16x32_bf16 v[116:119], v[140:143], v[176:179], v[116:119]
    v_mfma_f32_16x16x32_bf16 v[36:39], v[128:131], v[180:183], v[36:39]
    v_mfma_f32_16x16x32_bf16 v[64:67], v[132:135], v[180:183], v[64:67]
    v_mfma_f32_16x16x32_bf16 v[92:95], v[136:139], v[180:183], v[92:95]
    v_mfma_f32_16x16x32_bf16 v[120:123], v[140:143], v[180:183], v[120:123]
    v_mfma_f32_16x16x32_bf16 v[40:43], v[128:131], v[184:187], v[40:43]
    v_mfma_f32_16x16x32_bf16 v[68:71], v[132:135], v[184:187], v[68:71]
    v_mfma_f32_16x16x32_bf16 v[96:99], v[136:139], v[184:187], v[96:99]
    v_mfma_f32_16x16x32_bf16 v[124:127], v[140:143], v[184:187], v[124:127]
    s_waitcnt lgkmcnt(12)
    v_mfma_f32_16x16x32_bf16 v[16:19], v[144:147], v[188:191], v[16:19]
    s_waitcnt vmcnt(13)
    ds_write_b128 v223, a[168:171] offset:0
    s_waitcnt vmcnt(12)
    ds_write_b128 v224, a[172:175] offset:0
    v_mfma_f32_16x16x32_bf16 v[44:47], v[148:151], v[188:191], v[44:47]
    s_waitcnt vmcnt(11)
    ds_write_b128 v225, a[176:179] offset:0
    s_waitcnt vmcnt(10)
    ds_write_b128 v226, a[180:183] offset:0
    v_mfma_f32_16x16x32_bf16 v[72:75], v[152:155], v[188:191], v[72:75]
    s_waitcnt vmcnt(9)
    ds_write_b128 v227, a[184:187] offset:0
    s_waitcnt vmcnt(8)
    ds_write_b128 v228, a[188:191] offset:0
    v_mfma_f32_16x16x32_bf16 v[100:103], v[156:159], v[188:191], v[100:103]
    s_waitcnt vmcnt(7)
    ds_write_b128 v229, a[192:195] offset:0
    s_waitcnt vmcnt(6)
    ds_write_b128 v223, a[196:199] offset:7680
    v_mfma_f32_16x16x32_bf16 v[20:23], v[144:147], v[192:195], v[20:23]
    s_waitcnt vmcnt(5)
    ds_write_b128 v224, a[200:203] offset:7680
    v_mfma_f32_16x16x32_bf16 v[48:51], v[148:151], v[192:195], v[48:51]
    s_waitcnt vmcnt(4)
    ds_write_b128 v225, a[204:207] offset:7680
    v_mfma_f32_16x16x32_bf16 v[76:79], v[152:155], v[192:195], v[76:79]
    s_waitcnt vmcnt(3)
    ds_write_b128 v226, a[208:211] offset:7680
    v_mfma_f32_16x16x32_bf16 v[104:107], v[156:159], v[192:195], v[104:107]
    s_waitcnt vmcnt(2)
    ds_write_b128 v227, a[212:215] offset:7680
    v_mfma_f32_16x16x32_bf16 v[24:27], v[144:147], v[196:199], v[24:27]
    s_waitcnt vmcnt(1)
    ds_write_b128 v228, a[216:219] offset:7680
    v_mfma_f32_16x16x32_bf16 v[52:55], v[148:151], v[196:199], v[52:55]
    s_waitcnt vmcnt(0)
    ds_write_b128 v229, a[220:223] offset:7680
    v_mfma_f32_16x16x32_bf16 v[80:83], v[152:155], v[196:199], v[80:83]
    ds_read_b128 v[128:131], v12 offset:384
    v_mfma_f32_16x16x32_bf16 v[108:111], v[156:159], v[196:199], v[108:111]
    ds_read_b128 v[132:135], v12 offset:2496
    v_mfma_f32_16x16x32_bf16 v[28:31], v[144:147], v[200:203], v[28:31]
    ds_read_b128 v[136:139], v12 offset:17280
    v_mfma_f32_16x16x32_bf16 v[56:59], v[148:151], v[200:203], v[56:59]
    ds_read_b128 v[140:143], v12 offset:19392
    v_mfma_f32_16x16x32_bf16 v[84:87], v[152:155], v[200:203], v[84:87]
    ds_read_b64_tr_b16 v[160:161], v15 offset:0
    v_mfma_f32_16x16x32_bf16 v[112:115], v[156:159], v[200:203], v[112:115]
    ds_read_b64_tr_b16 v[162:163], v15 offset:896
    v_mfma_f32_16x16x32_bf16 v[32:35], v[144:147], v[204:207], v[32:35]
    ds_read_b64_tr_b16 v[164:165], v15 offset:32
    v_mfma_f32_16x16x32_bf16 v[60:63], v[148:151], v[204:207], v[60:63]
    ds_read_b64_tr_b16 v[166:167], v15 offset:928
    v_mfma_f32_16x16x32_bf16 v[88:91], v[152:155], v[204:207], v[88:91]
    ds_read_b64_tr_b16 v[168:169], v15 offset:64
    v_mfma_f32_16x16x32_bf16 v[116:119], v[156:159], v[204:207], v[116:119]
    ds_read_b64_tr_b16 v[170:171], v15 offset:960
    v_mfma_f32_16x16x32_bf16 v[36:39], v[144:147], v[208:211], v[36:39]
    ds_read_b64_tr_b16 v[172:173], v15 offset:96
    v_mfma_f32_16x16x32_bf16 v[64:67], v[148:151], v[208:211], v[64:67]
    ds_read_b64_tr_b16 v[174:175], v15 offset:992
    v_mfma_f32_16x16x32_bf16 v[92:95], v[152:155], v[208:211], v[92:95]
    ds_read_b64_tr_b16 v[176:177], v15 offset:128
    v_mfma_f32_16x16x32_bf16 v[120:123], v[156:159], v[208:211], v[120:123]
    ds_read_b64_tr_b16 v[178:179], v15 offset:1024
    v_mfma_f32_16x16x32_bf16 v[40:43], v[144:147], v[212:215], v[40:43]
    ds_read_b64_tr_b16 v[180:181], v15 offset:160
    v_mfma_f32_16x16x32_bf16 v[68:71], v[148:151], v[212:215], v[68:71]
    ds_read_b64_tr_b16 v[182:183], v15 offset:1056
    v_mfma_f32_16x16x32_bf16 v[96:99], v[152:155], v[212:215], v[96:99]
    ds_read_b64_tr_b16 v[184:185], v15 offset:192
    v_mfma_f32_16x16x32_bf16 v[124:127], v[156:159], v[212:215], v[124:127]
    ds_read_b64_tr_b16 v[186:187], v15 offset:1088
    s_waitcnt lgkmcnt(12)
    v_mfma_f32_16x16x32_bf16 v[16:19], v[128:131], v[160:163], v[16:19]
    ds_read_b128 v[144:147], v12 offset:448
    v_mfma_f32_16x16x32_bf16 v[44:47], v[132:135], v[160:163], v[44:47]
    ds_read_b128 v[148:151], v12 offset:2560
    v_mfma_f32_16x16x32_bf16 v[72:75], v[136:139], v[160:163], v[72:75]
    ds_read_b128 v[152:155], v12 offset:17344
    v_mfma_f32_16x16x32_bf16 v[100:103], v[140:143], v[160:163], v[100:103]
    ds_read_b128 v[156:159], v12 offset:19456
    s_waitcnt lgkmcnt(14)
    v_mfma_f32_16x16x32_bf16 v[20:23], v[128:131], v[164:167], v[20:23]
    ds_read_b64_tr_b16 v[188:189], v15 offset:7680
    v_mfma_f32_16x16x32_bf16 v[48:51], v[132:135], v[164:167], v[48:51]
    ds_read_b64_tr_b16 v[190:191], v15 offset:8576
    v_mfma_f32_16x16x32_bf16 v[76:79], v[136:139], v[164:167], v[76:79]
    ds_read_b64_tr_b16 v[192:193], v15 offset:7712
    v_mfma_f32_16x16x32_bf16 v[104:107], v[140:143], v[164:167], v[104:107]
    ds_read_b64_tr_b16 v[194:195], v15 offset:8608
    v_mfma_f32_16x16x32_bf16 v[24:27], v[128:131], v[168:171], v[24:27]
    ds_read_b64_tr_b16 v[196:197], v15 offset:7744
    v_mfma_f32_16x16x32_bf16 v[52:55], v[132:135], v[168:171], v[52:55]
    ds_read_b64_tr_b16 v[198:199], v15 offset:8640
    v_mfma_f32_16x16x32_bf16 v[80:83], v[136:139], v[168:171], v[80:83]
    ds_read_b64_tr_b16 v[200:201], v15 offset:7776
    v_mfma_f32_16x16x32_bf16 v[108:111], v[140:143], v[168:171], v[108:111]
    ds_read_b64_tr_b16 v[202:203], v15 offset:8672
    v_mfma_f32_16x16x32_bf16 v[28:31], v[128:131], v[172:175], v[28:31]
    ds_read_b64_tr_b16 v[204:205], v15 offset:7808
    v_mfma_f32_16x16x32_bf16 v[56:59], v[132:135], v[172:175], v[56:59]
    ds_read_b64_tr_b16 v[206:207], v15 offset:8704
    v_mfma_f32_16x16x32_bf16 v[84:87], v[136:139], v[172:175], v[84:87]
    ds_read_b64_tr_b16 v[208:209], v15 offset:7840
    v_mfma_f32_16x16x32_bf16 v[112:115], v[140:143], v[172:175], v[112:115]
    ds_read_b64_tr_b16 v[210:211], v15 offset:8736
    v_mfma_f32_16x16x32_bf16 v[32:35], v[128:131], v[176:179], v[32:35]
    ds_read_b64_tr_b16 v[212:213], v15 offset:7872
    v_mfma_f32_16x16x32_bf16 v[60:63], v[132:135], v[176:179], v[60:63]
    ds_read_b64_tr_b16 v[214:215], v15 offset:8768
    v_mfma_f32_16x16x32_bf16 v[88:91], v[136:139], v[176:179], v[88:91]
    v_mfma_f32_16x16x32_bf16 v[116:119], v[140:143], v[176:179], v[116:119]
    v_mfma_f32_16x16x32_bf16 v[36:39], v[128:131], v[180:183], v[36:39]
    v_mfma_f32_16x16x32_bf16 v[64:67], v[132:135], v[180:183], v[64:67]
    v_mfma_f32_16x16x32_bf16 v[92:95], v[136:139], v[180:183], v[92:95]
    v_mfma_f32_16x16x32_bf16 v[120:123], v[140:143], v[180:183], v[120:123]
    v_mfma_f32_16x16x32_bf16 v[40:43], v[128:131], v[184:187], v[40:43]
    v_mfma_f32_16x16x32_bf16 v[68:71], v[132:135], v[184:187], v[68:71]
    v_mfma_f32_16x16x32_bf16 v[96:99], v[136:139], v[184:187], v[96:99]
    v_mfma_f32_16x16x32_bf16 v[124:127], v[140:143], v[184:187], v[124:127]
    s_waitcnt lgkmcnt(12)
    v_mfma_f32_16x16x32_bf16 v[16:19], v[144:147], v[188:191], v[16:19]
    v_mfma_f32_16x16x32_bf16 v[44:47], v[148:151], v[188:191], v[44:47]
    v_mfma_f32_16x16x32_bf16 v[72:75], v[152:155], v[188:191], v[72:75]
    v_mfma_f32_16x16x32_bf16 v[100:103], v[156:159], v[188:191], v[100:103]
    s_waitcnt lgkmcnt(10)
    v_mfma_f32_16x16x32_bf16 v[20:23], v[144:147], v[192:195], v[20:23]
    v_mfma_f32_16x16x32_bf16 v[48:51], v[148:151], v[192:195], v[48:51]
    v_mfma_f32_16x16x32_bf16 v[76:79], v[152:155], v[192:195], v[76:79]
    v_mfma_f32_16x16x32_bf16 v[104:107], v[156:159], v[192:195], v[104:107]
    s_waitcnt lgkmcnt(8)
    v_mfma_f32_16x16x32_bf16 v[24:27], v[144:147], v[196:199], v[24:27]
    v_mfma_f32_16x16x32_bf16 v[52:55], v[148:151], v[196:199], v[52:55]
    v_mfma_f32_16x16x32_bf16 v[80:83], v[152:155], v[196:199], v[80:83]
    v_mfma_f32_16x16x32_bf16 v[108:111], v[156:159], v[196:199], v[108:111]
    s_waitcnt lgkmcnt(6)
    v_mfma_f32_16x16x32_bf16 v[28:31], v[144:147], v[200:203], v[28:31]
    v_mfma_f32_16x16x32_bf16 v[56:59], v[148:151], v[200:203], v[56:59]
    v_mfma_f32_16x16x32_bf16 v[84:87], v[152:155], v[200:203], v[84:87]
    v_mfma_f32_16x16x32_bf16 v[112:115], v[156:159], v[200:203], v[112:115]
    s_waitcnt lgkmcnt(4)
    v_mfma_f32_16x16x32_bf16 v[32:35], v[144:147], v[204:207], v[32:35]
    v_mfma_f32_16x16x32_bf16 v[60:63], v[148:151], v[204:207], v[60:63]
    v_mfma_f32_16x16x32_bf16 v[88:91], v[152:155], v[204:207], v[88:91]
    v_mfma_f32_16x16x32_bf16 v[116:119], v[156:159], v[204:207], v[116:119]
    s_waitcnt lgkmcnt(2)
    v_mfma_f32_16x16x32_bf16 v[36:39], v[144:147], v[208:211], v[36:39]
    v_mfma_f32_16x16x32_bf16 v[64:67], v[148:151], v[208:211], v[64:67]
    v_mfma_f32_16x16x32_bf16 v[92:95], v[152:155], v[208:211], v[92:95]
    v_mfma_f32_16x16x32_bf16 v[120:123], v[156:159], v[208:211], v[120:123]
    s_waitcnt lgkmcnt(0)
    v_mfma_f32_16x16x32_bf16 v[40:43], v[144:147], v[212:215], v[40:43]
    v_mfma_f32_16x16x32_bf16 v[68:71], v[148:151], v[212:215], v[68:71]
    v_mfma_f32_16x16x32_bf16 v[96:99], v[152:155], v[212:215], v[96:99]
    v_mfma_f32_16x16x32_bf16 v[124:127], v[156:159], v[212:215], v[124:127]
    s_mul_i32 s39, s32, 7
    s_add_u32 s39, s39, 0
    s_lshr_b32 s38, s39, 1
    s_lshl_b32 s38, s38, 2
    s_lshr_b32 s41, s34, 2
    s_add_u32 s38, s38, s41
    s_lshl_b32 s38, s38, 3
    s_and_b32 s41, s34, 3
    s_lshl_b32 s41, s41, 1
    s_add_u32 s38, s38, s41
    s_and_b32 s39, s39, 1
    s_add_u32 s38, s38, s39
    s_mul_i32 s38, s38, 7
    s_add_u32 s38, s38, s35
    s_lshl_b32 s38, s38, 11
    s_add_u32 s38, s38, 6815744
    v_cvt_pk_bf16_f32 v232, v16, v17
    v_cvt_pk_bf16_f32 v233, v18, v19
    v_cvt_pk_bf16_f32 v234, v44, v45
    v_cvt_pk_bf16_f32 v235, v46, v47
    buffer_store_dwordx4 v[232:235], v9, s[20:23], s38 offen offset:0 sc1
    v_cvt_pk_bf16_f32 v236, v72, v73
    v_cvt_pk_bf16_f32 v237, v74, v75
    v_cvt_pk_bf16_f32 v238, v100, v101
    v_cvt_pk_bf16_f32 v239, v102, v103
    buffer_store_dwordx4 v[236:239], v9, s[20:23], s38 offen offset:1024 sc1
    s_mul_i32 s39, s32, 7
    s_add_u32 s39, s39, 1
    s_lshr_b32 s38, s39, 1
    s_lshl_b32 s38, s38, 2
    s_lshr_b32 s41, s34, 2
    s_add_u32 s38, s38, s41
    s_lshl_b32 s38, s38, 3
    s_and_b32 s41, s34, 3
    s_lshl_b32 s41, s41, 1
    s_add_u32 s38, s38, s41
    s_and_b32 s39, s39, 1
    s_add_u32 s38, s38, s39
    s_mul_i32 s38, s38, 7
    s_add_u32 s38, s38, s35
    s_lshl_b32 s38, s38, 11
    s_add_u32 s38, s38, 6815744
    v_cvt_pk_bf16_f32 v240, v20, v21
    v_cvt_pk_bf16_f32 v241, v22, v23
    v_cvt_pk_bf16_f32 v242, v48, v49
    v_cvt_pk_bf16_f32 v243, v50, v51
    buffer_store_dwordx4 v[240:243], v9, s[20:23], s38 offen offset:0 sc1
    v_cvt_pk_bf16_f32 v244, v76, v77
    v_cvt_pk_bf16_f32 v245, v78, v79
    v_cvt_pk_bf16_f32 v246, v104, v105
    v_cvt_pk_bf16_f32 v247, v106, v107
    buffer_store_dwordx4 v[244:247], v9, s[20:23], s38 offen offset:1024 sc1
    s_mul_i32 s39, s32, 7
    s_add_u32 s39, s39, 2
    s_lshr_b32 s38, s39, 1
    s_lshl_b32 s38, s38, 2
    s_lshr_b32 s41, s34, 2
    s_add_u32 s38, s38, s41
    s_lshl_b32 s38, s38, 3
    s_and_b32 s41, s34, 3
    s_lshl_b32 s41, s41, 1
    s_add_u32 s38, s38, s41
    s_and_b32 s39, s39, 1
    s_add_u32 s38, s38, s39
    s_mul_i32 s38, s38, 7
    s_add_u32 s38, s38, s35
    s_lshl_b32 s38, s38, 11
    s_add_u32 s38, s38, 6815744
    v_cvt_pk_bf16_f32 v232, v24, v25
    v_cvt_pk_bf16_f32 v233, v26, v27
    v_cvt_pk_bf16_f32 v234, v52, v53
    v_cvt_pk_bf16_f32 v235, v54, v55
    buffer_store_dwordx4 v[232:235], v9, s[20:23], s38 offen offset:0 sc1
    v_cvt_pk_bf16_f32 v236, v80, v81
    v_cvt_pk_bf16_f32 v237, v82, v83
    v_cvt_pk_bf16_f32 v238, v108, v109
    v_cvt_pk_bf16_f32 v239, v110, v111
    buffer_store_dwordx4 v[236:239], v9, s[20:23], s38 offen offset:1024 sc1
    s_mul_i32 s39, s32, 7
    s_add_u32 s39, s39, 3
    s_lshr_b32 s38, s39, 1
    s_lshl_b32 s38, s38, 2
    s_lshr_b32 s41, s34, 2
    s_add_u32 s38, s38, s41
    s_lshl_b32 s38, s38, 3
    s_and_b32 s41, s34, 3
    s_lshl_b32 s41, s41, 1
    s_add_u32 s38, s38, s41
    s_and_b32 s39, s39, 1
    s_add_u32 s38, s38, s39
    s_mul_i32 s38, s38, 7
    s_add_u32 s38, s38, s35
    s_lshl_b32 s38, s38, 11
    s_add_u32 s38, s38, 6815744
    v_cvt_pk_bf16_f32 v240, v28, v29
    v_cvt_pk_bf16_f32 v241, v30, v31
    v_cvt_pk_bf16_f32 v242, v56, v57
    v_cvt_pk_bf16_f32 v243, v58, v59
    buffer_store_dwordx4 v[240:243], v9, s[20:23], s38 offen offset:0 sc1
    v_cvt_pk_bf16_f32 v244, v84, v85
    v_cvt_pk_bf16_f32 v245, v86, v87
    v_cvt_pk_bf16_f32 v246, v112, v113
    v_cvt_pk_bf16_f32 v247, v114, v115
    buffer_store_dwordx4 v[244:247], v9, s[20:23], s38 offen offset:1024 sc1
    s_mul_i32 s39, s32, 7
    s_add_u32 s39, s39, 4
    s_lshr_b32 s38, s39, 1
    s_lshl_b32 s38, s38, 2
    s_lshr_b32 s41, s34, 2
    s_add_u32 s38, s38, s41
    s_lshl_b32 s38, s38, 3
    s_and_b32 s41, s34, 3
    s_lshl_b32 s41, s41, 1
    s_add_u32 s38, s38, s41
    s_and_b32 s39, s39, 1
    s_add_u32 s38, s38, s39
    s_mul_i32 s38, s38, 7
    s_add_u32 s38, s38, s35
    s_lshl_b32 s38, s38, 11
    s_add_u32 s38, s38, 6815744
    v_cvt_pk_bf16_f32 v232, v32, v33
    v_cvt_pk_bf16_f32 v233, v34, v35
    v_cvt_pk_bf16_f32 v234, v60, v61
    v_cvt_pk_bf16_f32 v235, v62, v63
    buffer_store_dwordx4 v[232:235], v9, s[20:23], s38 offen offset:0 sc1
    v_cvt_pk_bf16_f32 v236, v88, v89
    v_cvt_pk_bf16_f32 v237, v90, v91
    v_cvt_pk_bf16_f32 v238, v116, v117
    v_cvt_pk_bf16_f32 v239, v118, v119
    buffer_store_dwordx4 v[236:239], v9, s[20:23], s38 offen offset:1024 sc1
    s_mul_i32 s39, s32, 7
    s_add_u32 s39, s39, 5
    s_lshr_b32 s38, s39, 1
    s_lshl_b32 s38, s38, 2
    s_lshr_b32 s41, s34, 2
    s_add_u32 s38, s38, s41
    s_lshl_b32 s38, s38, 3
    s_and_b32 s41, s34, 3
    s_lshl_b32 s41, s41, 1
    s_add_u32 s38, s38, s41
    s_and_b32 s39, s39, 1
    s_add_u32 s38, s38, s39
    s_mul_i32 s38, s38, 7
    s_add_u32 s38, s38, s35
    s_lshl_b32 s38, s38, 11
    s_add_u32 s38, s38, 6815744
    v_cvt_pk_bf16_f32 v240, v36, v37
    v_cvt_pk_bf16_f32 v241, v38, v39
    v_cvt_pk_bf16_f32 v242, v64, v65
    v_cvt_pk_bf16_f32 v243, v66, v67
    buffer_store_dwordx4 v[240:243], v9, s[20:23], s38 offen offset:0 sc1
    v_cvt_pk_bf16_f32 v244, v92, v93
    v_cvt_pk_bf16_f32 v245, v94, v95
    v_cvt_pk_bf16_f32 v246, v120, v121
    v_cvt_pk_bf16_f32 v247, v122, v123
    buffer_store_dwordx4 v[244:247], v9, s[20:23], s38 offen offset:1024 sc1
    s_mul_i32 s39, s32, 7
    s_add_u32 s39, s39, 6
    s_lshr_b32 s38, s39, 1
    s_lshl_b32 s38, s38, 2
    s_lshr_b32 s41, s34, 2
    s_add_u32 s38, s38, s41
    s_lshl_b32 s38, s38, 3
    s_and_b32 s41, s34, 3
    s_lshl_b32 s41, s41, 1
    s_add_u32 s38, s38, s41
    s_and_b32 s39, s39, 1
    s_add_u32 s38, s38, s39
    s_mul_i32 s38, s38, 7
    s_add_u32 s38, s38, s35
    s_lshl_b32 s38, s38, 11
    s_add_u32 s38, s38, 6815744
    v_cvt_pk_bf16_f32 v232, v40, v41
    v_cvt_pk_bf16_f32 v233, v42, v43
    v_cvt_pk_bf16_f32 v234, v68, v69
    v_cvt_pk_bf16_f32 v235, v70, v71
    buffer_store_dwordx4 v[232:235], v9, s[20:23], s38 offen offset:0 sc1
    v_cvt_pk_bf16_f32 v236, v96, v97
    v_cvt_pk_bf16_f32 v237, v98, v99
    v_cvt_pk_bf16_f32 v238, v124, v125
    v_cvt_pk_bf16_f32 v239, v126, v127
    buffer_store_dwordx4 v[236:239], v9, s[20:23], s38 offen offset:1024 sc1
Lk1_done:
    s_and_b32 s66, s2, 7
    s_sub_u32 s66, s66, 1
    s_lshl_b32 s66, s66, 5
    s_lshr_b32 s67, s2, 3
    s_add_u32 s66, s66, s67
Lk1_fin:
    v_mov_b32 v249, 0
    s_mov_b32 s68, 0x100000
Lnp:
    buffer_load_dword v248, v249, s[60:63], 0 offen sc1
    s_waitcnt vmcnt(0)
    v_readfirstlane_b32 s98, v248
    s_nop 3
    s_cmp_lg_u32 s98, 0
    s_cbranch_scc1 Lnq
    s_sub_u32 s68, s68, 1
    s_cbranch_scc0 Lnp
    s_endpgm
Lnq:
    s_barrier
    s_cmp_eq_u32 s32, 0
    s_cbranch_scc0 Lnf
    s_lshl_b32 s66, s66, 6
    s_add_u32 s66, s66, 15990784
    v_mov_b32 v248, s98
    s_mov_b64 exec, 1
    buffer_store_dword v248, v249, s[20:23], s66 offen sc1
    s_mov_b64 exec, -1
Lnf:
    s_load_dwordx2 s[4:5], s[0:1], 0
    s_load_dwordx2 s[6:7], s[0:1], 72
    s_load_dwordx2 s[8:9], s[0:1], 64
    s_waitcnt lgkmcnt(0)
    s_mov_b32 s12, s4
    s_mov_b32 s13, s5
    s_mov_b32 s14, 1835008
    s_mov_b32 s15, 0x00020000
    s_mov_b32 s16, s6
    s_mov_b32 s17, s7
    s_mov_b32 s18, 268435456
    s_mov_b32 s19, 0x00020000
    s_mov_b32 s20, s8
    s_mov_b32 s21, s9
    s_mov_b32 s22, 256
    s_mov_b32 s23, 0x00020000
    v_lshrrev_b32 v1, 6, v0
    s_nop 0
    v_readfirstlane_b32 s24, v1
    s_mov_b32 s28, 1048576
    s_mov_b32 s38, 0xff00ff00
    s_mov_b32 s39, 0xff00ff00
    s_mov_b32 s40, 0x00ff00ff
    s_mov_b32 s41, 0x00ff00ff
    s_and_b32 s33, s2, 7
    s_cmp_eq_u32 s33, 0
    s_cbranch_scc0 Lnotchain
    s_lshr_b32 s25, s2, 3
    s_cmp_lt_u32 s25, 32
    s_cbranch_scc0 Lnotchain
    v_and_b32 v250, 63, v0
    v_add_u32 v251, 0, v250
    v_min_u32 v251, 31, v251
    v_lshlrev_b32 v251, 6, v251
    s_mov_b32 s36, 16005120
Lnw_18:
    buffer_load_dword v253, v251, s[16:19], s36 offen sc1
    s_waitcnt vmcnt(0)
    v_cmp_ne_u32 vcc, s98, v253
    s_cbranch_vccz Lnk_19
    s_sleep 1
    s_sub_u32 s28, s28, 1
    s_cbranch_scc0 Lnw_18
    s_branch Lfail
Lnk_19:
    s_cmp_eq_u32 s25, 31
    s_cbranch_scc1 Ltracker
    s_cmp_eq_u32 s24, 0
    s_cbranch_scc0 Lx_20
    s_getreg_b32 s33, hwreg(HW_REG_XCC_ID, 0, 4)
    s_lshl_b32 s34, s25, 2
    s_add_u32 s34, s34, 15466496
    v_mov_b32 v2, s33
    v_mov_b32 v3, 0
    s_mov_b64 exec, 1
    buffer_store_dword v2, v3, s[16:19], s34 offen sc1
    s_mov_b64 exec, -1
Lx_20:
    s_cmp_eq_u32 s25, 30
    s_cbranch_scc1 Lbridge
    s_mov_b32 s26, 0
    s_mov_b32 s29, 13631488
    s_mov_b32 s30, 13635584
    s_mov_b32 s31, 14680064
    s_cmp_lt_u32 s25, 16
    s_cbranch_scc0 Lvalue
    s_mul_i32 s35, s25, 7
    v_and_b32 v250, 63, v0
    v_add_u32 v251, 0, v250
    v_min_u32 v251, 6, v251
    v_add_u32 v251, s35, v251
    v_lshlrev_b32 v251, 6, v251
    s_mov_b32 s36, 15990784
Lnw_21:
    buffer_load_dword v253, v251, s[16:19], s36 offen sc1
    s_waitcnt vmcnt(0)
    v_cmp_ne_u32 vcc, s98, v253
    s_cbranch_vccz Lnk_22
    s_sleep 1
    s_sub_u32 s28, s28, 1
    s_cbranch_scc0 Lnw_21
    s_branch Lfail
Lnk_22:
    v_and_b32 v1, 63, v0
    v_mov_b32 v2, 0x4444
    v_mov_b32 v20, 0xeeee
    v_cndmask_b32 v2, v2, v20, s[38:39]
    v_lshlrev_b32 v3, 4, v0
    v_lshrrev_b32 v20, 4, v0
    v_lshlrev_b32 v20, 7, v20
    v_add_u32 v4, v3, v20
    v_lshrrev_b32 v21, 4, v1
    v_bfe_u32 v22, v1, 2, 2
    v_and_b32 v23, 3, v1
    v_mul_u32_u24 v5, 384, v21
    v_lshrrev_b32 v24, 1, v22
    v_lshl_add_u32 v5, v24, 6, v5
    v_lshrrev_b32 v24, 1, v23
    v_lshl_add_u32 v5, v24, 5, v5
    v_and_b32 v24, 1, v22
    v_lshl_add_u32 v5, v24, 4, v5
    v_and_b32 v24, 1, v23
    v_lshl_add_u32 v5, v24, 3, v5
    v_mul_u32_u24 v7, 3584, v21
    v_and_b32 v24, 1, v21
    v_lshl_add_u32 v7, v24, 5, v7
    v_lshrrev_b32 v24, 1, v21
    v_lshl_add_u32 v7, v24, 7, v7
    v_and_b32 v24, 15, v1
    v_lshl_add_u32 v7, v24, 3, v7
    s_mul_i32 s33, s24, 7
    s_and_b32 s34, s24, 1
    s_add_u32 s35, s33, s34
    s_lshl_b32 s35, s35, 7
    s_add_u32 s35, s35, 10752
    s_cmp_eq_u32 s34, 0
    s_cselect_b32 s36, 6, 0
    s_add_u32 s36, s36, s33
    s_lshl_b32 s36, s36, 7
    s_add_u32 s36, s36, 10752
    v_add_u32 v8, s36, v7
    v_add_u32 v7, s35, v7
    v_mul_u32_u24 v9, 3584, v23
    v_and_b32 v24, 1, v23
    v_lshl_add_u32 v9, v24, 5, v9
    v_lshrrev_b32 v24, 1, v23
    v_lshl_add_u32 v9, v24, 7, v9
    v_lshl_add_u32 v9, v21, 6, v9
    v_lshl_add_u32 v9, v22, 3, v9
    v_add_u32 v9, 10752, v9
    s_mul_i32 s33, s24, 14336
    s_add_u32 s33, s33, 25856
    v_lshlrev_b32 v10, 4, v1
    v_add_u32 v10, s33, v10
    v_and_b32 v24, 7, v1
    v_lshlrev_b32 v12, 5, v24
    v_add_u32 v12, 25344, v12
    s_lshl_b32 s33, s24, 3
    v_add_u32 v11, s33, v12
    v_and_b32 v24, 7, v1
    v_lshlrev_b32 v17, 4, v24
    v_add_u32 v17, 25600, v17
    s_lshl_b32 s33, s24, 2
    v_add_u32 v19, s33, v17
    v_mov_b32 v18, 0x7f800000
    s_mov_b32 s89, 0x42800000
    s_cmp_eq_u32 s24, 0
    s_cbranch_scc1 Lw0_23
    s_sub_u32 s33, s24, 1
    s_and_b32 s33, s33, 1
    s_lshl_b32 s34, s33, 3
    s_mul_i32 s35, s33, 14336
    v_lshlrev_b32 v6, 4, v1
    v_add_u32 v6, s35, v6
    v_and_b32 v24, 7, v1
    v_lshlrev_b32 v13, 4, v24
    v_lshrrev_b32 v24, 1, v21
    v_lshl_add_u32 v13, v24, 8, v13
    v_and_b32 v24, 1, v21
    v_lshl_add_u32 v13, v24, 7, v13
    s_lshr_b32 s35, s25, 1
    s_lshl_b32 s35, s35, 10
    s_and_b32 s36, s25, 1
    s_lshl_b32 s36, s36, 9
    s_add_u32 s35, s35, s36
    s_add_u32 s35, s35, s34
    v_add_u32 v13, s35, v13
    s_branch Lwj_24
Lw0_23:
    v_lshrrev_b32 v24, 1, v21
    v_mul_u32_u24 v6, 384, v24
    v_and_b32 v24, 1, v21
    v_lshl_add_u32 v6, v24, 7, v6
    v_lshl_add_u32 v6, v22, 4, v6
    v_and_b32 v24, 1, v23
    v_lshl_add_u32 v6, v24, 3, v6
    v_and_b32 v24, 7, v1
    v_lshlrev_b32 v13, 4, v24
    v_bfe_u32 v24, v1, 3, 1
    v_lshl_add_u32 v13, v24, 8, v13
    v_lshrrev_b32 v24, 5, v1
    v_lshl_add_u32 v13, v24, 7, v13
    v_bfe_u32 v24, v1, 4, 1
    v_lshl_add_u32 v13, v24, 3, v13
    s_lshr_b32 s33, s25, 2
    s_lshl_b32 s33, s33, 10
    s_bfe_u32 s34, s25, 0x10001
    s_lshl_b32 s34, s34, 9
    s_add_u32 s33, s33, s34
    s_and_b32 s34, s25, 1
    s_lshl_b32 s34, s34, 2
    s_add_u32 s33, s33, s34
    s_add_u32 s33, s33, 8192
    v_add_u32 v13, s33, v13
Lwj_24:
    s_lshl_b32 s33, s25, 2
    s_add_u32 s33, s33, s24
    s_mul_i32 s33, s33, 100352
    s_add_u32 s33, s33, 0
    s_and_b32 s34, s24, 1
    v_lshlrev_b32 v20, 4, v1
    s_add_u32 s35, s34, 0
    s_mul_i32 s35, s35, 14336
    s_add_u32 s35, s35, s33
    buffer_load_dwordx4 a[0:3], v20, s[16:19], s35 offen offset:0 sc1
    buffer_load_dwordx4 a[4:7], v20, s[16:19], s35 offen offset:1024 sc1
    buffer_load_dwordx4 a[8:11], v20, s[16:19], s35 offen offset:2048 sc1
    buffer_load_dwordx4 a[12:15], v20, s[16:19], s35 offen offset:3072 sc1
    s_add_u32 s35, s35, 4096
    buffer_load_dwordx4 a[16:19], v20, s[16:19], s35 offen offset:0 sc1
    buffer_load_dwordx4 a[20:23], v20, s[16:19], s35 offen offset:1024 sc1
    buffer_load_dwordx4 a[24:27], v20, s[16:19], s35 offen offset:2048 sc1
    buffer_load_dwordx4 a[28:31], v20, s[16:19], s35 offen offset:3072 sc1
    s_add_u32 s35, s35, 4096
    buffer_load_dwordx4 a[32:35], v20, s[16:19], s35 offen offset:0 sc1
    buffer_load_dwordx4 a[36:39], v20, s[16:19], s35 offen offset:1024 sc1
    buffer_load_dwordx4 a[40:43], v20, s[16:19], s35 offen offset:2048 sc1
    buffer_load_dwordx4 a[44:47], v20, s[16:19], s35 offen offset:3072 sc1
    s_add_u32 s35, s35, 4096
    buffer_load_dwordx4 a[48:51], v20, s[16:19], s35 offen offset:0 sc1
    buffer_load_dwordx4 a[52:55], v20, s[16:19], s35 offen offset:1024 sc1
    s_add_u32 s35, s34, 1
    s_mul_i32 s35, s35, 14336
    s_add_u32 s35, s35, s33
    s_mul_i32 s36, s24, 14336
    s_add_u32 s36, s36, 25856
    s_add_u32 m0, s36, 0
    s_nop 0
    buffer_load_dwordx4 v20, s[16:19], s35 offen offset:0 sc1 lds
    s_add_u32 m0, s36, 0
    s_nop 0
    buffer_load_dwordx4 v20, s[16:19], s35 offen offset:1024 sc1 lds
    s_add_u32 m0, s36, 0
    s_nop 0
    buffer_load_dwordx4 v20, s[16:19], s35 offen offset:2048 sc1 lds
    s_add_u32 m0, s36, 0
    s_nop 0
    buffer_load_dwordx4 v20, s[16:19], s35 offen offset:3072 sc1 lds
    s_add_u32 s35, s35, 4096
    s_add_u32 m0, s36, 4096
    s_nop 0
    buffer_load_dwordx4 v20, s[16:19], s35 offen offset:0 sc1 lds
    s_add_u32 m0, s36, 4096
    s_nop 0
    buffer_load_dwordx4 v20, s[16:19], s35 offen offset:1024 sc1 lds
    s_add_u32 m0, s36, 4096
    s_nop 0
    buffer_load_dwordx4 v20, s[16:19], s35 offen offset:2048 sc1 lds
    s_add_u32 m0, s36, 4096
    s_nop 0
    buffer_load_dwordx4 v20, s[16:19], s35 offen offset:3072 sc1 lds
    s_add_u32 s35, s35, 4096
    s_add_u32 m0, s36, 8192
    s_nop 0
    buffer_load_dwordx4 v20, s[16:19], s35 offen offset:0 sc1 lds
    s_add_u32 m0, s36, 8192
    s_nop 0
    buffer_load_dwordx4 v20, s[16:19], s35 offen offset:1024 sc1 lds
    s_add_u32 m0, s36, 8192
    s_nop 0
    buffer_load_dwordx4 v20, s[16:19], s35 offen offset:2048 sc1 lds
    s_add_u32 m0, s36, 8192
    s_nop 0
    buffer_load_dwordx4 v20, s[16:19], s35 offen offset:3072 sc1 lds
    s_add_u32 s35, s35, 4096
    s_add_u32 m0, s36, 12288
    s_nop 0
    buffer_load_dwordx4 v20, s[16:19], s35 offen offset:0 sc1 lds
    s_add_u32 m0, s36, 12288
    s_nop 0
    buffer_load_dwordx4 v20, s[16:19], s35 offen offset:1024 sc1 lds
    s_add_u32 s35, s34, 2
    s_mul_i32 s35, s35, 14336
    s_add_u32 s35, s35, s33
    buffer_load_dwordx4 a[56:59], v20, s[16:19], s35 offen offset:0 sc1
    buffer_load_dwordx4 a[60:63], v20, s[16:19], s35 offen offset:1024 sc1
    buffer_load_dwordx4 a[64:67], v20, s[16:19], s35 offen offset:2048 sc1
    buffer_load_dwordx4 a[68:71], v20, s[16:19], s35 offen offset:3072 sc1
    s_add_u32 s35, s35, 4096
    buffer_load_dwordx4 a[72:75], v20, s[16:19], s35 offen offset:0 sc1
    buffer_load_dwordx4 a[76:79], v20, s[16:19], s35 offen offset:1024 sc1
    buffer_load_dwordx4 a[80:83], v20, s[16:19], s35 offen offset:2048 sc1
    buffer_load_dwordx4 a[84:87], v20, s[16:19], s35 offen offset:3072 sc1
    s_add_u32 s35, s35, 4096
    buffer_load_dwordx4 a[88:91], v20, s[16:19], s35 offen offset:0 sc1
    buffer_load_dwordx4 a[92:95], v20, s[16:19], s35 offen offset:1024 sc1
    buffer_load_dwordx4 a[96:99], v20, s[16:19], s35 offen offset:2048 sc1
    buffer_load_dwordx4 a[100:103], v20, s[16:19], s35 offen offset:3072 sc1
    s_add_u32 s35, s35, 4096
    buffer_load_dwordx4 a[104:107], v20, s[16:19], s35 offen offset:0 sc1
    buffer_load_dwordx4 a[108:111], v20, s[16:19], s35 offen offset:1024 sc1
    s_add_u32 s35, s34, 3
    s_mul_i32 s35, s35, 14336
    s_add_u32 s35, s35, s33
    buffer_load_dwordx4 a[112:115], v20, s[16:19], s35 offen offset:0 sc1
    buffer_load_dwordx4 a[116:119], v20, s[16:19], s35 offen offset:1024 sc1
    buffer_load_dwordx4 a[120:123], v20, s[16:19], s35 offen offset:2048 sc1
    buffer_load_dwordx4 a[124:127], v20, s[16:19], s35 offen offset:3072 sc1
    s_add_u32 s35, s35, 4096
    buffer_load_dwordx4 a[128:131], v20, s[16:19], s35 offen offset:0 sc1
    buffer_load_dwordx4 a[132:135], v20, s[16:19], s35 offen offset:1024 sc1
    s_waitcnt vmcnt(16)
    buffer_load_dwordx4 a[136:139], v20, s[16:19], s35 offen offset:2048 sc1
    buffer_load_dwordx4 a[140:143], v20, s[16:19], s35 offen offset:3072 sc1
    s_add_u32 s35, s35, 4096
    buffer_load_dwordx4 a[144:147], v20, s[16:19], s35 offen offset:0 sc1
    buffer_load_dwordx4 a[148:151], v20, s[16:19], s35 offen offset:1024 sc1
    buffer_load_dwordx4 a[152:155], v20, s[16:19], s35 offen offset:2048 sc1
    buffer_load_dwordx4 a[156:159], v20, s[16:19], s35 offen offset:3072 sc1
    s_add_u32 s35, s35, 4096
    buffer_load_dwordx4 a[160:163], v20, s[16:19], s35 offen offset:0 sc1
    buffer_load_dwordx4 a[164:167], v20, s[16:19], s35 offen offset:1024 sc1
    s_add_u32 s35, s34, 4
    s_mul_i32 s35, s35, 14336
    s_add_u32 s35, s35, s33
    buffer_load_dwordx4 a[168:171], v20, s[16:19], s35 offen offset:0 sc1
    buffer_load_dwordx4 a[172:175], v20, s[16:19], s35 offen offset:1024 sc1
    buffer_load_dwordx4 a[176:179], v20, s[16:19], s35 offen offset:2048 sc1
    buffer_load_dwordx4 a[180:183], v20, s[16:19], s35 offen offset:3072 sc1
    s_add_u32 s35, s35, 4096
    buffer_load_dwordx4 a[184:187], v20, s[16:19], s35 offen offset:0 sc1
    buffer_load_dwordx4 a[188:191], v20, s[16:19], s35 offen offset:1024 sc1
    buffer_load_dwordx4 a[192:195], v20, s[16:19], s35 offen offset:2048 sc1
    buffer_load_dwordx4 a[196:199], v20, s[16:19], s35 offen offset:3072 sc1
    s_add_u32 s35, s35, 4096
    buffer_load_dwordx4 a[200:203], v20, s[16:19], s35 offen offset:0 sc1
    buffer_load_dwordx4 a[204:207], v20, s[16:19], s35 offen offset:1024 sc1
    buffer_load_dwordx4 a[208:211], v20, s[16:19], s35 offen offset:2048 sc1
    buffer_load_dwordx4 a[212:215], v20, s[16:19], s35 offen offset:3072 sc1
    s_add_u32 s35, s35, 4096
    buffer_load_dwordx4 a[216:219], v20, s[16:19], s35 offen offset:0 sc1
    buffer_load_dwordx4 a[220:223], v20, s[16:19], s35 offen offset:1024 sc1
    s_add_u32 s35, s34, 5
    s_mul_i32 s35, s35, 14336
    s_add_u32 s35, s35, s33
    buffer_load_dwordx4 a[224:227], v20, s[16:19], s35 offen offset:0 sc1
    buffer_load_dwordx4 a[228:231], v20, s[16:19], s35 offen offset:1024 sc1
    buffer_load_dwordx4 a[232:235], v20, s[16:19], s35 offen offset:2048 sc1
    buffer_load_dwordx4 a[236:239], v20, s[16:19], s35 offen offset:3072 sc1
    s_add_u32 s35, s35, 4096
    buffer_load_dwordx4 a[240:243], v20, s[16:19], s35 offen offset:0 sc1
    buffer_load_dwordx4 a[244:247], v20, s[16:19], s35 offen offset:1024 sc1
    buffer_load_dwordx4 a[248:251], v20, s[16:19], s35 offen offset:2048 sc1
    buffer_load_dwordx4 a[252:255], v20, s[16:19], s35 offen offset:3072 sc1
    s_add_u32 s35, s35, 4096
    buffer_load_dwordx4 v[176:179], v20, s[16:19], s35 offen offset:0 sc1
    buffer_load_dwordx4 v[180:183], v20, s[16:19], s35 offen offset:1024 sc1
    buffer_load_dwordx4 v[184:187], v20, s[16:19], s35 offen offset:2048 sc1
    buffer_load_dwordx4 v[188:191], v20, s[16:19], s35 offen offset:3072 sc1
    s_add_u32 s35, s35, 4096
    buffer_load_dwordx4 v[192:195], v20, s[16:19], s35 offen offset:0 sc1
    buffer_load_dwordx4 v[196:199], v20, s[16:19], s35 offen offset:1024 sc1
    s_add_u32 s35, s34, 6
    s_cmp_eq_u32 s35, 7
    s_cselect_b32 s35, 0, s35
    s_mul_i32 s35, s35, 14336
    s_add_u32 s35, s35, s33
    buffer_load_dwordx4 v[200:203], v20, s[16:19], s35 offen offset:0 sc1
    buffer_load_dwordx4 v[204:207], v20, s[16:19], s35 offen offset:1024 sc1
    buffer_load_dwordx4 v[208:211], v20, s[16:19], s35 offen offset:2048 sc1
    buffer_load_dwordx4 v[212:215], v20, s[16:19], s35 offen offset:3072 sc1
    s_add_u32 s35, s35, 4096
    buffer_load_dwordx4 v[216:219], v20, s[16:19], s35 offen offset:0 sc1
    buffer_load_dwordx4 v[220:223], v20, s[16:19], s35 offen offset:1024 sc1
    buffer_load_dwordx4 v[224:227], v20, s[16:19], s35 offen offset:2048 sc1
    buffer_load_dwordx4 v[228:231], v20, s[16:19], s35 offen offset:3072 sc1
    s_add_u32 s35, s35, 4096
    buffer_load_dwordx4 v[232:235], v20, s[16:19], s35 offen offset:0 sc1
    buffer_load_dwordx4 v[236:239], v20, s[16:19], s35 offen offset:1024 sc1
    buffer_load_dwordx4 v[240:243], v20, s[16:19], s35 offen offset:2048 sc1
    buffer_load_dwordx4 v[244:247], v20, s[16:19], s35 offen offset:3072 sc1
    s_waitcnt vmcnt(16)
    s_add_u32 s35, s35, 4096
    buffer_load_dwordx4 v[248:251], v20, s[16:19], s35 offen offset:0 sc1
    buffer_load_dwordx4 v[252:255], v20, s[16:19], s35 offen offset:1024 sc1
    s_waitcnt vmcnt(0)
    v_min_u32 v20, 30, v1
    v_lshlrev_b32 v20, 2, v20
    s_mov_b32 s34, 15466496
Lxp_25:
    buffer_load_dword v21, v20, s[16:19], s34 offen sc1
    s_waitcnt vmcnt(0)
    v_cmp_eq_u32 vcc, -1, v21
    s_cbranch_vccz Lok_26
    s_sub_u32 s28, s28, 1
    s_cbranch_scc0 Lxp_25
    s_branch Lfail
Lok_26:
    s_getreg_b32 s33, hwreg(HW_REG_XCC_ID, 0, 4)
    s_nop 0
    v_cmp_ne_u32 vcc, s33, v21
    s_nop 4
    s_cmp_eq_u64 vcc, 0
    s_cselect_b32 s27, 0, 1
    v_and_b32 v14, 7, v1
    s_lshl_b32 s33, s25, 3
    v_add_u32 v14, s33, v14
    v_min_u32 v14, 111, v14
    v_lshlrev_b32 v14, 6, v14
    v_min_u32 v15, 27, v1
    s_mul_i32 s33, s25, 28
    v_add_u32 v15, s33, v15
    v_lshlrev_b32 v15, 6, v15
    v_add_u32 v15, 57344, v15
    v_min_u32 v16, 11, v1
    s_mul_i32 s33, s25, 12
    v_add_u32 v16, s33, v16
    v_lshlrev_b32 v16, 6, v16
    v_add_u32 v16, 12288, v16
    s_mov_b32 s50, 13645824
    s_mov_b32 s94, -1
    s_mov_b32 s32, 65011712
    s_mov_b32 s84, 65015808
    s_mov_b32 s85, 65019904
    s_mov_b32 s86, 65024000
    s_cmp_eq_u32 s24, 3
    s_cselect_b32 s33, 1, 3
    v_and_b32 v1, s33, v1
    v_lshlrev_b32 v1, 2, v1
    s_lshl_b32 s33, s24, 7
    v_add_u32 v1, s33, v1
    s_mov_b32 s93, 15468544
    s_lshr_b32 s33, s25, 2
    s_lshl_b32 s33, s33, 7
    s_and_b32 s34, s25, 3
    s_lshl_b32 s34, s34, 2
    s_add_u32 s33, s33, s34
    s_add_u32 s95, s33, 15467520
    v_mov_b32 v42, 0
    s_cmp_eq_u32 s24, 0
    s_cbranch_scc1 Lsc0
    s_cmp_eq_u32 s24, 3
    s_cbranch_scc1 Lsc3
    buffer_load_dwordx4 v[120:123], v6, s[16:19], s32 offen offset:0 sc1
    buffer_load_dwordx4 v[124:127], v6, s[16:19], s32 offen offset:1024 sc1
    buffer_load_dwordx4 v[128:131], v6, s[16:19], s32 offen offset:2048 sc1
    buffer_load_dwordx4 v[132:135], v6, s[16:19], s32 offen offset:3072 sc1
    buffer_load_dwordx4 v[136:139], v6, s[16:19], s84 offen offset:0 sc1
    buffer_load_dwordx4 v[140:143], v6, s[16:19], s84 offen offset:1024 sc1
    buffer_load_dwordx4 v[144:147], v6, s[16:19], s84 offen offset:2048 sc1
    buffer_load_dwordx4 v[148:151], v6, s[16:19], s84 offen offset:3072 sc1
    buffer_load_dwordx4 v[152:155], v6, s[16:19], s85 offen offset:0 sc1
    buffer_load_dwordx4 v[156:159], v6, s[16:19], s85 offen offset:1024 sc1
    buffer_load_dwordx4 v[160:163], v6, s[16:19], s85 offen offset:2048 sc1
    buffer_load_dwordx4 v[164:167], v6, s[16:19], s85 offen offset:3072 sc1
    buffer_load_dwordx4 v[168:171], v6, s[16:19], s86 offen offset:0 sc1
    buffer_load_dwordx4 v[172:175], v6, s[16:19], s86 offen offset:1024 sc1
Lsc_27:
    v_mov_b64 v[64:65], 0
    v_mov_b64 v[66:67], 0
    v_mov_b64 v[68:69], 0
    v_mov_b64 v[70:71], 0
    v_mov_b64 v[72:73], 0
    v_mov_b64 v[74:75], 0
    v_mov_b64 v[76:77], 0
    v_mov_b64 v[78:79], 0
    v_mov_b64 v[80:81], 0
    v_mov_b64 v[82:83], 0
    v_mov_b64 v[84:85], 0
    v_mov_b64 v[86:87], 0
    v_mov_b64 v[88:89], 0
    v_mov_b64 v[90:91], 0
    ds_read_b128 v[48:51], v10 offset:0
    ds_read_b128 v[52:55], v10 offset:1024
    ds_read_b128 v[56:59], v10 offset:2048
    ds_read_b128 v[60:63], v10 offset:3072
    s_waitcnt vmcnt(0)
    buffer_load_dword v36, v1, s[16:19], s93 offen sc1
    s_nop 9
    buffer_load_dword v37, v1, s[16:19], s93 offen sc1
    s_nop 9
    buffer_load_dword v38, v1, s[16:19], s93 offen sc1
    s_nop 9
Lhu_28:
    buffer_load_dword v39, v1, s[16:19], s93 offen sc1
    s_waitcnt vmcnt(3)
    v_cmp_gt_i32 vcc, s94, v36
    s_cbranch_vccz Lhk_29
    buffer_load_dword v36, v1, s[16:19], s93 offen sc1
    s_waitcnt vmcnt(3)
    v_cmp_gt_i32 vcc, s94, v37
    s_cbranch_vccz Lhk_29
    buffer_load_dword v37, v1, s[16:19], s93 offen sc1
    s_waitcnt vmcnt(3)
    v_cmp_gt_i32 vcc, s94, v38
    s_cbranch_vccz Lhk_29
    buffer_load_dword v38, v1, s[16:19], s93 offen sc1
    s_waitcnt vmcnt(3)
    v_cmp_gt_i32 vcc, s94, v39
    s_cbranch_vccz Lhk_29
    s_sub_u32 s28, s28, 1
    s_cbranch_scc0 Lhu_28
    s_branch Lfail
Lhk_29:
Lpm_30:
    buffer_load_dwordx4 v[20:23], v3, s[16:19], s29 offen sc1
    buffer_load_dwordx4 v[24:27], v3, s[16:19], s30 offen sc1
    s_waitcnt vmcnt(0)
    ds_write_b128 v4, v[20:23] offset:0
    ds_write_b128 v4, v[24:27] offset:6144
    v_max3_u32 v28, v20, v21, v22
    v_max_u32 v28, v28, v23
    v_max3_u32 v29, v24, v25, v26
    v_max_u32 v29, v29, v27
    v_max_u32 v28, v28, v29
    v_cmp_eq_u32 vcc, -1, v28
    s_cbranch_vccz Lok_31
    s_sub_u32 s28, s28, 1
    s_cbranch_scc0 Lpm_30
    s_branch Lfail
Lok_31:
    s_waitcnt lgkmcnt(0)
    s_barrier
    ds_read_b64_tr_b16 v[92:93], v5 offset:0
    ds_read_b64_tr_b16 v[94:95], v5 offset:128
    ds_read_b64_tr_b16 v[96:97], v5 offset:1536
    ds_read_b64_tr_b16 v[98:99], v5 offset:1664
    ds_read_b64_tr_b16 v[100:101], v5 offset:3072
    ds_read_b64_tr_b16 v[102:103], v5 offset:3200
    ds_read_b64_tr_b16 v[104:105], v5 offset:4608
    ds_read_b64_tr_b16 v[106:107], v5 offset:4736
    ds_read_b64_tr_b16 v[108:109], v5 offset:6144
    ds_read_b64_tr_b16 v[110:111], v5 offset:6272
    ds_read_b64_tr_b16 v[112:113], v5 offset:7680
    ds_read_b64_tr_b16 v[114:115], v5 offset:7808
    ds_read_b64_tr_b16 v[116:117], v5 offset:9216
    ds_read_b64_tr_b16 v[118:119], v5 offset:9344
    s_waitcnt lgkmcnt(12)
    v_smfmac_f32_16x16x64_bf16 v[64:67], v[92:95], a[0:7], v2
    s_waitcnt lgkmcnt(10)
    v_smfmac_f32_16x16x64_bf16 v[64:67], v[96:99], a[8:15], v2
    s_waitcnt lgkmcnt(8)
    v_smfmac_f32_16x16x64_bf16 v[64:67], v[100:103], a[16:23], v2
    v_smfmac_f32_16x16x64_bf16 v[68:71], v[92:95], v[48:55], v2
    ds_read_b128 v[48:51], v10 offset:4096
    s_waitcnt lgkmcnt(7)
    v_smfmac_f32_16x16x64_bf16 v[64:67], v[104:107], a[24:31], v2
    ds_read_b128 v[52:55], v10 offset:5120
    s_waitcnt lgkmcnt(6)
    v_smfmac_f32_16x16x64_bf16 v[64:67], v[108:111], a[32:39], v2
    s_waitcnt lgkmcnt(4)
    v_smfmac_f32_16x16x64_bf16 v[64:67], v[112:115], a[40:47], v2
    v_smfmac_f32_16x16x64_bf16 v[68:71], v[96:99], v[56:63], v2
    ds_read_b128 v[56:59], v10 offset:6144
    s_waitcnt lgkmcnt(3)
    v_smfmac_f32_16x16x64_bf16 v[64:67], v[116:119], a[48:55], v2
    ds_read_b128 v[60:63], v10 offset:7168
    v_smfmac_f32_16x16x64_bf16 v[72:75], v[92:95], a[56:63], v2
    v_smfmac_f32_16x16x64_bf16 v[72:75], v[96:99], a[64:71], v2
    s_waitcnt lgkmcnt(2)
    v_smfmac_f32_16x16x64_bf16 v[68:71], v[100:103], v[48:55], v2
    ds_read_b128 v[48:51], v10 offset:8192
    v_smfmac_f32_16x16x64_bf16 v[72:75], v[100:103], a[72:79], v2
    ds_read_b128 v[52:55], v10 offset:9216
    v_smfmac_f32_16x16x64_bf16 v[72:75], v[104:107], a[80:87], v2
    v_cvt_pk_bf16_f32 v20, v64, v65
    v_smfmac_f32_16x16x64_bf16 v[72:75], v[108:111], a[88:95], v2
    s_waitcnt lgkmcnt(2)
    v_smfmac_f32_16x16x64_bf16 v[68:71], v[104:107], v[56:63], v2
    ds_read_b128 v[56:59], v10 offset:10240
    v_smfmac_f32_16x16x64_bf16 v[72:75], v[112:115], a[96:103], v2
    ds_read_b128 v[60:63], v10 offset:11264
    v_smfmac_f32_16x16x64_bf16 v[72:75], v[116:119], a[104:111], v2
    v_cvt_pk_bf16_f32 v21, v66, v67
    v_smfmac_f32_16x16x64_bf16 v[76:79], v[92:95], a[112:119], v2
    s_waitcnt lgkmcnt(2)
    v_smfmac_f32_16x16x64_bf16 v[68:71], v[108:111], v[48:55], v2
    ds_read_b128 v[48:51], v10 offset:12288
    v_smfmac_f32_16x16x64_bf16 v[76:79], v[96:99], a[120:127], v2
    ds_read_b128 v[52:55], v10 offset:13312
    v_smfmac_f32_16x16x64_bf16 v[76:79], v[100:103], a[128:135], v2
    ds_write_b64 v7, v[20:21] offset:0
    v_smfmac_f32_16x16x64_bf16 v[76:79], v[104:107], a[136:143], v2
    s_waitcnt lgkmcnt(3)
    v_smfmac_f32_16x16x64_bf16 v[68:71], v[112:115], v[56:63], v2
    v_cvt_pk_bf16_f32 v24, v72, v73
    v_smfmac_f32_16x16x64_bf16 v[76:79], v[108:111], a[144:151], v2
    v_cvt_pk_bf16_f32 v25, v74, v75
    v_smfmac_f32_16x16x64_bf16 v[76:79], v[112:115], a[152:159], v2
    ds_write_b64 v7, v[24:25] offset:256
    v_smfmac_f32_16x16x64_bf16 v[76:79], v[116:119], a[160:167], v2
    s_waitcnt lgkmcnt(2)
    v_smfmac_f32_16x16x64_bf16 v[68:71], v[116:119], v[48:55], v2
    v_smfmac_f32_16x16x64_bf16 v[80:83], v[92:95], a[168:175], v2
    v_smfmac_f32_16x16x64_bf16 v[80:83], v[96:99], a[176:183], v2
    v_smfmac_f32_16x16x64_bf16 v[80:83], v[100:103], a[184:191], v2
    s_nop 2
    v_cvt_pk_bf16_f32 v26, v76, v77
    v_smfmac_f32_16x16x64_bf16 v[80:83], v[104:107], a[192:199], v2
    v_cvt_pk_bf16_f32 v27, v78, v79
    v_smfmac_f32_16x16x64_bf16 v[80:83], v[108:111], a[200:207], v2
    ds_write_b64 v7, v[26:27] offset:384
    v_smfmac_f32_16x16x64_bf16 v[80:83], v[112:115], a[208:215], v2
    v_cvt_pk_bf16_f32 v22, v68, v69
    v_smfmac_f32_16x16x64_bf16 v[80:83], v[116:119], a[216:223], v2
    v_cvt_pk_bf16_f32 v23, v70, v71
    v_smfmac_f32_16x16x64_bf16 v[84:87], v[92:95], a[224:231], v2
    ds_write_b64 v7, v[22:23] offset:128
    v_smfmac_f32_16x16x64_bf16 v[84:87], v[96:99], a[232:239], v2
    v_smfmac_f32_16x16x64_bf16 v[84:87], v[100:103], a[240:247], v2
    v_smfmac_f32_16x16x64_bf16 v[84:87], v[104:107], a[248:255], v2
    s_nop 1
    v_cvt_pk_bf16_f32 v28, v80, v81
    v_smfmac_f32_16x16x64_bf16 v[84:87], v[108:111], v[176:183], v2
    s_waitcnt lgkmcnt(0)
    s_barrier
    v_smfmac_f32_16x16x64_bf16 v[84:87], v[112:115], v[184:191], v2
    v_cvt_pk_bf16_f32 v29, v82, v83
    ds_read_b64_tr_b16 v[48:49], v9 offset:0
    v_smfmac_f32_16x16x64_bf16 v[84:87], v[116:119], v[192:199], v2
    ds_write_b64 v7, v[28:29] offset:512
    ds_read_b64_tr_b16 v[50:51], v9 offset:32
    v_smfmac_f32_16x16x64_bf16 v[88:91], v[92:95], v[200:207], v2
    ds_read_b64_tr_b16 v[52:53], v9 offset:256
    ds_read_b64_tr_b16 v[54:55], v9 offset:288
    v_smfmac_f32_16x16x64_bf16 v[88:91], v[96:99], v[208:215], v2
    ds_read_b64_tr_b16 v[56:57], v9 offset:1024
    ds_read_b64_tr_b16 v[58:59], v9 offset:1056
    v_smfmac_f32_16x16x64_bf16 v[88:91], v[100:103], v[216:223], v2
    ds_read_b64_tr_b16 v[60:61], v9 offset:1280
    ds_read_b64_tr_b16 v[62:63], v9 offset:1312
    v_smfmac_f32_16x16x64_bf16 v[88:91], v[104:107], v[224:231], v2
    v_cvt_pk_bf16_f32 v30, v84, v85
    ds_read_b64_tr_b16 v[64:65], v9 offset:1792
    v_smfmac_f32_16x16x64_bf16 v[88:91], v[108:111], v[232:239], v2
    v_cvt_pk_bf16_f32 v31, v86, v87
    v_smfmac_f32_16x16x64_bf16 v[88:91], v[112:115], v[240:247], v2
    ds_write_b64 v7, v[30:31] offset:640
    v_smfmac_f32_16x16x64_bf16 v[88:91], v[116:119], v[248:255], v2
    ds_read_b64_tr_b16 v[66:67], v9 offset:1824
    s_waitcnt lgkmcnt(9)
    v_mfma_f32_16x16x32_bf16 v[44:47], v[120:123], v[48:51], 0
    ds_read_b64_tr_b16 v[68:69], v9 offset:2048
    ds_read_b64_tr_b16 v[70:71], v9 offset:2080
    s_waitcnt lgkmcnt(9)
    v_mfma_f32_16x16x32_bf16 v[44:47], v[124:127], v[52:55], v[44:47]
    ds_read_b64_tr_b16 v[72:73], v9 offset:2816
    ds_read_b64_tr_b16 v[74:75], v9 offset:2848
    s_waitcnt lgkmcnt(9)
    v_mfma_f32_16x16x32_bf16 v[44:47], v[136:139], v[56:59], v[44:47]
    ds_read_b64_tr_b16 v[76:77], v9 offset:3072
    ds_read_b64_tr_b16 v[78:79], v9 offset:3104
    v_cvt_pk_bf16_f32 v32, v88, v89
    v_cvt_pk_bf16_f32 v33, v90, v91
    s_waitcnt lgkmcnt(9)
    v_mfma_f32_16x16x32_bf16 v[44:47], v[140:143], v[60:63], v[44:47]
    s_waitcnt lgkmcnt(7)
    s_barrier
    ds_write_b64 v8, v[32:33]
    s_waitcnt lgkmcnt(7)
    v_mfma_f32_16x16x32_bf16 v[44:47], v[148:151], v[64:67], v[44:47]
    ds_read_b64_tr_b16 v[92:93], v9 offset:512
    ds_read_b64_tr_b16 v[94:95], v9 offset:544
    s_waitcnt lgkmcnt(7)
    v_mfma_f32_16x16x32_bf16 v[44:47], v[152:155], v[68:71], v[44:47]
    ds_read_b64_tr_b16 v[96:97], v9 offset:1536
    ds_read_b64_tr_b16 v[98:99], v9 offset:1568
    s_waitcnt lgkmcnt(7)
    v_mfma_f32_16x16x32_bf16 v[44:47], v[164:167], v[72:75], v[44:47]
    ds_read_b64_tr_b16 v[100:101], v9 offset:2304
    ds_read_b64_tr_b16 v[102:103], v9 offset:2336
    s_waitcnt lgkmcnt(7)
    v_mfma_f32_16x16x32_bf16 v[44:47], v[168:171], v[76:79], v[44:47]
    ds_read_b64_tr_b16 v[104:105], v9 offset:3328
    ds_read_b64_tr_b16 v[106:107], v9 offset:3360
    s_waitcnt lgkmcnt(8)
    s_barrier
    ds_read_b64_tr_b16 v[108:109], v9 offset:768
    ds_read_b64_tr_b16 v[110:111], v9 offset:800
    ds_read_b64_tr_b16 v[112:113], v9 offset:2560
    ds_read_b64_tr_b16 v[114:115], v9 offset:2592
    s_waitcnt lgkmcnt(10)
    v_mfma_f32_16x16x32_bf16 v[44:47], v[128:131], v[92:95], v[44:47]
    s_waitcnt lgkmcnt(8)
    v_mfma_f32_16x16x32_bf16 v[44:47], v[144:147], v[96:99], v[44:47]
    s_waitcnt lgkmcnt(6)
    v_mfma_f32_16x16x32_bf16 v[44:47], v[156:159], v[100:103], v[44:47]
    s_waitcnt lgkmcnt(4)
    v_mfma_f32_16x16x32_bf16 v[44:47], v[172:175], v[104:107], v[44:47]
    s_waitcnt lgkmcnt(2)
    v_mfma_f32_16x16x32_bf16 v[44:47], v[132:135], v[108:111], v[44:47]
    s_waitcnt lgkmcnt(0)
    v_mfma_f32_16x16x32_bf16 v[44:47], v[160:163], v[112:115], v[44:47]
    s_nop 7
    v_add_f32_dpp v44, v44, v44 row_ror:8 row_mask:0xf bank_mask:0xf
    v_add_f32_dpp v45, v45, v45 row_ror:8 row_mask:0xf bank_mask:0xf
    v_add_f32_dpp v46, v46, v46 row_ror:8 row_mask:0xf bank_mask:0xf
    v_add_f32_dpp v47, v47, v47 row_ror:8 row_mask:0xf bank_mask:0xf
    v_exp_f32 v24, v44
    v_exp_f32 v25, v45
    v_exp_f32 v26, v46
    v_exp_f32 v27, v47
    v_max3_f32 v22, abs(v44), abs(v45), abs(v46)
    v_max_f32 v22, v22, abs(v47)
    v_add_f32 v28, v24, v25
    v_add_f32 v23, v26, v27
    v_cmp_nge_f32 vcc, s89, v22
    v_add_f32 v23, v23, v28
    s_nop 0
    v_cndmask_b32 v28, v23, v18, vcc
    v_cndmask_b32 v23, v23, v18, vcc
    s_nop 1
    v_permlane16_swap_b32 v23, v28
    v_add_f32 v28, v23, v28
    v_mov_b32 v23, v28
    s_nop 1
    v_permlane32_swap_b32 v23, v28
    v_add_f32 v23, v23, v28
    s_mov_b64 exec, 0xff
    ds_write_b32 v19, v23
    s_mov_b64 exec, -1
    s_waitcnt lgkmcnt(0)
    s_barrier
    ds_read_b128 v[32:35], v17
    s_waitcnt lgkmcnt(0)
    v_add_f32 v32, v32, v33
    v_add_f32 v32, v32, v34
    v_rcp_f32 v30, v32
    v_cmp_nlt_f32 vcc, v32, v18
    v_mul_f32 v24, v24, v30
    v_mul_f32 v25, v25, v30
    v_mul_f32 v26, v26, v30
    v_mul_f32 v27, v27, v30
    s_cbranch_vccnz Lexact_32
Lexb_33:
    s_cmp_eq_u32 s27, 0
    v_cvt_pk_bf16_f32 v20, v24, v25
    v_cvt_pk_bf16_f32 v21, v26, v27
    s_mov_b64 exec, s[40:41]
    s_cbranch_scc0 Lslow_34
    buffer_store_dwordx2 v[20:21], v13, s[16:19], s31 offen
Lback_35:
    s_mov_b64 exec, -1
    s_mov_b32 s94, s26
    s_add_u32 s26, s26, 1
    s_add_u32 s29, s29, 7168
    s_add_u32 s30, s30, 7168
    s_add_u32 s31, s31, 12288
    s_add_u32 s32, s32, 28672
    s_add_u32 s84, s84, 28672
    s_add_u32 s85, s85, 28672
    s_add_u32 s86, s86, 28672
    s_add_u32 s50, s50, 7168
    s_sleep 7
    buffer_load_dwordx4 v[120:123], v6, s[16:19], s32 offen offset:0 sc1
    buffer_load_dwordx4 v[124:127], v6, s[16:19], s32 offen offset:1024 sc1
    buffer_load_dwordx4 v[128:131], v6, s[16:19], s32 offen offset:2048 sc1
    buffer_load_dwordx4 v[132:135], v6, s[16:19], s32 offen offset:3072 sc1
    buffer_load_dwordx4 v[136:139], v6, s[16:19], s84 offen offset:0 sc1
    buffer_load_dwordx4 v[140:143], v6, s[16:19], s84 offen offset:1024 sc1
    buffer_load_dwordx4 v[144:147], v6, s[16:19], s84 offen offset:2048 sc1
    buffer_load_dwordx4 v[148:151], v6, s[16:19], s84 offen offset:3072 sc1
    buffer_load_dwordx4 v[152:155], v6, s[16:19], s85 offen offset:0 sc1
    buffer_load_dwordx4 v[156:159], v6, s[16:19], s85 offen offset:1024 sc1
    buffer_load_dwordx4 v[160:163], v6, s[16:19], s85 offen offset:2048 sc1
    buffer_load_dwordx4 v[164:167], v6, s[16:19], s85 offen offset:3072 sc1
    buffer_load_dwordx4 v[168:171], v6, s[16:19], s86 offen offset:0 sc1
    buffer_load_dwordx4 v[172:175], v6, s[16:19], s86 offen offset:1024 sc1
    s_cmp_lt_u32 s26, 63
    s_cbranch_scc1 Lsc_27
    s_branch Lscend
Lsc0:
Lsc_36:
    v_mov_b64 v[64:65], 0
    v_mov_b64 v[66:67], 0
    v_mov_b64 v[68:69], 0
    v_mov_b64 v[70:71], 0
    v_mov_b64 v[72:73], 0
    v_mov_b64 v[74:75], 0
    v_mov_b64 v[76:77], 0
    v_mov_b64 v[78:79], 0
    v_mov_b64 v[80:81], 0
    v_mov_b64 v[82:83], 0
    v_mov_b64 v[84:85], 0
    v_mov_b64 v[86:87], 0
    v_mov_b64 v[88:89], 0
    v_mov_b64 v[90:91], 0
    ds_read_b128 v[48:51], v10 offset:0
    ds_read_b128 v[52:55], v10 offset:1024
    ds_read_b128 v[56:59], v10 offset:2048
    ds_read_b128 v[60:63], v10 offset:3072
    s_sleep 8
    s_waitcnt vmcnt(0)
    buffer_load_dword v36, v1, s[16:19], s93 offen sc1
    s_nop 9
    buffer_load_dword v37, v1, s[16:19], s93 offen sc1
    s_nop 9
    buffer_load_dword v38, v1, s[16:19], s93 offen sc1
    s_nop 9
Lhu_37:
    buffer_load_dword v39, v1, s[16:19], s93 offen sc1
    s_waitcnt vmcnt(3)
    v_cmp_gt_i32 vcc, s94, v36
    s_cbranch_vccz Lhk_38
    buffer_load_dword v36, v1, s[16:19], s93 offen sc1
    s_waitcnt vmcnt(3)
    v_cmp_gt_i32 vcc, s94, v37
    s_cbranch_vccz Lhk_38
    buffer_load_dword v37, v1, s[16:19], s93 offen sc1
    s_waitcnt vmcnt(3)
    v_cmp_gt_i32 vcc, s94, v38
    s_cbranch_vccz Lhk_38
    buffer_load_dword v38, v1, s[16:19], s93 offen sc1
    s_waitcnt vmcnt(3)
    v_cmp_gt_i32 vcc, s94, v39
    s_cbranch_vccz Lhk_38
    s_sub_u32 s28, s28, 1
    s_cbranch_scc0 Lhu_37
    s_branch Lfail
Lhk_38:
Lpm_39:
    buffer_load_dwordx4 v[20:23], v3, s[16:19], s29 offen sc1
    buffer_load_dwordx4 v[24:27], v3, s[16:19], s30 offen sc1
    s_waitcnt vmcnt(0)
    ds_write_b128 v4, v[20:23] offset:0
    ds_write_b128 v4, v[24:27] offset:6144
    v_max3_u32 v28, v20, v21, v22
    v_max_u32 v28, v28, v23
    v_max3_u32 v29, v24, v25, v26
    v_max_u32 v29, v29, v27
    v_max_u32 v28, v28, v29
    v_cmp_eq_u32 vcc, -1, v28
    s_cbranch_vccz Lok_40
    s_sub_u32 s28, s28, 1
    s_cbranch_scc0 Lpm_39
    s_branch Lfail
Lok_40:
    s_waitcnt lgkmcnt(0)
    s_barrier
    ds_read_b64_tr_b16 v[92:93], v5 offset:0
    ds_read_b64_tr_b16 v[94:95], v5 offset:128
    ds_read_b64_tr_b16 v[96:97], v5 offset:1536
    ds_read_b64_tr_b16 v[98:99], v5 offset:1664
    ds_read_b64_tr_b16 v[100:101], v5 offset:3072
    ds_read_b64_tr_b16 v[102:103], v5 offset:3200
    ds_read_b64_tr_b16 v[104:105], v5 offset:4608
    ds_read_b64_tr_b16 v[106:107], v5 offset:4736
    ds_read_b64_tr_b16 v[108:109], v5 offset:6144
    ds_read_b64_tr_b16 v[110:111], v5 offset:6272
    ds_read_b64_tr_b16 v[112:113], v5 offset:7680
    ds_read_b64_tr_b16 v[114:115], v5 offset:7808
    ds_read_b64_tr_b16 v[116:117], v5 offset:9216
    ds_read_b64_tr_b16 v[118:119], v5 offset:9344
    v_mov_b64 v[44:45], 0
    v_mov_b64 v[46:47], 0
    s_waitcnt lgkmcnt(12)
    v_smfmac_f32_16x16x64_bf16 v[64:67], v[92:95], a[0:7], v2
    s_waitcnt lgkmcnt(10)
    v_smfmac_f32_16x16x64_bf16 v[64:67], v[96:99], a[8:15], v2
    s_waitcnt lgkmcnt(8)
    v_smfmac_f32_16x16x64_bf16 v[64:67], v[100:103], a[16:23], v2
    v_smfmac_f32_16x16x64_bf16 v[68:71], v[92:95], v[48:55], v2
    ds_read_b128 v[48:51], v10 offset:4096
    s_waitcnt lgkmcnt(7)
    v_smfmac_f32_16x16x64_bf16 v[64:67], v[104:107], a[24:31], v2
    ds_read_b128 v[52:55], v10 offset:5120
    s_waitcnt lgkmcnt(6)
    v_smfmac_f32_16x16x64_bf16 v[64:67], v[108:111], a[32:39], v2
    s_waitcnt lgkmcnt(4)
    v_smfmac_f32_16x16x64_bf16 v[64:67], v[112:115], a[40:47], v2
    v_smfmac_f32_16x16x64_bf16 v[68:71], v[96:99], v[56:63], v2
    ds_read_b128 v[56:59], v10 offset:6144
    s_waitcnt lgkmcnt(3)
    v_smfmac_f32_16x16x64_bf16 v[64:67], v[116:119], a[48:55], v2
    ds_read_b128 v[60:63], v10 offset:7168
    v_smfmac_f32_16x16x64_bf16 v[72:75], v[92:95], a[56:63], v2
    v_smfmac_f32_16x16x64_bf16 v[72:75], v[96:99], a[64:71], v2
    s_waitcnt lgkmcnt(2)
    v_smfmac_f32_16x16x64_bf16 v[68:71], v[100:103], v[48:55], v2
    ds_read_b128 v[48:51], v10 offset:8192
    v_smfmac_f32_16x16x64_bf16 v[72:75], v[100:103], a[72:79], v2
    ds_read_b128 v[52:55], v10 offset:9216
    v_smfmac_f32_16x16x64_bf16 v[72:75], v[104:107], a[80:87], v2
    v_cvt_pk_bf16_f32 v20, v64, v65
    v_smfmac_f32_16x16x64_bf16 v[72:75], v[108:111], a[88:95], v2
    s_waitcnt lgkmcnt(2)
    v_smfmac_f32_16x16x64_bf16 v[68:71], v[104:107], v[56:63], v2
    ds_read_b128 v[56:59], v10 offset:10240
    v_smfmac_f32_16x16x64_bf16 v[72:75], v[112:115], a[96:103], v2
    ds_read_b128 v[60:63], v10 offset:11264
    v_smfmac_f32_16x16x64_bf16 v[72:75], v[116:119], a[104:111], v2
    v_cvt_pk_bf16_f32 v21, v66, v67
    v_smfmac_f32_16x16x64_bf16 v[76:79], v[92:95], a[112:119], v2
    s_waitcnt lgkmcnt(2)
    v_smfmac_f32_16x16x64_bf16 v[68:71], v[108:111], v[48:55], v2
    ds_read_b128 v[48:51], v10 offset:12288
    v_smfmac_f32_16x16x64_bf16 v[76:79], v[96:99], a[120:127], v2
    ds_read_b128 v[52:55], v10 offset:13312
    v_smfmac_f32_16x16x64_bf16 v[76:79], v[100:103], a[128:135], v2
    ds_write_b64 v7, v[20:21] offset:0
    v_smfmac_f32_16x16x64_bf16 v[76:79], v[104:107], a[136:143], v2
    s_waitcnt lgkmcnt(3)
    v_smfmac_f32_16x16x64_bf16 v[68:71], v[112:115], v[56:63], v2
    v_cvt_pk_bf16_f32 v24, v72, v73
    v_smfmac_f32_16x16x64_bf16 v[76:79], v[108:111], a[144:151], v2
    v_cvt_pk_bf16_f32 v25, v74, v75
    v_smfmac_f32_16x16x64_bf16 v[76:79], v[112:115], a[152:159], v2
    ds_write_b64 v7, v[24:25] offset:256
    v_smfmac_f32_16x16x64_bf16 v[76:79], v[116:119], a[160:167], v2
    s_waitcnt lgkmcnt(2)
    v_smfmac_f32_16x16x64_bf16 v[68:71], v[116:119], v[48:55], v2
    v_smfmac_f32_16x16x64_bf16 v[80:83], v[92:95], a[168:175], v2
    v_smfmac_f32_16x16x64_bf16 v[80:83], v[96:99], a[176:183], v2
    v_smfmac_f32_16x16x64_bf16 v[80:83], v[100:103], a[184:191], v2
    s_nop 2
    v_cvt_pk_bf16_f32 v26, v76, v77
    v_smfmac_f32_16x16x64_bf16 v[80:83], v[104:107], a[192:199], v2
    v_cvt_pk_bf16_f32 v27, v78, v79
    v_smfmac_f32_16x16x64_bf16 v[80:83], v[108:111], a[200:207], v2
    ds_write_b64 v7, v[26:27] offset:384
    v_smfmac_f32_16x16x64_bf16 v[80:83], v[112:115], a[208:215], v2
    v_cvt_pk_bf16_f32 v22, v68, v69
    v_smfmac_f32_16x16x64_bf16 v[80:83], v[116:119], a[216:223], v2
    v_cvt_pk_bf16_f32 v23, v70, v71
    v_smfmac_f32_16x16x64_bf16 v[84:87], v[92:95], a[224:231], v2
    ds_write_b64 v7, v[22:23] offset:128
    v_smfmac_f32_16x16x64_bf16 v[84:87], v[96:99], a[232:239], v2
    v_smfmac_f32_16x16x64_bf16 v[84:87], v[100:103], a[240:247], v2
    v_smfmac_f32_16x16x64_bf16 v[84:87], v[104:107], a[248:255], v2
    s_nop 1
    v_cvt_pk_bf16_f32 v28, v80, v81
    v_smfmac_f32_16x16x64_bf16 v[84:87], v[108:111], v[176:183], v2
    s_waitcnt lgkmcnt(0)
    s_barrier
    v_smfmac_f32_16x16x64_bf16 v[84:87], v[112:115], v[184:191], v2
    v_cvt_pk_bf16_f32 v29, v82, v83
    ds_read_b64_tr_b16 v[120:121], v9 offset:0
    v_smfmac_f32_16x16x64_bf16 v[84:87], v[116:119], v[192:199], v2
    ds_write_b64 v7, v[28:29] offset:512
    ds_read_b64_tr_b16 v[122:123], v9 offset:32
    v_smfmac_f32_16x16x64_bf16 v[88:91], v[92:95], v[200:207], v2
    ds_read_b64_tr_b16 v[124:125], v9 offset:256
    ds_read_b64_tr_b16 v[126:127], v9 offset:288
    v_smfmac_f32_16x16x64_bf16 v[88:91], v[96:99], v[208:215], v2
    ds_read_b64_tr_b16 v[136:137], v9 offset:1024
    ds_read_b64_tr_b16 v[138:139], v9 offset:1056
    v_smfmac_f32_16x16x64_bf16 v[88:91], v[100:103], v[216:223], v2
    ds_read_b64_tr_b16 v[140:141], v9 offset:1280
    v_smfmac_f32_16x16x64_bf16 v[88:91], v[104:107], v[224:231], v2
    v_cvt_pk_bf16_f32 v30, v84, v85
    v_smfmac_f32_16x16x64_bf16 v[88:91], v[108:111], v[232:239], v2
    v_cvt_pk_bf16_f32 v31, v86, v87
    v_smfmac_f32_16x16x64_bf16 v[88:91], v[112:115], v[240:247], v2
    ds_write_b64 v7, v[30:31] offset:640
    v_smfmac_f32_16x16x64_bf16 v[88:91], v[116:119], v[248:255], v2
    ds_read_b64_tr_b16 v[142:143], v9 offset:1312
    s_waitcnt lgkmcnt(5)
    v_smfmac_f32_16x16x64_bf16 v[44:47], v[92:95], v[120:127], v2
    s_waitcnt lgkmcnt(0)
    v_smfmac_f32_16x16x64_bf16 v[44:47], v[100:103], v[136:143], v2
    s_nop 2
    v_cvt_pk_bf16_f32 v32, v88, v89
    v_cvt_pk_bf16_f32 v33, v90, v91
    s_barrier
    ds_write_b64 v8, v[32:33]
    ds_read_b64_tr_b16 v[144:145], v9 offset:1536
    ds_read_b64_tr_b16 v[146:147], v9 offset:1568
    ds_read_b64_tr_b16 v[148:149], v9 offset:1792
    ds_read_b64_tr_b16 v[150:151], v9 offset:1824
    ds_read_b64_tr_b16 v[152:153], v9 offset:2048
    ds_read_b64_tr_b16 v[154:155], v9 offset:2080
    ds_read_b64_tr_b16 v[156:157], v9 offset:2304
    ds_read_b64_tr_b16 v[158:159], v9 offset:2336
    ds_read_b64_tr_b16 v[168:169], v9 offset:3072
    ds_read_b64_tr_b16 v[170:171], v9 offset:3104
    ds_read_b64_tr_b16 v[172:173], v9 offset:3328
    ds_read_b64_tr_b16 v[174:175], v9 offset:3360
    s_waitcnt lgkmcnt(8)
    v_smfmac_f32_16x16x64_bf16 v[44:47], v[104:107], v[144:151], v2
    ds_read_b64_tr_b16 v[128:129], v9 offset:512
    ds_read_b64_tr_b16 v[130:131], v9 offset:544
    ds_read_b64_tr_b16 v[164:165], v9 offset:2816
    ds_read_b64_tr_b16 v[166:167], v9 offset:2848
    s_barrier
    ds_read_b64_tr_b16 v[132:133], v9 offset:768
    ds_read_b64_tr_b16 v[134:135], v9 offset:800
    ds_read_b64_tr_b16 v[160:161], v9 offset:2560
    ds_read_b64_tr_b16 v[162:163], v9 offset:2592
    s_waitcnt lgkmcnt(12)
    v_smfmac_f32_16x16x64_bf16 v[44:47], v[108:111], v[152:159], v2
    s_waitcnt lgkmcnt(8)
    v_smfmac_f32_16x16x64_bf16 v[44:47], v[116:119], v[168:175], v2
    s_waitcnt lgkmcnt(2)
    v_smfmac_f32_16x16x64_bf16 v[44:47], v[96:99], v[128:135], v2
    s_waitcnt lgkmcnt(0)
    v_smfmac_f32_16x16x64_bf16 v[44:47], v[112:115], v[160:167], v2
    s_nop 7
    v_add_f32_dpp v44, v44, v44 row_ror:8 row_mask:0xf bank_mask:0xf
    v_add_f32_dpp v45, v45, v45 row_ror:8 row_mask:0xf bank_mask:0xf
    v_add_f32_dpp v46, v46, v46 row_ror:8 row_mask:0xf bank_mask:0xf
    v_add_f32_dpp v47, v47, v47 row_ror:8 row_mask:0xf bank_mask:0xf
    v_permlane32_swap_b32 v44, v45
    s_nop 0
    v_permlane32_swap_b32 v46, v47
    v_add_f32 v44, v44, v45
    v_add_f32 v46, v46, v47
    v_exp_f32 v24, v44
    v_exp_f32 v25, v46
    v_max_f32 v22, abs(v44), abs(v46)
    v_cmp_nge_f32 vcc, s89, v22
    v_add_f32 v23, v24, v25
    s_nop 0
    v_cndmask_b32 v28, v23, v18, vcc
    v_cndmask_b32 v23, v23, v18, vcc
    s_nop 1
    v_permlane16_swap_b32 v23, v28
    v_add_f32 v28, v23, v28
    v_mov_b32 v23, v28
    s_nop 1
    v_permlane32_swap_b32 v23, v28
    v_add_f32 v23, v23, v28
    s_mov_b64 exec, 0xff
    ds_write_b32 v19, v23
    s_mov_b64 exec, -1
    s_waitcnt lgkmcnt(0)
    s_barrier
    ds_read_b128 v[32:35], v17
    s_waitcnt lgkmcnt(0)
    v_add_f32 v32, v32, v33
    v_add_f32 v32, v32, v34
    v_rcp_f32 v30, v32
    v_cmp_nlt_f32 vcc, v32, v18
    v_mul_f32 v24, v24, v30
    v_mul_f32 v25, v25, v30
    s_cbranch_vccnz Lexact_41
Lexb_42:
    s_cmp_eq_u32 s27, 0
    v_permlane32_swap_b32 v24, v25
    v_cvt_pk_bf16_f32 v20, v24, v25
    s_cbranch_scc0 Lslow_43
    buffer_store_dword v20, v13, s[16:19], s31 offen
Lback_44:
    s_mov_b64 exec, -1
    s_mov_b32 s94, s26
    s_add_u32 s26, s26, 1
    s_add_u32 s29, s29, 7168
    s_add_u32 s30, s30, 7168
    s_add_u32 s31, s31, 12288
    s_add_u32 s32, s32, 28672
    s_add_u32 s84, s84, 28672
    s_add_u32 s85, s85, 28672
    s_add_u32 s86, s86, 28672
    s_add_u32 s50, s50, 7168
    s_cmp_lt_u32 s26, 63
    s_cbranch_scc1 Lsc_36
    s_branch Lscend
Lsc3:
Lsc_45:
    v_mov_b64 v[64:65], 0
    v_mov_b64 v[66:67], 0
    v_mov_b64 v[68:69], 0
    v_mov_b64 v[70:71], 0
    v_mov_b64 v[72:73], 0
    v_mov_b64 v[74:75], 0
    v_mov_b64 v[76:77], 0
    v_mov_b64 v[78:79], 0
    v_mov_b64 v[80:81], 0
    v_mov_b64 v[82:83], 0
    v_mov_b64 v[84:85], 0
    v_mov_b64 v[86:87], 0
    v_mov_b64 v[88:89], 0
    v_mov_b64 v[90:91], 0
    ds_read_b128 v[48:51], v10 offset:0
    ds_read_b128 v[52:55], v10 offset:1024
    ds_read_b128 v[56:59], v10 offset:2048
    ds_read_b128 v[60:63], v10 offset:3072
    s_sleep 8
    s_waitcnt vmcnt(0)
    buffer_load_dword v36, v1, s[16:19], s93 offen sc1
    s_nop 9
    buffer_load_dword v37, v1, s[16:19], s93 offen sc1
    s_nop 9
    buffer_load_dword v38, v1, s[16:19], s93 offen sc1
    s_nop 9
Lhu_46:
    buffer_load_dword v39, v1, s[16:19], s93 offen sc1
    s_waitcnt vmcnt(3)
    v_cmp_gt_i32 vcc, s94, v36
    s_cbranch_vccz Lhk_47
    buffer_load_dword v36, v1, s[16:19], s93 offen sc1
    s_waitcnt vmcnt(3)
    v_cmp_gt_i32 vcc, s94, v37
    s_cbranch_vccz Lhk_47
    buffer_load_dword v37, v1, s[16:19], s93 offen sc1
    s_waitcnt vmcnt(3)
    v_cmp_gt_i32 vcc, s94, v38
    s_cbranch_vccz Lhk_47
    buffer_load_dword v38, v1, s[16:19], s93 offen sc1
    s_waitcnt vmcnt(3)
    v_cmp_gt_i32 vcc, s94, v39
    s_cbranch_vccz Lhk_47
    s_sub_u32 s28, s28, 1
    s_cbranch_scc0 Lhu_46
    s_branch Lfail
Lhk_47:
Lpm_48:
    buffer_load_dwordx4 v[20:23], v3, s[16:19], s29 offen sc1
    s_waitcnt vmcnt(0)
    ds_write_b128 v4, v[20:23] offset:0
    v_max_u32 v28, v20, v21
    v_max_u32 v29, v22, v23
    v_max_u32 v28, v28, v29
    v_cmp_eq_u32 vcc, -1, v28
    s_cbranch_vccz Lok_49
    s_sub_u32 s28, s28, 1
    s_cbranch_scc0 Lpm_48
    s_branch Lfail
Lok_49:
    s_waitcnt lgkmcnt(0)
    s_barrier
    ds_read_b64_tr_b16 v[92:93], v5 offset:0
    ds_read_b64_tr_b16 v[94:95], v5 offset:128
    ds_read_b64_tr_b16 v[96:97], v5 offset:1536
    ds_read_b64_tr_b16 v[98:99], v5 offset:1664
    ds_read_b64_tr_b16 v[100:101], v5 offset:3072
    ds_read_b64_tr_b16 v[102:103], v5 offset:3200
    ds_read_b64_tr_b16 v[104:105], v5 offset:4608
    ds_read_b64_tr_b16 v[106:107], v5 offset:4736
    ds_read_b64_tr_b16 v[108:109], v5 offset:6144
    ds_read_b64_tr_b16 v[110:111], v5 offset:6272
    ds_read_b64_tr_b16 v[112:113], v5 offset:7680
    ds_read_b64_tr_b16 v[114:115], v5 offset:7808
    ds_read_b64_tr_b16 v[116:117], v5 offset:9216
    ds_read_b64_tr_b16 v[118:119], v5 offset:9344
    s_waitcnt lgkmcnt(12)
    v_smfmac_f32_16x16x64_bf16 v[64:67], v[92:95], a[0:7], v2
    s_waitcnt lgkmcnt(10)
    v_smfmac_f32_16x16x64_bf16 v[64:67], v[96:99], a[8:15], v2
    s_waitcnt lgkmcnt(8)
    v_smfmac_f32_16x16x64_bf16 v[64:67], v[100:103], a[16:23], v2
    v_smfmac_f32_16x16x64_bf16 v[68:71], v[92:95], v[48:55], v2
    ds_read_b128 v[48:51], v10 offset:4096
    s_waitcnt lgkmcnt(7)
    v_smfmac_f32_16x16x64_bf16 v[64:67], v[104:107], a[24:31], v2
    ds_read_b128 v[52:55], v10 offset:5120
    s_waitcnt lgkmcnt(6)
    v_smfmac_f32_16x16x64_bf16 v[64:67], v[108:111], a[32:39], v2
    s_waitcnt lgkmcnt(4)
    v_smfmac_f32_16x16x64_bf16 v[64:67], v[112:115], a[40:47], v2
    v_smfmac_f32_16x16x64_bf16 v[68:71], v[96:99], v[56:63], v2
    ds_read_b128 v[56:59], v10 offset:6144
    s_waitcnt lgkmcnt(3)
    v_smfmac_f32_16x16x64_bf16 v[64:67], v[116:119], a[48:55], v2
    ds_read_b128 v[60:63], v10 offset:7168
    v_smfmac_f32_16x16x64_bf16 v[72:75], v[92:95], a[56:63], v2
    v_smfmac_f32_16x16x64_bf16 v[72:75], v[96:99], a[64:71], v2
    s_waitcnt lgkmcnt(2)
    v_smfmac_f32_16x16x64_bf16 v[68:71], v[100:103], v[48:55], v2
    ds_read_b128 v[48:51], v10 offset:8192
    v_smfmac_f32_16x16x64_bf16 v[72:75], v[100:103], a[72:79], v2
    ds_read_b128 v[52:55], v10 offset:9216
    v_smfmac_f32_16x16x64_bf16 v[72:75], v[104:107], a[80:87], v2
    v_cvt_pk_bf16_f32 v20, v64, v65
    v_smfmac_f32_16x16x64_bf16 v[72:75], v[108:111], a[88:95], v2
    s_waitcnt lgkmcnt(2)
    v_smfmac_f32_16x16x64_bf16 v[68:71], v[104:107], v[56:63], v2
    ds_read_b128 v[56:59], v10 offset:10240
    v_smfmac_f32_16x16x64_bf16 v[72:75], v[112:115], a[96:103], v2
    ds_read_b128 v[60:63], v10 offset:11264
    v_smfmac_f32_16x16x64_bf16 v[72:75], v[116:119], a[104:111], v2
    v_cvt_pk_bf16_f32 v21, v66, v67
    v_smfmac_f32_16x16x64_bf16 v[76:79], v[92:95], a[112:119], v2
    s_waitcnt lgkmcnt(2)
    v_smfmac_f32_16x16x64_bf16 v[68:71], v[108:111], v[48:55], v2
    ds_read_b128 v[48:51], v10 offset:12288
    v_smfmac_f32_16x16x64_bf16 v[76:79], v[96:99], a[120:127], v2
    ds_read_b128 v[52:55], v10 offset:13312
    v_smfmac_f32_16x16x64_bf16 v[76:79], v[100:103], a[128:135], v2
    ds_write_b64 v7, v[20:21] offset:0
    v_smfmac_f32_16x16x64_bf16 v[76:79], v[104:107], a[136:143], v2
    s_waitcnt lgkmcnt(3)
    v_smfmac_f32_16x16x64_bf16 v[68:71], v[112:115], v[56:63], v2
    v_cvt_pk_bf16_f32 v24, v72, v73
    v_smfmac_f32_16x16x64_bf16 v[76:79], v[108:111], a[144:151], v2
    v_cvt_pk_bf16_f32 v25, v74, v75
    v_smfmac_f32_16x16x64_bf16 v[76:79], v[112:115], a[152:159], v2
    ds_write_b64 v7, v[24:25] offset:256
    v_smfmac_f32_16x16x64_bf16 v[76:79], v[116:119], a[160:167], v2
    s_waitcnt lgkmcnt(2)
    v_smfmac_f32_16x16x64_bf16 v[68:71], v[116:119], v[48:55], v2
    buffer_load_dword v38, v14, s[16:19], s50 offen sc1
    v_smfmac_f32_16x16x64_bf16 v[80:83], v[92:95], a[168:175], v2
    buffer_load_dword v39, v15, s[16:19], s32 offen sc1
    v_smfmac_f32_16x16x64_bf16 v[80:83], v[96:99], a[176:183], v2
    buffer_load_dword v40, v16, s[16:19], s31 offen sc1
    v_smfmac_f32_16x16x64_bf16 v[80:83], v[100:103], a[184:191], v2
    v_cvt_pk_bf16_f32 v26, v76, v77
    v_smfmac_f32_16x16x64_bf16 v[80:83], v[104:107], a[192:199], v2
    v_cvt_pk_bf16_f32 v27, v78, v79
    v_smfmac_f32_16x16x64_bf16 v[80:83], v[108:111], a[200:207], v2
    ds_write_b64 v7, v[26:27] offset:384
    v_smfmac_f32_16x16x64_bf16 v[80:83], v[112:115], a[208:215], v2
    v_cvt_pk_bf16_f32 v22, v68, v69
    v_smfmac_f32_16x16x64_bf16 v[80:83], v[116:119], a[216:223], v2
    v_cvt_pk_bf16_f32 v23, v70, v71
    v_smfmac_f32_16x16x64_bf16 v[84:87], v[92:95], a[224:231], v2
    ds_write_b64 v7, v[22:23] offset:128
    v_smfmac_f32_16x16x64_bf16 v[84:87], v[96:99], a[232:239], v2
    v_smfmac_f32_16x16x64_bf16 v[84:87], v[100:103], a[240:247], v2
    v_smfmac_f32_16x16x64_bf16 v[84:87], v[104:107], a[248:255], v2
    s_nop 1
    v_cvt_pk_bf16_f32 v28, v80, v81
    v_smfmac_f32_16x16x64_bf16 v[84:87], v[108:111], v[176:183], v2
    s_waitcnt lgkmcnt(0)
    s_barrier
    v_smfmac_f32_16x16x64_bf16 v[84:87], v[112:115], v[184:191], v2
    v_cvt_pk_bf16_f32 v29, v82, v83
    v_smfmac_f32_16x16x64_bf16 v[84:87], v[116:119], v[192:199], v2
    ds_write_b64 v7, v[28:29] offset:512
    v_smfmac_f32_16x16x64_bf16 v[88:91], v[92:95], v[200:207], v2
    v_smfmac_f32_16x16x64_bf16 v[88:91], v[96:99], v[208:215], v2
    v_smfmac_f32_16x16x64_bf16 v[88:91], v[100:103], v[216:223], v2
    v_smfmac_f32_16x16x64_bf16 v[88:91], v[104:107], v[224:231], v2
    s_nop 2
    v_cvt_pk_bf16_f32 v30, v84, v85
    v_smfmac_f32_16x16x64_bf16 v[88:91], v[108:111], v[232:239], v2
    v_cvt_pk_bf16_f32 v31, v86, v87
    v_smfmac_f32_16x16x64_bf16 v[88:91], v[112:115], v[240:247], v2
    ds_write_b64 v7, v[30:31] offset:640
    v_smfmac_f32_16x16x64_bf16 v[88:91], v[116:119], v[248:255], v2
    s_nop 7
    v_cvt_pk_bf16_f32 v32, v88, v89
    v_cvt_pk_bf16_f32 v33, v90, v91
    s_waitcnt lgkmcnt(0)
    s_barrier
    ds_write_b64 v8, v[32:33]
    s_waitcnt lgkmcnt(0)
    s_barrier
    s_barrier
    v_mov_b32 v43, s26
    s_cmp_eq_u32 s27, 0
    s_mov_b64 exec, 1
    s_cbranch_scc0 Lslow_50
    buffer_store_dword v43, v42, s[16:19], s95 offen
Lback_51:
    s_mov_b64 exec, -1
    ds_read_b128 v[32:35], v17
    s_waitcnt lgkmcnt(0)
    v_add_f32 v32, v32, v33
    v_add_f32 v32, v32, v34
    v_cmp_nlt_f32 vcc, v32, v18
    s_cbranch_vccnz Lexact_52
Lexb_53:
    s_mov_b32 s94, s26
    s_add_u32 s26, s26, 1
    s_add_u32 s29, s29, 7168
    s_add_u32 s30, s30, 7168
    s_add_u32 s31, s31, 12288
    s_add_u32 s32, s32, 28672
    s_add_u32 s84, s84, 28672
    s_add_u32 s85, s85, 28672
    s_add_u32 s86, s86, 28672
    s_add_u32 s50, s50, 7168
    s_cmp_lt_u32 s26, 63
    s_cbranch_scc1 Lsc_45
Lscend:
    s_branch Ldone
Lvalue:
    s_sub_u32 s25, s25, 16
    s_mov_b32 s35, 112
    v_and_b32 v250, 63, v0
    v_add_u32 v251, 0, v250
    v_min_u32 v251, 111, v251
    v_add_u32 v251, s35, v251
    v_lshlrev_b32 v251, 6, v251
    v_add_u32 v252, 64, v250
    v_min_u32 v252, 111, v252
    v_add_u32 v252, s35, v252
    v_lshlrev_b32 v252, 6, v252
    s_mov_b32 s36, 15990784
Lnw_54:
    buffer_load_dword v253, v251, s[16:19], s36 offen sc1
    buffer_load_dword v254, v252, s[16:19], s36 offen sc1
    s_waitcnt vmcnt(0)
    v_cmp_ne_u32 vcc, s98, v253
    v_cmp_ne_u32 s[96:97], s98, v254
    s_nop 1
    s_or_b64 vcc, vcc, s[96:97]
    s_cbranch_vccz Lnk_55
    s_sleep 1
    s_sub_u32 s28, s28, 1
    s_cbranch_scc0 Lnw_54
    s_branch Lfail
Lnk_55:
    v_and_b32 v1, 63, v0
    v_mov_b32 v2, 0x4444
    v_mov_b32 v80, 0xeeee
    v_cndmask_b32 v2, v2, v80, s[38:39]
    v_lshlrev_b32 v3, 4, v0
    v_lshrrev_b32 v80, 4, v0
    v_lshlrev_b32 v80, 7, v80
    v_add_u32 v4, v3, v80
    v_lshrrev_b32 v81, 4, v1
    v_bfe_u32 v82, v1, 2, 2
    v_and_b32 v83, 3, v1
    v_mul_u32_u24 v5, 384, v81
    v_lshrrev_b32 v84, 1, v82
    v_lshl_add_u32 v5, v84, 6, v5
    v_lshrrev_b32 v84, 1, v83
    v_lshl_add_u32 v5, v84, 5, v5
    v_and_b32 v84, 1, v82
    v_lshl_add_u32 v5, v84, 4, v5
    v_and_b32 v84, 1, v83
    v_lshl_add_u32 v5, v84, 3, v5
    s_mul_i32 s33, s24, 14336
    s_add_u32 s33, s33, 25856
    v_lshlrev_b32 v6, 4, v1
    v_add_u32 v6, s33, v6
    s_lshl_b32 s33, s25, 15
    s_lshl_b32 s34, s24, 13
    s_add_u32 s33, s33, s34
    v_lshlrev_b32 v7, 4, v1
    v_add_u32 v7, s33, v7
    s_lshl_b32 s33, s25, 14
    s_lshl_b32 s34, s24, 12
    s_add_u32 s33, s33, s34
    v_lshlrev_b32 v13, 4, v1
    v_add_u32 v13, s33, v13
    v_and_b32 v14, 3, v1
    s_lshl_b32 s33, s24, 2
    v_add_u32 v14, s33, v14
    v_lshlrev_b32 v14, 6, v14
    v_mov_b32 v14, 0
    s_lshl_b32 s33, s25, 7
    v_mov_b32 v15, s33
    v_lshlrev_b32 v8, 4, v1
    v_lshlrev_b32 v11, 4, v1
    s_lshl_b32 s33, s24, 10
    s_add_u32 s33, s33, 10752
    v_add_u32 v10, s33, v11
    s_and_b32 s33, s24, 1
    s_lshl_b32 s33, s33, 3
    s_add_u32 s33, s33, 10752
    v_add_u32 v11, s33, v11
    v_and_b32 v84, 15, v1
    v_lshlrev_b32 v12, 4, v84
    v_lshrrev_b32 v84, 5, v1
    v_lshl_add_u32 v12, v84, 8, v12
    v_and_b32 v84, 1, v81
    v_lshl_add_u32 v12, v84, 3, v12
    s_lshl_b32 s33, s25, 9
    s_and_b32 s34, s24, 1
    s_lshl_b32 s34, s34, 2
    s_add_u32 s33, s33, s34
    v_add_u32 v12, s33, v12
    s_lshl_b32 s33, s25, 2
    s_add_u32 s33, s33, s24
    s_mul_i32 s33, s33, 114688
    s_add_u32 s33, s33, 6815744
    v_lshlrev_b32 v80, 4, v1
    s_mov_b32 s35, 0
    s_mul_i32 s35, s35, 14336
    s_add_u32 s35, s35, s33
    buffer_load_dwordx4 a[0:3], v80, s[16:19], s35 offen offset:0 sc1
    buffer_load_dwordx4 a[4:7], v80, s[16:19], s35 offen offset:1024 sc1
    buffer_load_dwordx4 a[8:11], v80, s[16:19], s35 offen offset:2048 sc1
    buffer_load_dwordx4 a[12:15], v80, s[16:19], s35 offen offset:3072 sc1
    s_add_u32 s35, s35, 4096
    buffer_load_dwordx4 a[16:19], v80, s[16:19], s35 offen offset:0 sc1
    buffer_load_dwordx4 a[20:23], v80, s[16:19], s35 offen offset:1024 sc1
    buffer_load_dwordx4 a[24:27], v80, s[16:19], s35 offen offset:2048 sc1
    buffer_load_dwordx4 a[28:31], v80, s[16:19], s35 offen offset:3072 sc1
    s_add_u32 s35, s35, 4096
    buffer_load_dwordx4 a[32:35], v80, s[16:19], s35 offen offset:0 sc1
    buffer_load_dwordx4 a[36:39], v80, s[16:19], s35 offen offset:1024 sc1
    buffer_load_dwordx4 a[40:43], v80, s[16:19], s35 offen offset:2048 sc1
    buffer_load_dwordx4 a[44:47], v80, s[16:19], s35 offen offset:3072 sc1
    s_add_u32 s35, s35, 4096
    buffer_load_dwordx4 a[48:51], v80, s[16:19], s35 offen offset:0 sc1
    buffer_load_dwordx4 a[52:55], v80, s[16:19], s35 offen offset:1024 sc1
    s_mov_b32 s35, 1
    s_mul_i32 s35, s35, 14336
    s_add_u32 s35, s35, s33
    s_mul_i32 s36, s24, 14336
    s_add_u32 s36, s36, 25856
    s_add_u32 m0, s36, 0
    s_nop 0
    buffer_load_dwordx4 v80, s[16:19], s35 offen offset:0 sc1 lds
    s_add_u32 m0, s36, 0
    s_nop 0
    buffer_load_dwordx4 v80, s[16:19], s35 offen offset:1024 sc1 lds
    s_add_u32 m0, s36, 0
    s_nop 0
    buffer_load_dwordx4 v80, s[16:19], s35 offen offset:2048 sc1 lds
    s_add_u32 m0, s36, 0
    s_nop 0
    buffer_load_dwordx4 v80, s[16:19], s35 offen offset:3072 sc1 lds
    s_add_u32 s35, s35, 4096
    s_add_u32 m0, s36, 4096
    s_nop 0
    buffer_load_dwordx4 v80, s[16:19], s35 offen offset:0 sc1 lds
    s_add_u32 m0, s36, 4096
    s_nop 0
    buffer_load_dwordx4 v80, s[16:19], s35 offen offset:1024 sc1 lds
    s_add_u32 m0, s36, 4096
    s_nop 0
    buffer_load_dwordx4 v80, s[16:19], s35 offen offset:2048 sc1 lds
    s_add_u32 m0, s36, 4096
    s_nop 0
    buffer_load_dwordx4 v80, s[16:19], s35 offen offset:3072 sc1 lds
    s_add_u32 s35, s35, 4096
    s_add_u32 m0, s36, 8192
    s_nop 0
    buffer_load_dwordx4 v80, s[16:19], s35 offen offset:0 sc1 lds
    s_add_u32 m0, s36, 8192
    s_nop 0
    buffer_load_dwordx4 v80, s[16:19], s35 offen offset:1024 sc1 lds
    s_add_u32 m0, s36, 8192
    s_nop 0
    buffer_load_dwordx4 v80, s[16:19], s35 offen offset:2048 sc1 lds
    s_add_u32 m0, s36, 8192
    s_nop 0
    buffer_load_dwordx4 v80, s[16:19], s35 offen offset:3072 sc1 lds
    s_add_u32 s35, s35, 4096
    s_add_u32 m0, s36, 12288
    s_nop 0
    buffer_load_dwordx4 v80, s[16:19], s35 offen offset:0 sc1 lds
    s_add_u32 m0, s36, 12288
    s_nop 0
    buffer_load_dwordx4 v80, s[16:19], s35 offen offset:1024 sc1 lds
    s_mov_b32 s35, 2
    s_mul_i32 s35, s35, 14336
    s_add_u32 s35, s35, s33
    buffer_load_dwordx4 a[56:59], v80, s[16:19], s35 offen offset:0 sc1
    buffer_load_dwordx4 a[60:63], v80, s[16:19], s35 offen offset:1024 sc1
    buffer_load_dwordx4 a[64:67], v80, s[16:19], s35 offen offset:2048 sc1
    buffer_load_dwordx4 a[68:71], v80, s[16:19], s35 offen offset:3072 sc1
    s_add_u32 s35, s35, 4096
    buffer_load_dwordx4 a[72:75], v80, s[16:19], s35 offen offset:0 sc1
    buffer_load_dwordx4 a[76:79], v80, s[16:19], s35 offen offset:1024 sc1
    buffer_load_dwordx4 a[80:83], v80, s[16:19], s35 offen offset:2048 sc1
    buffer_load_dwordx4 a[84:87], v80, s[16:19], s35 offen offset:3072 sc1
    s_add_u32 s35, s35, 4096
    buffer_load_dwordx4 a[88:91], v80, s[16:19], s35 offen offset:0 sc1
    buffer_load_dwordx4 a[92:95], v80, s[16:19], s35 offen offset:1024 sc1
    buffer_load_dwordx4 a[96:99], v80, s[16:19], s35 offen offset:2048 sc1
    buffer_load_dwordx4 a[100:103], v80, s[16:19], s35 offen offset:3072 sc1
    s_add_u32 s35, s35, 4096
    buffer_load_dwordx4 a[104:107], v80, s[16:19], s35 offen offset:0 sc1
    buffer_load_dwordx4 a[108:111], v80, s[16:19], s35 offen offset:1024 sc1
    s_mov_b32 s35, 3
    s_mul_i32 s35, s35, 14336
    s_add_u32 s35, s35, s33
    buffer_load_dwordx4 a[112:115], v80, s[16:19], s35 offen offset:0 sc1
    buffer_load_dwordx4 a[116:119], v80, s[16:19], s35 offen offset:1024 sc1
    buffer_load_dwordx4 a[120:123], v80, s[16:19], s35 offen offset:2048 sc1
    buffer_load_dwordx4 a[124:127], v80, s[16:19], s35 offen offset:3072 sc1
    s_add_u32 s35, s35, 4096
    buffer_load_dwordx4 a[128:131], v80, s[16:19], s35 offen offset:0 sc1
    buffer_load_dwordx4 a[132:135], v80, s[16:19], s35 offen offset:1024 sc1
    s_waitcnt vmcnt(16)
    buffer_load_dwordx4 a[136:139], v80, s[16:19], s35 offen offset:2048 sc1
    buffer_load_dwordx4 a[140:143], v80, s[16:19], s35 offen offset:3072 sc1
    s_add_u32 s35, s35, 4096
    buffer_load_dwordx4 a[144:147], v80, s[16:19], s35 offen offset:0 sc1
    buffer_load_dwordx4 a[148:151], v80, s[16:19], s35 offen offset:1024 sc1
    buffer_load_dwordx4 a[152:155], v80, s[16:19], s35 offen offset:2048 sc1
    buffer_load_dwordx4 a[156:159], v80, s[16:19], s35 offen offset:3072 sc1
    s_add_u32 s35, s35, 4096
    buffer_load_dwordx4 a[160:163], v80, s[16:19], s35 offen offset:0 sc1
    buffer_load_dwordx4 a[164:167], v80, s[16:19], s35 offen offset:1024 sc1
    s_mov_b32 s35, 4
    s_mul_i32 s35, s35, 14336
    s_add_u32 s35, s35, s33
    buffer_load_dwordx4 a[168:171], v80, s[16:19], s35 offen offset:0 sc1
    buffer_load_dwordx4 a[172:175], v80, s[16:19], s35 offen offset:1024 sc1
    buffer_load_dwordx4 a[176:179], v80, s[16:19], s35 offen offset:2048 sc1
    buffer_load_dwordx4 a[180:183], v80, s[16:19], s35 offen offset:3072 sc1
    s_add_u32 s35, s35, 4096
    buffer_load_dwordx4 a[184:187], v80, s[16:19], s35 offen offset:0 sc1
    buffer_load_dwordx4 a[188:191], v80, s[16:19], s35 offen offset:1024 sc1
    buffer_load_dwordx4 a[192:195], v80, s[16:19], s35 offen offset:2048 sc1
    buffer_load_dwordx4 a[196:199], v80, s[16:19], s35 offen offset:3072 sc1
    s_add_u32 s35, s35, 4096
    buffer_load_dwordx4 a[200:203], v80, s[16:19], s35 offen offset:0 sc1
    buffer_load_dwordx4 a[204:207], v80, s[16:19], s35 offen offset:1024 sc1
    buffer_load_dwordx4 a[208:211], v80, s[16:19], s35 offen offset:2048 sc1
    buffer_load_dwordx4 a[212:215], v80, s[16:19], s35 offen offset:3072 sc1
    s_add_u32 s35, s35, 4096
    buffer_load_dwordx4 a[216:219], v80, s[16:19], s35 offen offset:0 sc1
    buffer_load_dwordx4 a[220:223], v80, s[16:19], s35 offen offset:1024 sc1
    s_mov_b32 s35, 5
    s_mul_i32 s35, s35, 14336
    s_add_u32 s35, s35, s33
    buffer_load_dwordx4 a[224:227], v80, s[16:19], s35 offen offset:0 sc1
    buffer_load_dwordx4 a[228:231], v80, s[16:19], s35 offen offset:1024 sc1
    buffer_load_dwordx4 a[232:235], v80, s[16:19], s35 offen offset:2048 sc1
    buffer_load_dwordx4 a[236:239], v80, s[16:19], s35 offen offset:3072 sc1
    s_add_u32 s35, s35, 4096
    buffer_load_dwordx4 a[240:243], v80, s[16:19], s35 offen offset:0 sc1
    buffer_load_dwordx4 a[244:247], v80, s[16:19], s35 offen offset:1024 sc1
    buffer_load_dwordx4 a[248:251], v80, s[16:19], s35 offen offset:2048 sc1
    buffer_load_dwordx4 a[252:255], v80, s[16:19], s35 offen offset:3072 sc1
    s_add_u32 s35, s35, 4096
    buffer_load_dwordx4 v[120:123], v80, s[16:19], s35 offen offset:0 sc1
    buffer_load_dwordx4 v[124:127], v80, s[16:19], s35 offen offset:1024 sc1
    buffer_load_dwordx4 v[128:131], v80, s[16:19], s35 offen offset:2048 sc1
    buffer_load_dwordx4 v[132:135], v80, s[16:19], s35 offen offset:3072 sc1
    s_add_u32 s35, s35, 4096
    buffer_load_dwordx4 v[136:139], v80, s[16:19], s35 offen offset:0 sc1
    buffer_load_dwordx4 v[140:143], v80, s[16:19], s35 offen offset:1024 sc1
    s_mov_b32 s35, 6
    s_mul_i32 s35, s35, 14336
    s_add_u32 s35, s35, s33
    buffer_load_dwordx4 v[144:147], v80, s[16:19], s35 offen offset:0 sc1
    buffer_load_dwordx4 v[148:151], v80, s[16:19], s35 offen offset:1024 sc1
    buffer_load_dwordx4 v[152:155], v80, s[16:19], s35 offen offset:2048 sc1
    buffer_load_dwordx4 v[156:159], v80, s[16:19], s35 offen offset:3072 sc1
    s_add_u32 s35, s35, 4096
    buffer_load_dwordx4 v[160:163], v80, s[16:19], s35 offen offset:0 sc1
    buffer_load_dwordx4 v[164:167], v80, s[16:19], s35 offen offset:1024 sc1
    buffer_load_dwordx4 v[168:171], v80, s[16:19], s35 offen offset:2048 sc1
    buffer_load_dwordx4 v[172:175], v80, s[16:19], s35 offen offset:3072 sc1
    s_add_u32 s35, s35, 4096
    buffer_load_dwordx4 v[176:179], v80, s[16:19], s35 offen offset:0 sc1
    buffer_load_dwordx4 v[180:183], v80, s[16:19], s35 offen offset:1024 sc1
    buffer_load_dwordx4 v[184:187], v80, s[16:19], s35 offen offset:2048 sc1
    buffer_load_dwordx4 v[188:191], v80, s[16:19], s35 offen offset:3072 sc1
    s_waitcnt vmcnt(16)
    s_add_u32 s35, s35, 4096
    buffer_load_dwordx4 v[192:195], v80, s[16:19], s35 offen offset:0 sc1
    buffer_load_dwordx4 v[196:199], v80, s[16:19], s35 offen offset:1024 sc1
    s_mov_b32 s35, 7
    s_mul_i32 s35, s35, 14336
    s_add_u32 s35, s35, s33
    buffer_load_dwordx4 v[200:203], v80, s[16:19], s35 offen offset:0 sc1
    buffer_load_dwordx4 v[204:207], v80, s[16:19], s35 offen offset:1024 sc1
    buffer_load_dwordx4 v[208:211], v80, s[16:19], s35 offen offset:2048 sc1
    buffer_load_dwordx4 v[212:215], v80, s[16:19], s35 offen offset:3072 sc1
    s_add_u32 s35, s35, 4096
    buffer_load_dwordx4 v[216:219], v80, s[16:19], s35 offen offset:0 sc1
    buffer_load_dwordx4 v[220:223], v80, s[16:19], s35 offen offset:1024 sc1
    buffer_load_dwordx4 v[224:227], v80, s[16:19], s35 offen offset:2048 sc1
    buffer_load_dwordx4 v[228:231], v80, s[16:19], s35 offen offset:3072 sc1
    s_add_u32 s35, s35, 4096
    buffer_load_dwordx4 v[232:235], v80, s[16:19], s35 offen offset:0 sc1
    buffer_load_dwordx4 v[236:239], v80, s[16:19], s35 offen offset:1024 sc1
    buffer_load_dwordx4 v[240:243], v80, s[16:19], s35 offen offset:2048 sc1
    buffer_load_dwordx4 v[244:247], v80, s[16:19], s35 offen offset:3072 sc1
    s_add_u32 s35, s35, 4096
    buffer_load_dwordx4 v[248:251], v80, s[16:19], s35 offen offset:0 sc1
    buffer_load_dwordx4 v[252:255], v80, s[16:19], s35 offen offset:1024 sc1
    s_waitcnt vmcnt(0)
    v_min_u32 v80, 30, v1
    v_lshlrev_b32 v80, 2, v80
    s_mov_b32 s34, 15466496
Lxp_56:
    buffer_load_dword v81, v80, s[16:19], s34 offen sc1
    s_waitcnt vmcnt(0)
    v_cmp_eq_u32 vcc, -1, v81
    s_cbranch_vccz Lok_57
    s_sub_u32 s28, s28, 1
    s_cbranch_scc0 Lxp_56
    s_branch Lfail
Lok_57:
    s_getreg_b32 s33, hwreg(HW_REG_XCC_ID, 0, 4)
    s_nop 0
    v_cmp_ne_u32 vcc, s33, v81
    s_nop 4
    s_cmp_eq_u64 vcc, 0
    s_cselect_b32 s27, 0, 1
    v_mov_b32 v0, 1
    v_and_b32 v9, 3, v1
    v_lshlrev_b32 v9, 2, v9
    s_lshl_b32 s33, s24, 7
    v_add_u32 v9, s33, v9
    s_mov_b32 s93, 15467520
    s_and_b32 s33, s25, 7
    s_lshr_b32 s33, s33, 1
    s_lshl_b32 s33, s33, 7
    s_lshr_b32 s34, s25, 3
    s_lshl_b32 s34, s34, 1
    s_and_b32 s35, s25, 1
    s_add_u32 s34, s34, s35
    s_lshl_b32 s34, s34, 2
    s_add_u32 s33, s33, s34
    s_add_u32 s95, s33, 15468544
    s_cmp_eq_u32 s24, 3
    s_cbranch_scc0 Lva_nz
    v_mov_b32 v12, 0
Lva_nz:
    v_mov_b32 v1, -1
    s_mov_b32 s42, 16777216
    s_mov_b32 s43, 16781312
    s_mov_b32 s44, 46137344
    s_mov_b32 s88, 15469568
    s_lshl_b32 s33, s24, 10
    s_add_u32 s47, s31, s33
    s_add_u32 s47, s47, 8192
    s_lshl_b32 s33, s24, 11
    s_add_u32 s31, s31, s33
    s_mov_b32 s87, 0
    s_mov_b32 s45, 14155776
    s_cmp_eq_u32 s25, s24
    s_cselect_b32 s87, 1, s87
    s_add_u32 s33, s24, 4
    s_cmp_eq_u32 s25, s33
    s_cselect_b32 s34, 2, 0
    s_cmp_lt_u32 s25, 7
    s_cselect_b32 s34, s34, 0
    s_cmp_eq_u32 s34, 2
    s_cselect_b32 s87, 2, s87
    s_cselect_b32 s34, 4096, 0
    s_add_u32 s45, s45, s34
    s_mov_b32 s46, 15470848
    s_cmp_eq_u32 s24, 3
    s_cbranch_scc1 Lva3
    s_cmp_eq_u32 s24, 2
    s_cbranch_scc1 Lva2
Lva_58:
    ds_read_b128 v[16:19], v6 offset:0
    ds_read_b128 v[20:23], v6 offset:1024
    ds_read_b128 v[24:27], v6 offset:2048
    ds_read_b128 v[28:31], v6 offset:3072
    s_sleep 4
Lpm_60:
    buffer_load_dwordx4 v[48:51], v3, s[16:19], s29 offen sc1
    buffer_load_dwordx4 v[52:55], v3, s[16:19], s30 offen sc1
    s_waitcnt vmcnt(0)
    ds_write_b128 v4, v[48:51] offset:0
    ds_write_b128 v4, v[52:55] offset:6144
    v_max3_u32 v80, v48, v49, v50
    v_max_u32 v80, v80, v51
    v_max3_u32 v81, v52, v53, v54
    v_max_u32 v81, v81, v55
    v_max_u32 v80, v80, v81
    v_cmp_eq_u32 vcc, -1, v80
    s_cbranch_vccz Lok_61
    s_sub_u32 s28, s28, 1
    s_cbranch_scc0 Lpm_60
    s_branch Lfail
Lok_61:
Lmc_59:
    s_waitcnt lgkmcnt(0)
    s_barrier
    ds_read_b64_tr_b16 v[92:93], v5 offset:0
    ds_read_b64_tr_b16 v[94:95], v5 offset:128
    ds_read_b64_tr_b16 v[96:97], v5 offset:1536
    ds_read_b64_tr_b16 v[98:99], v5 offset:1664
    ds_read_b64_tr_b16 v[100:101], v5 offset:3072
    ds_read_b64_tr_b16 v[102:103], v5 offset:3200
    ds_read_b64_tr_b16 v[104:105], v5 offset:4608
    ds_read_b64_tr_b16 v[106:107], v5 offset:4736
    ds_read_b64_tr_b16 v[108:109], v5 offset:6144
    ds_read_b64_tr_b16 v[110:111], v5 offset:6272
    ds_read_b64_tr_b16 v[112:113], v5 offset:7680
    ds_read_b64_tr_b16 v[114:115], v5 offset:7808
    ds_read_b64_tr_b16 v[116:117], v5 offset:9216
    ds_read_b64_tr_b16 v[118:119], v5 offset:9344
    v_mov_b32 v80, 0
    v_mov_b32 v81, 0
    v_mov_b32 v82, 0
    v_mov_b32 v83, 0
    v_mov_b32 v84, 0
    v_mov_b32 v85, 0
    v_mov_b32 v86, 0
    v_mov_b32 v87, 0
    v_mov_b32 v88, 0
    v_mov_b32 v89, 0
    v_mov_b32 v90, 0
    v_mov_b32 v91, 0
    s_waitcnt lgkmcnt(12)
    v_smfmac_f32_16x16x64_bf16 v[80:83], v[92:95], a[0:7], v2
    v_cmp_ge_i32 vcc, s26, v1
    s_cbranch_vccnz Lfvx_62
Lfvb_63:
    buffer_load_dword v1, v14, s[16:19], s88 offen sc1
    s_waitcnt lgkmcnt(10)
    v_smfmac_f32_16x16x64_bf16 v[80:83], v[96:99], a[8:15], v2
    s_waitcnt lgkmcnt(8)
    v_smfmac_f32_16x16x64_bf16 v[80:83], v[100:103], a[16:23], v2
    buffer_load_dwordx4 v[48:51], v7, s[16:19], s42 offen offset:0 sc1
    s_waitcnt lgkmcnt(6)
    v_smfmac_f32_16x16x64_bf16 v[80:83], v[104:107], a[24:31], v2
    s_waitcnt lgkmcnt(4)
    v_smfmac_f32_16x16x64_bf16 v[80:83], v[108:111], a[32:39], v2
    s_waitcnt lgkmcnt(2)
    v_smfmac_f32_16x16x64_bf16 v[80:83], v[112:115], a[40:47], v2
    buffer_load_dwordx4 v[52:55], v7, s[16:19], s42 offen offset:1024 sc1
    s_waitcnt lgkmcnt(0)
    v_smfmac_f32_16x16x64_bf16 v[80:83], v[116:119], a[48:55], v2
    v_smfmac_f32_16x16x64_bf16 v[88:91], v[92:95], a[56:63], v2
    v_smfmac_f32_16x16x64_bf16 v[88:91], v[96:99], a[64:71], v2
    buffer_load_dwordx4 v[56:59], v7, s[16:19], s42 offen offset:2048 sc1
    v_smfmac_f32_16x16x64_bf16 v[84:87], v[92:95], v[16:23], v2
    ds_read_b128 v[16:19], v6 offset:4096
    ds_read_b128 v[20:23], v6 offset:5120
    v_smfmac_f32_16x16x64_bf16 v[88:91], v[100:103], a[72:79], v2
    s_nop 0
    v_cvt_pk_bf16_f32 v32, v80, v81
    v_cvt_pk_bf16_f32 v33, v82, v83
    v_smfmac_f32_16x16x64_bf16 v[88:91], v[104:107], a[80:87], v2
    v_mov_b32 v80, 0
    v_mov_b32 v81, 0
    v_smfmac_f32_16x16x64_bf16 v[84:87], v[96:99], v[24:31], v2
    buffer_load_dwordx4 v[60:63], v7, s[16:19], s42 offen offset:3072 sc1
    ds_read_b128 v[24:27], v6 offset:6144
    ds_read_b128 v[28:31], v6 offset:7168
    v_mov_b32 v82, 0
    v_mov_b32 v83, 0
    v_smfmac_f32_16x16x64_bf16 v[88:91], v[108:111], a[88:95], v2
    v_smfmac_f32_16x16x64_bf16 v[88:91], v[112:115], a[96:103], v2
    s_waitcnt lgkmcnt(2)
    v_smfmac_f32_16x16x64_bf16 v[84:87], v[100:103], v[16:23], v2
    ds_read_b128 v[16:19], v6 offset:8192
    ds_read_b128 v[20:23], v6 offset:9216
    v_smfmac_f32_16x16x64_bf16 v[88:91], v[116:119], a[104:111], v2
    buffer_load_dwordx4 v[64:67], v7, s[16:19], s43 offen offset:0 sc1
    v_smfmac_f32_16x16x64_bf16 v[80:83], v[92:95], a[112:119], v2
    s_waitcnt lgkmcnt(2)
    v_smfmac_f32_16x16x64_bf16 v[84:87], v[104:107], v[24:31], v2
    ds_read_b128 v[24:27], v6 offset:10240
    ds_read_b128 v[28:31], v6 offset:11264
    v_smfmac_f32_16x16x64_bf16 v[80:83], v[96:99], a[120:127], v2
    v_smfmac_f32_16x16x64_bf16 v[80:83], v[100:103], a[128:135], v2
    buffer_load_dwordx4 v[68:71], v7, s[16:19], s43 offen offset:1024 sc1
    v_cvt_pk_bf16_f32 v34, v88, v89
    v_cvt_pk_bf16_f32 v35, v90, v91
    s_waitcnt lgkmcnt(2)
    v_smfmac_f32_16x16x64_bf16 v[84:87], v[108:111], v[16:23], v2
    ds_read_b128 v[16:19], v6 offset:12288
    ds_read_b128 v[20:23], v6 offset:13312
    v_mov_b32 v88, 0
    v_mov_b32 v89, 0
    v_smfmac_f32_16x16x64_bf16 v[80:83], v[104:107], a[136:143], v2
    v_mov_b32 v90, 0
    v_mov_b32 v91, 0
    v_smfmac_f32_16x16x64_bf16 v[80:83], v[108:111], a[144:151], v2
    s_waitcnt lgkmcnt(2)
    v_smfmac_f32_16x16x64_bf16 v[84:87], v[112:115], v[24:31], v2
    buffer_load_dwordx4 v[72:75], v7, s[16:19], s43 offen offset:2048 sc1
    v_smfmac_f32_16x16x64_bf16 v[80:83], v[112:115], a[152:159], v2
    v_smfmac_f32_16x16x64_bf16 v[80:83], v[116:119], a[160:167], v2
    s_waitcnt lgkmcnt(0)
    v_smfmac_f32_16x16x64_bf16 v[84:87], v[116:119], v[16:23], v2
    v_smfmac_f32_16x16x64_bf16 v[88:91], v[92:95], a[168:175], v2
    buffer_load_dwordx4 v[76:79], v7, s[16:19], s43 offen offset:3072 sc1
    v_smfmac_f32_16x16x64_bf16 v[88:91], v[96:99], a[176:183], v2
    v_smfmac_f32_16x16x64_bf16 v[88:91], v[100:103], a[184:191], v2
    s_nop 1
    v_cvt_pk_bf16_f32 v42, v80, v81
    v_cvt_pk_bf16_f32 v43, v82, v83
    v_smfmac_f32_16x16x64_bf16 v[88:91], v[104:107], a[192:199], v2
    v_cvt_pk_bf16_f32 v40, v84, v85
    v_cvt_pk_bf16_f32 v41, v86, v87
    v_mov_b32 v80, 0
    v_mov_b32 v81, 0
    v_smfmac_f32_16x16x64_bf16 v[88:91], v[108:111], a[200:207], v2
    v_mov_b32 v84, 0
    v_mov_b32 v85, 0
    v_mov_b32 v82, 0
    v_mov_b32 v83, 0
    v_smfmac_f32_16x16x64_bf16 v[88:91], v[112:115], a[208:215], v2
    v_mov_b32 v86, 0
    v_mov_b32 v87, 0
    v_smfmac_f32_16x16x64_bf16 v[88:91], v[116:119], a[216:223], v2
    v_smfmac_f32_16x16x64_bf16 v[80:83], v[92:95], a[224:231], v2
    v_smfmac_f32_16x16x64_bf16 v[80:83], v[96:99], a[232:239], v2
    v_smfmac_f32_16x16x64_bf16 v[80:83], v[100:103], a[240:247], v2
    v_smfmac_f32_16x16x64_bf16 v[80:83], v[104:107], a[248:255], v2
    s_nop 3
    v_cvt_pk_bf16_f32 v36, v88, v89
    v_cvt_pk_bf16_f32 v37, v90, v91
    v_smfmac_f32_16x16x64_bf16 v[80:83], v[108:111], v[120:127], v2
    v_mov_b32 v88, 0
    v_mov_b32 v89, 0
    v_smfmac_f32_16x16x64_bf16 v[80:83], v[112:115], v[128:135], v2
    v_mov_b32 v90, 0
    v_mov_b32 v91, 0
    v_smfmac_f32_16x16x64_bf16 v[80:83], v[116:119], v[136:143], v2
    v_smfmac_f32_16x16x64_bf16 v[84:87], v[92:95], v[144:151], v2
    v_smfmac_f32_16x16x64_bf16 v[84:87], v[96:99], v[152:159], v2
    v_smfmac_f32_16x16x64_bf16 v[84:87], v[100:103], v[160:167], v2
    v_smfmac_f32_16x16x64_bf16 v[84:87], v[104:107], v[168:175], v2
    s_nop 3
    v_cvt_pk_bf16_f32 v44, v80, v81
    v_cvt_pk_bf16_f32 v45, v82, v83
    v_smfmac_f32_16x16x64_bf16 v[84:87], v[108:111], v[176:183], v2
    v_smfmac_f32_16x16x64_bf16 v[84:87], v[112:115], v[184:191], v2
    v_smfmac_f32_16x16x64_bf16 v[84:87], v[116:119], v[192:199], v2
    v_smfmac_f32_16x16x64_bf16 v[88:91], v[92:95], v[200:207], v2
    v_smfmac_f32_16x16x64_bf16 v[88:91], v[96:99], v[208:215], v2
    v_smfmac_f32_16x16x64_bf16 v[88:91], v[100:103], v[216:223], v2
    v_smfmac_f32_16x16x64_bf16 v[88:91], v[104:107], v[224:231], v2
    s_nop 3
    v_cvt_pk_bf16_f32 v38, v84, v85
    v_cvt_pk_bf16_f32 v39, v86, v87
    v_smfmac_f32_16x16x64_bf16 v[88:91], v[108:111], v[232:239], v2
    v_smfmac_f32_16x16x64_bf16 v[88:91], v[112:115], v[240:247], v2
    v_smfmac_f32_16x16x64_bf16 v[88:91], v[116:119], v[248:255], v2
    v_mov_b32 v104, 0
    v_mov_b32 v105, 0
    v_mov_b32 v106, 0
    v_mov_b32 v107, 0
    v_mov_b32 v108, 0
    v_mov_b32 v109, 0
    v_mov_b32 v110, 0
    v_mov_b32 v111, 0
    v_cvt_pk_bf16_f32 v46, v88, v89
    v_cvt_pk_bf16_f32 v47, v90, v91
    s_sleep 2
    s_waitcnt vmcnt(0)
    buffer_load_dword v112, v9, s[16:19], s93 offen sc1
    s_nop 9
    buffer_load_dword v113, v9, s[16:19], s93 offen sc1
    s_nop 9
    buffer_load_dword v114, v9, s[16:19], s93 offen sc1
    s_nop 9
Lhu_64:
    buffer_load_dword v115, v9, s[16:19], s93 offen sc1
    s_waitcnt vmcnt(3)
    v_cmp_gt_i32 vcc, s26, v112
    s_cbranch_vccz Lhk_65
    buffer_load_dword v112, v9, s[16:19], s93 offen sc1
    s_waitcnt vmcnt(3)
    v_cmp_gt_i32 vcc, s26, v113
    s_cbranch_vccz Lhk_65
    buffer_load_dword v113, v9, s[16:19], s93 offen sc1
    s_waitcnt vmcnt(3)
    v_cmp_gt_i32 vcc, s26, v114
    s_cbranch_vccz Lhk_65
    buffer_load_dword v114, v9, s[16:19], s93 offen sc1
    s_waitcnt vmcnt(3)
    v_cmp_gt_i32 vcc, s26, v115
    s_cbranch_vccz Lhk_65
    s_sub_u32 s28, s28, 1
    s_cbranch_scc0 Lhu_64
    s_branch Lfail
Lhk_65:
Lpp_66:
    buffer_load_dwordx4 v[92:95], v8, s[16:19], s47 offen sc1
    buffer_load_dwordx4 v[96:99], v8, s[16:19], s31 offen sc1
    buffer_load_dwordx4 v[100:103], v8, s[16:19], s31 offen offset:1024 sc1
    s_waitcnt vmcnt(0)
    v_max3_u32 v112, v92, v93, v94
    v_max3_u32 v112, v112, v95, v96
    v_max_u32 v112, v112, v97
    v_max3_u32 v113, v98, v99, v100
    v_max3_u32 v113, v113, v101, v102
    v_max_u32 v113, v113, v103
    v_max_u32 v112, v112, v113
    v_cmp_eq_u32 vcc, -1, v112
    s_cbranch_vccz Lok_67
    s_sub_u32 s28, s28, 1
    s_cbranch_scc0 Lpp_66
    s_branch Lfail
Lok_67:
    v_smfmac_f32_16x16x64_bf16 v[104:107], v[92:95], v[32:39], v2
    v_smfmac_f32_16x16x64_bf16 v[108:111], v[92:95], v[40:47], v2
    v_smfmac_f32_16x16x64_bf16 v[104:107], v[96:99], v[48:55], v2
    v_smfmac_f32_16x16x64_bf16 v[108:111], v[96:99], v[56:63], v2
    v_smfmac_f32_16x16x64_bf16 v[104:107], v[100:103], v[64:71], v2
    v_smfmac_f32_16x16x64_bf16 v[108:111], v[100:103], v[72:79], v2
    s_nop 7
    v_permlane32_swap_b32 v104, v108
    v_permlane32_swap_b32 v105, v109
    v_permlane32_swap_b32 v106, v110
    v_permlane32_swap_b32 v107, v111
    v_pk_add_f32 v[104:105], v[104:105], v[108:109]
    v_pk_add_f32 v[106:107], v[106:107], v[110:111]
    ds_write_b128 v10, v[104:107]
    s_waitcnt lgkmcnt(0)
    s_barrier
    ds_read_b64 v[112:113], v11 offset:0
    ds_read_b64 v[114:115], v11 offset:1024
    ds_read_b64 v[116:117], v11 offset:2048
    ds_read_b64 v[118:119], v11 offset:3072
    s_add_u32 s33, s29, 7168
    s_cmp_eq_u32 s27, 0
    s_waitcnt lgkmcnt(2)
    v_pk_add_f32 v[112:113], v[112:113], v[114:115]
    s_waitcnt lgkmcnt(0)
    v_pk_add_f32 v[116:117], v[116:117], v[118:119]
    v_pk_add_f32 v[112:113], v[112:113], v[116:117]
    v_cvt_pk_bf16_f32 v104, v112, v113
    s_cbranch_scc0 Lslow_68
    buffer_store_dword v104, v12, s[16:19], s33 offen
Lback_69:
    s_add_u32 s26, s26, 1
    s_add_u32 s29, s29, 7168
    s_add_u32 s30, s30, 7168
    s_add_u32 s45, s45, 7168
    s_add_u32 s31, s31, 12288
    s_add_u32 s47, s47, 12288
    s_add_u32 s42, s42, 458752
    s_add_u32 s43, s43, 458752
    s_add_u32 s44, s44, 229376
    s_add_u32 s88, s88, 0
    s_cmp_lt_u32 s26, 63
    s_cbranch_scc1 Lva_58
    s_branch Ldone
Lva2:
Lva_70:
    ds_read_b128 v[16:19], v6 offset:0
    ds_read_b128 v[20:23], v6 offset:1024
    ds_read_b128 v[24:27], v6 offset:2048
    ds_read_b128 v[28:31], v6 offset:3072
    s_sleep 4
Lpm_72:
    buffer_load_dwordx4 v[48:51], v3, s[16:19], s29 offen sc1
    buffer_load_dwordx4 v[52:55], v3, s[16:19], s30 offen sc1
    s_waitcnt vmcnt(0)
    ds_write_b128 v4, v[48:51] offset:0
    ds_write_b128 v4, v[52:55] offset:6144
    v_max3_u32 v80, v48, v49, v50
    v_max_u32 v80, v80, v51
    v_max3_u32 v81, v52, v53, v54
    v_max_u32 v81, v81, v55
    v_max_u32 v80, v80, v81
    v_cmp_eq_u32 vcc, -1, v80
    s_cbranch_vccz Lok_73
    s_sub_u32 s28, s28, 1
    s_cbranch_scc0 Lpm_72
    s_branch Lfail
Lok_73:
Lmc_71:
    s_waitcnt lgkmcnt(0)
    s_barrier
    ds_read_b64_tr_b16 v[92:93], v5 offset:0
    ds_read_b64_tr_b16 v[94:95], v5 offset:128
    ds_read_b64_tr_b16 v[96:97], v5 offset:1536
    ds_read_b64_tr_b16 v[98:99], v5 offset:1664
    ds_read_b64_tr_b16 v[100:101], v5 offset:3072
    ds_read_b64_tr_b16 v[102:103], v5 offset:3200
    ds_read_b64_tr_b16 v[104:105], v5 offset:4608
    ds_read_b64_tr_b16 v[106:107], v5 offset:4736
    ds_read_b64_tr_b16 v[108:109], v5 offset:6144
    ds_read_b64_tr_b16 v[110:111], v5 offset:6272
    ds_read_b64_tr_b16 v[112:113], v5 offset:7680
    ds_read_b64_tr_b16 v[114:115], v5 offset:7808
    ds_read_b64_tr_b16 v[116:117], v5 offset:9216
    ds_read_b64_tr_b16 v[118:119], v5 offset:9344
    v_mov_b32 v80, 0
    v_mov_b32 v81, 0
    v_mov_b32 v82, 0
    v_mov_b32 v83, 0
    v_mov_b32 v84, 0
    v_mov_b32 v85, 0
    v_mov_b32 v86, 0
    v_mov_b32 v87, 0
    v_mov_b32 v88, 0
    v_mov_b32 v89, 0
    v_mov_b32 v90, 0
    v_mov_b32 v91, 0
    s_waitcnt lgkmcnt(12)
    v_smfmac_f32_16x16x64_bf16 v[80:83], v[92:95], a[0:7], v2
    v_cmp_ge_i32 vcc, s26, v1
    s_cbranch_vccnz Lfvx_74
Lfvb_75:
    buffer_load_dword v1, v14, s[16:19], s88 offen sc1
    s_waitcnt lgkmcnt(10)
    v_smfmac_f32_16x16x64_bf16 v[80:83], v[96:99], a[8:15], v2
    s_waitcnt lgkmcnt(8)
    v_smfmac_f32_16x16x64_bf16 v[80:83], v[100:103], a[16:23], v2
    buffer_load_dwordx4 v[48:51], v7, s[16:19], s42 offen offset:0 sc1
    s_waitcnt lgkmcnt(6)
    v_smfmac_f32_16x16x64_bf16 v[80:83], v[104:107], a[24:31], v2
    s_waitcnt lgkmcnt(4)
    v_smfmac_f32_16x16x64_bf16 v[80:83], v[108:111], a[32:39], v2
    s_waitcnt lgkmcnt(2)
    v_smfmac_f32_16x16x64_bf16 v[80:83], v[112:115], a[40:47], v2
    buffer_load_dwordx4 v[52:55], v7, s[16:19], s42 offen offset:1024 sc1
    s_waitcnt lgkmcnt(0)
    v_smfmac_f32_16x16x64_bf16 v[80:83], v[116:119], a[48:55], v2
    v_smfmac_f32_16x16x64_bf16 v[88:91], v[92:95], a[56:63], v2
    v_smfmac_f32_16x16x64_bf16 v[88:91], v[96:99], a[64:71], v2
    buffer_load_dwordx4 v[56:59], v7, s[16:19], s42 offen offset:2048 sc1
    v_smfmac_f32_16x16x64_bf16 v[84:87], v[92:95], v[16:23], v2
    ds_read_b128 v[16:19], v6 offset:4096
    ds_read_b128 v[20:23], v6 offset:5120
    v_smfmac_f32_16x16x64_bf16 v[88:91], v[100:103], a[72:79], v2
    s_nop 0
    v_cvt_pk_bf16_f32 v32, v80, v81
    v_cvt_pk_bf16_f32 v33, v82, v83
    v_smfmac_f32_16x16x64_bf16 v[88:91], v[104:107], a[80:87], v2
    v_mov_b32 v80, 0
    v_mov_b32 v81, 0
    v_smfmac_f32_16x16x64_bf16 v[84:87], v[96:99], v[24:31], v2
    buffer_load_dwordx4 v[60:63], v7, s[16:19], s42 offen offset:3072 sc1
    ds_read_b128 v[24:27], v6 offset:6144
    ds_read_b128 v[28:31], v6 offset:7168
    v_mov_b32 v82, 0
    v_mov_b32 v83, 0
    v_smfmac_f32_16x16x64_bf16 v[88:91], v[108:111], a[88:95], v2
    v_smfmac_f32_16x16x64_bf16 v[88:91], v[112:115], a[96:103], v2
    s_waitcnt lgkmcnt(2)
    v_smfmac_f32_16x16x64_bf16 v[84:87], v[100:103], v[16:23], v2
    ds_read_b128 v[16:19], v6 offset:8192
    ds_read_b128 v[20:23], v6 offset:9216
    v_smfmac_f32_16x16x64_bf16 v[88:91], v[116:119], a[104:111], v2
    buffer_load_dwordx4 v[64:67], v7, s[16:19], s43 offen offset:0 sc1
    v_smfmac_f32_16x16x64_bf16 v[80:83], v[92:95], a[112:119], v2
    s_waitcnt lgkmcnt(2)
    v_smfmac_f32_16x16x64_bf16 v[84:87], v[104:107], v[24:31], v2
    ds_read_b128 v[24:27], v6 offset:10240
    ds_read_b128 v[28:31], v6 offset:11264
    v_smfmac_f32_16x16x64_bf16 v[80:83], v[96:99], a[120:127], v2
    v_smfmac_f32_16x16x64_bf16 v[80:83], v[100:103], a[128:135], v2
    buffer_load_dwordx4 v[68:71], v7, s[16:19], s43 offen offset:1024 sc1
    v_cvt_pk_bf16_f32 v34, v88, v89
    v_cvt_pk_bf16_f32 v35, v90, v91
    s_waitcnt lgkmcnt(2)
    v_smfmac_f32_16x16x64_bf16 v[84:87], v[108:111], v[16:23], v2
    ds_read_b128 v[16:19], v6 offset:12288
    ds_read_b128 v[20:23], v6 offset:13312
    v_mov_b32 v88, 0
    v_mov_b32 v89, 0
    v_smfmac_f32_16x16x64_bf16 v[80:83], v[104:107], a[136:143], v2
    v_mov_b32 v90, 0
    v_mov_b32 v91, 0
    v_smfmac_f32_16x16x64_bf16 v[80:83], v[108:111], a[144:151], v2
    s_waitcnt lgkmcnt(2)
    v_smfmac_f32_16x16x64_bf16 v[84:87], v[112:115], v[24:31], v2
    buffer_load_dwordx4 v[72:75], v7, s[16:19], s43 offen offset:2048 sc1
    v_smfmac_f32_16x16x64_bf16 v[80:83], v[112:115], a[152:159], v2
    v_smfmac_f32_16x16x64_bf16 v[80:83], v[116:119], a[160:167], v2
    s_waitcnt lgkmcnt(0)
    v_smfmac_f32_16x16x64_bf16 v[84:87], v[116:119], v[16:23], v2
    v_smfmac_f32_16x16x64_bf16 v[88:91], v[92:95], a[168:175], v2
    buffer_load_dwordx4 v[76:79], v7, s[16:19], s43 offen offset:3072 sc1
    v_smfmac_f32_16x16x64_bf16 v[88:91], v[96:99], a[176:183], v2
    v_smfmac_f32_16x16x64_bf16 v[88:91], v[100:103], a[184:191], v2
    s_nop 1
    v_cvt_pk_bf16_f32 v42, v80, v81
    v_cvt_pk_bf16_f32 v43, v82, v83
    v_smfmac_f32_16x16x64_bf16 v[88:91], v[104:107], a[192:199], v2
    v_cvt_pk_bf16_f32 v40, v84, v85
    v_cvt_pk_bf16_f32 v41, v86, v87
    v_mov_b32 v80, 0
    v_mov_b32 v81, 0
    v_smfmac_f32_16x16x64_bf16 v[88:91], v[108:111], a[200:207], v2
    v_mov_b32 v84, 0
    v_mov_b32 v85, 0
    v_mov_b32 v82, 0
    v_mov_b32 v83, 0
    v_smfmac_f32_16x16x64_bf16 v[88:91], v[112:115], a[208:215], v2
    v_mov_b32 v86, 0
    v_mov_b32 v87, 0
    v_smfmac_f32_16x16x64_bf16 v[88:91], v[116:119], a[216:223], v2
    v_smfmac_f32_16x16x64_bf16 v[80:83], v[92:95], a[224:231], v2
    v_smfmac_f32_16x16x64_bf16 v[80:83], v[96:99], a[232:239], v2
    v_smfmac_f32_16x16x64_bf16 v[80:83], v[100:103], a[240:247], v2
    v_smfmac_f32_16x16x64_bf16 v[80:83], v[104:107], a[248:255], v2
    s_nop 3
    v_cvt_pk_bf16_f32 v36, v88, v89
    v_cvt_pk_bf16_f32 v37, v90, v91
    v_smfmac_f32_16x16x64_bf16 v[80:83], v[108:111], v[120:127], v2
    v_mov_b32 v88, 0
    v_mov_b32 v89, 0
    v_smfmac_f32_16x16x64_bf16 v[80:83], v[112:115], v[128:135], v2
    v_mov_b32 v90, 0
    v_mov_b32 v91, 0
    v_smfmac_f32_16x16x64_bf16 v[80:83], v[116:119], v[136:143], v2
    v_smfmac_f32_16x16x64_bf16 v[84:87], v[92:95], v[144:151], v2
    v_smfmac_f32_16x16x64_bf16 v[84:87], v[96:99], v[152:159], v2
    v_smfmac_f32_16x16x64_bf16 v[84:87], v[100:103], v[160:167], v2
    v_smfmac_f32_16x16x64_bf16 v[84:87], v[104:107], v[168:175], v2
    s_nop 3
    v_cvt_pk_bf16_f32 v44, v80, v81
    v_cvt_pk_bf16_f32 v45, v82, v83
    v_smfmac_f32_16x16x64_bf16 v[84:87], v[108:111], v[176:183], v2
    v_smfmac_f32_16x16x64_bf16 v[84:87], v[112:115], v[184:191], v2
    v_smfmac_f32_16x16x64_bf16 v[84:87], v[116:119], v[192:199], v2
    v_smfmac_f32_16x16x64_bf16 v[88:91], v[92:95], v[200:207], v2
    v_smfmac_f32_16x16x64_bf16 v[88:91], v[96:99], v[208:215], v2
    v_smfmac_f32_16x16x64_bf16 v[88:91], v[100:103], v[216:223], v2
    v_smfmac_f32_16x16x64_bf16 v[88:91], v[104:107], v[224:231], v2
    s_nop 3
    v_cvt_pk_bf16_f32 v38, v84, v85
    v_cvt_pk_bf16_f32 v39, v86, v87
    v_smfmac_f32_16x16x64_bf16 v[88:91], v[108:111], v[232:239], v2
    v_smfmac_f32_16x16x64_bf16 v[88:91], v[112:115], v[240:247], v2
    v_smfmac_f32_16x16x64_bf16 v[88:91], v[116:119], v[248:255], v2
    v_mov_b32 v104, 0
    v_mov_b32 v105, 0
    v_mov_b32 v106, 0
    v_mov_b32 v107, 0
    v_mov_b32 v108, 0
    v_mov_b32 v109, 0
    v_mov_b32 v110, 0
    v_mov_b32 v111, 0
    v_cvt_pk_bf16_f32 v46, v88, v89
    v_cvt_pk_bf16_f32 v47, v90, v91
    s_sleep 2
    s_waitcnt vmcnt(0)
    buffer_load_dword v112, v9, s[16:19], s93 offen sc1
    s_nop 9
    buffer_load_dword v113, v9, s[16:19], s93 offen sc1
    s_nop 9
    buffer_load_dword v114, v9, s[16:19], s93 offen sc1
    s_nop 9
Lhu_76:
    buffer_load_dword v115, v9, s[16:19], s93 offen sc1
    s_waitcnt vmcnt(3)
    v_cmp_gt_i32 vcc, s26, v112
    s_cbranch_vccz Lhk_77
    buffer_load_dword v112, v9, s[16:19], s93 offen sc1
    s_waitcnt vmcnt(3)
    v_cmp_gt_i32 vcc, s26, v113
    s_cbranch_vccz Lhk_77
    buffer_load_dword v113, v9, s[16:19], s93 offen sc1
    s_waitcnt vmcnt(3)
    v_cmp_gt_i32 vcc, s26, v114
    s_cbranch_vccz Lhk_77
    buffer_load_dword v114, v9, s[16:19], s93 offen sc1
    s_waitcnt vmcnt(3)
    v_cmp_gt_i32 vcc, s26, v115
    s_cbranch_vccz Lhk_77
    s_sub_u32 s28, s28, 1
    s_cbranch_scc0 Lhu_76
    s_branch Lfail
Lhk_77:
Lpp_78:
    buffer_load_dwordx4 v[92:95], v8, s[16:19], s47 offen sc1
    buffer_load_dwordx4 v[96:99], v8, s[16:19], s31 offen sc1
    buffer_load_dwordx4 v[100:103], v8, s[16:19], s31 offen offset:1024 sc1
    s_waitcnt vmcnt(0)
    v_max3_u32 v112, v92, v93, v94
    v_max3_u32 v112, v112, v95, v96
    v_max_u32 v112, v112, v97
    v_max3_u32 v113, v98, v99, v100
    v_max3_u32 v113, v113, v101, v102
    v_max_u32 v113, v113, v103
    v_max_u32 v112, v112, v113
    v_cmp_eq_u32 vcc, -1, v112
    s_cbranch_vccz Lok_79
    s_sub_u32 s28, s28, 1
    s_cbranch_scc0 Lpp_78
    s_branch Lfail
Lok_79:
    v_smfmac_f32_16x16x64_bf16 v[104:107], v[92:95], v[32:39], v2
    v_smfmac_f32_16x16x64_bf16 v[108:111], v[92:95], v[40:47], v2
    v_smfmac_f32_16x16x64_bf16 v[104:107], v[96:99], v[48:55], v2
    v_smfmac_f32_16x16x64_bf16 v[108:111], v[96:99], v[56:63], v2
    v_smfmac_f32_16x16x64_bf16 v[104:107], v[100:103], v[64:71], v2
    v_smfmac_f32_16x16x64_bf16 v[108:111], v[100:103], v[72:79], v2
    s_nop 7
    v_permlane32_swap_b32 v104, v108
    v_permlane32_swap_b32 v105, v109
    v_permlane32_swap_b32 v106, v110
    v_permlane32_swap_b32 v107, v111
    v_pk_add_f32 v[104:105], v[104:105], v[108:109]
    v_pk_add_f32 v[106:107], v[106:107], v[110:111]
    ds_write_b128 v10, v[104:107]
    s_waitcnt lgkmcnt(0)
    s_barrier
    s_add_u32 s26, s26, 1
    s_add_u32 s29, s29, 7168
    s_add_u32 s30, s30, 7168
    s_add_u32 s45, s45, 7168
    s_add_u32 s31, s31, 12288
    s_add_u32 s47, s47, 12288
    s_add_u32 s42, s42, 458752
    s_add_u32 s43, s43, 458752
    s_add_u32 s44, s44, 229376
    s_add_u32 s88, s88, 0
    s_cmp_lt_u32 s26, 63
    s_cbranch_scc1 Lva_70
    s_branch Ldone
Lva3:
Lva_80:
    ds_read_b128 v[16:19], v6 offset:0
    ds_read_b128 v[20:23], v6 offset:1024
    ds_read_b128 v[24:27], v6 offset:2048
    ds_read_b128 v[28:31], v6 offset:3072
    s_sleep 4
Lpm_82:
    buffer_load_dwordx4 v[48:51], v3, s[16:19], s29 offen sc1
    s_waitcnt vmcnt(0)
    ds_write_b128 v4, v[48:51] offset:0
    v_max_u32 v80, v48, v49
    v_max_u32 v81, v50, v51
    v_max_u32 v80, v80, v81
    v_cmp_eq_u32 vcc, -1, v80
    s_cbranch_vccz Lok_83
    s_sub_u32 s28, s28, 1
    s_cbranch_scc0 Lpm_82
    s_branch Lfail
Lok_83:
Lmc_81:
    s_waitcnt lgkmcnt(0)
    s_barrier
    ds_read_b64_tr_b16 v[92:93], v5 offset:0
    ds_read_b64_tr_b16 v[94:95], v5 offset:128
    ds_read_b64_tr_b16 v[96:97], v5 offset:1536
    ds_read_b64_tr_b16 v[98:99], v5 offset:1664
    ds_read_b64_tr_b16 v[100:101], v5 offset:3072
    ds_read_b64_tr_b16 v[102:103], v5 offset:3200
    ds_read_b64_tr_b16 v[104:105], v5 offset:4608
    ds_read_b64_tr_b16 v[106:107], v5 offset:4736
    ds_read_b64_tr_b16 v[108:109], v5 offset:6144
    ds_read_b64_tr_b16 v[110:111], v5 offset:6272
    ds_read_b64_tr_b16 v[112:113], v5 offset:7680
    ds_read_b64_tr_b16 v[114:115], v5 offset:7808
    ds_read_b64_tr_b16 v[116:117], v5 offset:9216
    ds_read_b64_tr_b16 v[118:119], v5 offset:9344
    v_mov_b32 v80, 0
    v_mov_b32 v81, 0
    v_mov_b32 v82, 0
    v_mov_b32 v83, 0
    v_mov_b32 v84, 0
    v_mov_b32 v85, 0
    v_mov_b32 v86, 0
    v_mov_b32 v87, 0
    v_mov_b32 v88, 0
    v_mov_b32 v89, 0
    v_mov_b32 v90, 0
    v_mov_b32 v91, 0
    s_waitcnt lgkmcnt(12)
    v_smfmac_f32_16x16x64_bf16 v[80:83], v[92:95], a[0:7], v2
    v_cmp_ge_i32 vcc, s26, v1
    s_cbranch_vccnz Lfvx_84
Lfvb_85:
    buffer_load_dword v1, v14, s[16:19], s88 offen sc1
    s_waitcnt lgkmcnt(10)
    v_smfmac_f32_16x16x64_bf16 v[80:83], v[96:99], a[8:15], v2
    s_waitcnt lgkmcnt(8)
    v_smfmac_f32_16x16x64_bf16 v[80:83], v[100:103], a[16:23], v2
    buffer_load_dwordx4 v[48:51], v7, s[16:19], s42 offen offset:0 sc1
    s_waitcnt lgkmcnt(6)
    v_smfmac_f32_16x16x64_bf16 v[80:83], v[104:107], a[24:31], v2
    s_waitcnt lgkmcnt(4)
    v_smfmac_f32_16x16x64_bf16 v[80:83], v[108:111], a[32:39], v2
    s_waitcnt lgkmcnt(2)
    v_smfmac_f32_16x16x64_bf16 v[80:83], v[112:115], a[40:47], v2
    buffer_load_dwordx4 v[52:55], v7, s[16:19], s42 offen offset:1024 sc1
    s_waitcnt lgkmcnt(0)
    v_smfmac_f32_16x16x64_bf16 v[80:83], v[116:119], a[48:55], v2
    v_smfmac_f32_16x16x64_bf16 v[88:91], v[92:95], a[56:63], v2
    v_smfmac_f32_16x16x64_bf16 v[88:91], v[96:99], a[64:71], v2
    buffer_load_dwordx4 v[56:59], v7, s[16:19], s42 offen offset:2048 sc1
    v_smfmac_f32_16x16x64_bf16 v[84:87], v[92:95], v[16:23], v2
    ds_read_b128 v[16:19], v6 offset:4096
    ds_read_b128 v[20:23], v6 offset:5120
    v_smfmac_f32_16x16x64_bf16 v[88:91], v[100:103], a[72:79], v2
    s_nop 0
    v_cvt_pk_bf16_f32 v32, v80, v81
    v_cvt_pk_bf16_f32 v33, v82, v83
    v_smfmac_f32_16x16x64_bf16 v[88:91], v[104:107], a[80:87], v2
    v_mov_b32 v80, 0
    v_mov_b32 v81, 0
    v_smfmac_f32_16x16x64_bf16 v[84:87], v[96:99], v[24:31], v2
    buffer_load_dwordx4 v[60:63], v7, s[16:19], s42 offen offset:3072 sc1
    ds_read_b128 v[24:27], v6 offset:6144
    ds_read_b128 v[28:31], v6 offset:7168
    v_mov_b32 v82, 0
    v_mov_b32 v83, 0
    v_smfmac_f32_16x16x64_bf16 v[88:91], v[108:111], a[88:95], v2
    v_smfmac_f32_16x16x64_bf16 v[88:91], v[112:115], a[96:103], v2
    s_waitcnt lgkmcnt(2)
    v_smfmac_f32_16x16x64_bf16 v[84:87], v[100:103], v[16:23], v2
    ds_read_b128 v[16:19], v6 offset:8192
    ds_read_b128 v[20:23], v6 offset:9216
    v_smfmac_f32_16x16x64_bf16 v[88:91], v[116:119], a[104:111], v2
    buffer_load_dwordx4 v[64:67], v7, s[16:19], s43 offen offset:0 sc1
    v_smfmac_f32_16x16x64_bf16 v[80:83], v[92:95], a[112:119], v2
    s_waitcnt lgkmcnt(2)
    v_smfmac_f32_16x16x64_bf16 v[84:87], v[104:107], v[24:31], v2
    ds_read_b128 v[24:27], v6 offset:10240
    ds_read_b128 v[28:31], v6 offset:11264
    v_smfmac_f32_16x16x64_bf16 v[80:83], v[96:99], a[120:127], v2
    v_smfmac_f32_16x16x64_bf16 v[80:83], v[100:103], a[128:135], v2
    buffer_load_dwordx4 v[68:71], v7, s[16:19], s43 offen offset:1024 sc1
    v_cvt_pk_bf16_f32 v34, v88, v89
    v_cvt_pk_bf16_f32 v35, v90, v91
    s_waitcnt lgkmcnt(2)
    v_smfmac_f32_16x16x64_bf16 v[84:87], v[108:111], v[16:23], v2
    ds_read_b128 v[16:19], v6 offset:12288
    ds_read_b128 v[20:23], v6 offset:13312
    v_mov_b32 v88, 0
    v_mov_b32 v89, 0
    v_smfmac_f32_16x16x64_bf16 v[80:83], v[104:107], a[136:143], v2
    v_mov_b32 v90, 0
    v_mov_b32 v91, 0
    v_smfmac_f32_16x16x64_bf16 v[80:83], v[108:111], a[144:151], v2
    s_waitcnt lgkmcnt(2)
    v_smfmac_f32_16x16x64_bf16 v[84:87], v[112:115], v[24:31], v2
    buffer_load_dwordx4 v[72:75], v7, s[16:19], s43 offen offset:2048 sc1
    v_smfmac_f32_16x16x64_bf16 v[80:83], v[112:115], a[152:159], v2
    v_smfmac_f32_16x16x64_bf16 v[80:83], v[116:119], a[160:167], v2
    s_waitcnt lgkmcnt(0)
    v_smfmac_f32_16x16x64_bf16 v[84:87], v[116:119], v[16:23], v2
    v_smfmac_f32_16x16x64_bf16 v[88:91], v[92:95], a[168:175], v2
    buffer_load_dwordx4 v[76:79], v7, s[16:19], s43 offen offset:3072 sc1
    v_smfmac_f32_16x16x64_bf16 v[88:91], v[96:99], a[176:183], v2
    v_smfmac_f32_16x16x64_bf16 v[88:91], v[100:103], a[184:191], v2
    s_nop 1
    v_cvt_pk_bf16_f32 v42, v80, v81
    v_cvt_pk_bf16_f32 v43, v82, v83
    v_smfmac_f32_16x16x64_bf16 v[88:91], v[104:107], a[192:199], v2
    v_cvt_pk_bf16_f32 v40, v84, v85
    v_cvt_pk_bf16_f32 v41, v86, v87
    v_mov_b32 v80, 0
    v_mov_b32 v81, 0
    v_smfmac_f32_16x16x64_bf16 v[88:91], v[108:111], a[200:207], v2
    v_mov_b32 v84, 0
    v_mov_b32 v85, 0
    v_mov_b32 v82, 0
    v_mov_b32 v83, 0
    v_smfmac_f32_16x16x64_bf16 v[88:91], v[112:115], a[208:215], v2
    v_mov_b32 v86, 0
    v_mov_b32 v87, 0
    v_smfmac_f32_16x16x64_bf16 v[88:91], v[116:119], a[216:223], v2
    v_smfmac_f32_16x16x64_bf16 v[80:83], v[92:95], a[224:231], v2
    v_smfmac_f32_16x16x64_bf16 v[80:83], v[96:99], a[232:239], v2
    v_smfmac_f32_16x16x64_bf16 v[80:83], v[100:103], a[240:247], v2
    v_smfmac_f32_16x16x64_bf16 v[80:83], v[104:107], a[248:255], v2
    s_nop 3
    v_cvt_pk_bf16_f32 v36, v88, v89
    v_cvt_pk_bf16_f32 v37, v90, v91
    v_smfmac_f32_16x16x64_bf16 v[80:83], v[108:111], v[120:127], v2
    v_mov_b32 v88, 0
    v_mov_b32 v89, 0
    v_smfmac_f32_16x16x64_bf16 v[80:83], v[112:115], v[128:135], v2
    v_mov_b32 v90, 0
    v_mov_b32 v91, 0
    v_smfmac_f32_16x16x64_bf16 v[80:83], v[116:119], v[136:143], v2
    v_smfmac_f32_16x16x64_bf16 v[84:87], v[92:95], v[144:151], v2
    v_smfmac_f32_16x16x64_bf16 v[84:87], v[96:99], v[152:159], v2
    v_smfmac_f32_16x16x64_bf16 v[84:87], v[100:103], v[160:167], v2
    v_smfmac_f32_16x16x64_bf16 v[84:87], v[104:107], v[168:175], v2
    s_nop 3
    v_cvt_pk_bf16_f32 v44, v80, v81
    v_cvt_pk_bf16_f32 v45, v82, v83
    v_smfmac_f32_16x16x64_bf16 v[84:87], v[108:111], v[176:183], v2
    v_smfmac_f32_16x16x64_bf16 v[84:87], v[112:115], v[184:191], v2
    v_smfmac_f32_16x16x64_bf16 v[84:87], v[116:119], v[192:199], v2
    v_smfmac_f32_16x16x64_bf16 v[88:91], v[92:95], v[200:207], v2
    v_smfmac_f32_16x16x64_bf16 v[88:91], v[96:99], v[208:215], v2
    v_smfmac_f32_16x16x64_bf16 v[88:91], v[100:103], v[216:223], v2
    v_smfmac_f32_16x16x64_bf16 v[88:91], v[104:107], v[224:231], v2
    s_nop 3
    v_cvt_pk_bf16_f32 v38, v84, v85
    v_cvt_pk_bf16_f32 v39, v86, v87
    v_smfmac_f32_16x16x64_bf16 v[88:91], v[108:111], v[232:239], v2
    v_smfmac_f32_16x16x64_bf16 v[88:91], v[112:115], v[240:247], v2
    v_smfmac_f32_16x16x64_bf16 v[88:91], v[116:119], v[248:255], v2
    v_mov_b32 v104, 0
    v_mov_b32 v105, 0
    v_mov_b32 v106, 0
    v_mov_b32 v107, 0
    v_mov_b32 v108, 0
    v_mov_b32 v109, 0
    v_mov_b32 v110, 0
    v_mov_b32 v111, 0
    v_cvt_pk_bf16_f32 v46, v88, v89
    v_cvt_pk_bf16_f32 v47, v90, v91
    s_sleep 2
    s_waitcnt vmcnt(0)
    buffer_load_dword v112, v9, s[16:19], s93 offen sc1
    s_nop 9
    buffer_load_dword v113, v9, s[16:19], s93 offen sc1
    s_nop 9
    buffer_load_dword v114, v9, s[16:19], s93 offen sc1
    s_nop 9
Lhu_86:
    buffer_load_dword v115, v9, s[16:19], s93 offen sc1
    s_waitcnt vmcnt(3)
    v_cmp_gt_i32 vcc, s26, v112
    s_cbranch_vccz Lhk_87
    buffer_load_dword v112, v9, s[16:19], s93 offen sc1
    s_waitcnt vmcnt(3)
    v_cmp_gt_i32 vcc, s26, v113
    s_cbranch_vccz Lhk_87
    buffer_load_dword v113, v9, s[16:19], s93 offen sc1
    s_waitcnt vmcnt(3)
    v_cmp_gt_i32 vcc, s26, v114
    s_cbranch_vccz Lhk_87
    buffer_load_dword v114, v9, s[16:19], s93 offen sc1
    s_waitcnt vmcnt(3)
    v_cmp_gt_i32 vcc, s26, v115
    s_cbranch_vccz Lhk_87
    s_sub_u32 s28, s28, 1
    s_cbranch_scc0 Lhu_86
    s_branch Lfail
Lhk_87:
Lpp_88:
    buffer_load_dwordx4 v[92:95], v8, s[16:19], s47 offen sc1
    buffer_load_dwordx4 v[96:99], v8, s[16:19], s31 offen sc1
    buffer_load_dwordx4 v[100:103], v8, s[16:19], s31 offen offset:1024 sc1
    s_waitcnt vmcnt(0)
    v_max3_u32 v112, v92, v93, v94
    v_max3_u32 v112, v112, v95, v96
    v_max_u32 v112, v112, v97
    v_max3_u32 v113, v98, v99, v100
    v_max3_u32 v113, v113, v101, v102
    v_max_u32 v113, v113, v103
    v_max_u32 v112, v112, v113
    v_cmp_eq_u32 vcc, -1, v112
    s_cbranch_vccz Lok_89
    s_sub_u32 s28, s28, 1
    s_cbranch_scc0 Lpp_88
    s_branch Lfail
Lok_89:
    v_smfmac_f32_16x16x64_bf16 v[104:107], v[92:95], v[32:39], v2
    v_smfmac_f32_16x16x64_bf16 v[108:111], v[92:95], v[40:47], v2
    v_smfmac_f32_16x16x64_bf16 v[104:107], v[96:99], v[48:55], v2
    v_smfmac_f32_16x16x64_bf16 v[108:111], v[96:99], v[56:63], v2
    v_smfmac_f32_16x16x64_bf16 v[104:107], v[100:103], v[64:71], v2
    v_smfmac_f32_16x16x64_bf16 v[108:111], v[100:103], v[72:79], v2
    s_nop 7
    v_permlane32_swap_b32 v104, v108
    v_permlane32_swap_b32 v105, v109
    v_permlane32_swap_b32 v106, v110
    v_permlane32_swap_b32 v107, v111
    v_pk_add_f32 v[104:105], v[104:105], v[108:109]
    v_pk_add_f32 v[106:107], v[106:107], v[110:111]
    ds_write_b128 v10, v[104:107]
    s_waitcnt lgkmcnt(0)
    s_barrier
    v_mov_b32 v11, s26
    s_cmp_eq_u32 s27, 0
    s_mov_b64 exec, 1
    s_cbranch_scc0 Lslow_90
    buffer_store_dword v11, v12, s[16:19], s95 offen
Lback_91:
    s_mov_b64 exec, -1
    s_add_u32 s26, s26, 1
    s_add_u32 s29, s29, 7168
    s_add_u32 s30, s30, 7168
    s_add_u32 s45, s45, 7168
    s_add_u32 s31, s31, 12288
    s_add_u32 s47, s47, 12288
    s_add_u32 s42, s42, 458752
    s_add_u32 s43, s43, 458752
    s_add_u32 s44, s44, 229376
    s_add_u32 s88, s88, 0
    s_cmp_lt_u32 s26, 63
    s_cbranch_scc1 Lva_80
    s_branch Ldone
Lbridge:
    v_lshlrev_b32 v3, 4, v0
    s_mov_b32 s26, 0
    s_mov_b32 s29, 13631488
    s_mov_b32 s30, 13635584
    s_mov_b32 s45, 14155776
    s_mov_b32 s34, 14159872
    s_cmp_eq_u32 s24, 3
    s_cbranch_scc1 Lbr3
Lbr:
Lbp_92:
    buffer_load_dwordx4 v[20:23], v3, s[16:19], s29 offen sc1
    buffer_load_dwordx4 v[24:27], v3, s[16:19], s30 offen sc1
    s_waitcnt vmcnt(0)
    v_max3_u32 v28, v20, v21, v22
    v_max_u32 v28, v28, v23
    v_max3_u32 v29, v24, v25, v26
    v_max_u32 v29, v29, v27
    v_max_u32 v28, v28, v29
    v_cmp_eq_u32 vcc, -1, v28
    s_cbranch_vccz Lok_93
    s_sleep 1
    s_sub_u32 s28, s28, 1
    s_cbranch_scc0 Lbp_92
    s_branch Lfail
Lok_93:
    buffer_store_dwordx4 v[20:23], v3, s[16:19], s45 offen sc1
    buffer_store_dwordx4 v[24:27], v3, s[16:19], s34 offen sc1
    s_add_u32 s26, s26, 1
    s_add_u32 s29, s29, 7168
    s_add_u32 s30, s30, 7168
    s_add_u32 s45, s45, 7168
    s_add_u32 s34, s34, 7168
    s_cmp_lt_u32 s26, 64
    s_cbranch_scc1 Lbr
    s_branch Ldone
Lbr3:
Lbp_94:
    buffer_load_dwordx4 v[20:23], v3, s[16:19], s29 offen sc1
    s_waitcnt vmcnt(0)
    v_max_u32 v28, v20, v21
    v_max_u32 v29, v22, v23
    v_max_u32 v28, v28, v29
    v_cmp_eq_u32 vcc, -1, v28
    s_cbranch_vccz Lok_95
    s_sleep 1
    s_sub_u32 s28, s28, 1
    s_cbranch_scc0 Lbp_94
    s_branch Lfail
Lok_95:
    buffer_store_dwordx4 v[20:23], v3, s[16:19], s45 offen sc1
    s_add_u32 s26, s26, 1
    s_add_u32 s29, s29, 7168
    s_add_u32 s30, s30, 7168
    s_add_u32 s45, s45, 7168
    s_add_u32 s34, s34, 7168
    s_cmp_lt_u32 s26, 64
    s_cbranch_scc1 Lbr3
    s_branch Ldone
Ltracker:
    s_cmp_eq_u32 s24, 0
    s_cbranch_scc0 Ldone
    v_and_b32 v3, 15, v0
    v_lshlrev_b32 v3, 6, v3
    v_mov_b32 v4, 0
    s_mov_b32 s26, 0
    s_mov_b32 s29, 15532032
    s_mov_b32 s30, 15469568
Ltr:
    buffer_load_dword v20, v3, s[16:19], s29 offen sc1
    s_waitcnt vmcnt(0)
    v_cmp_eq_u32 vcc, -1, v20
    s_cbranch_vccz Ltr_ok
    s_sleep 2
    s_sub_u32 s28, s28, 1
    s_cbranch_scc0 Ltr
    s_branch Lfail
Ltr_ok:
    s_add_u32 s26, s26, 1
    s_add_u32 s29, s29, 1024
    v_mov_b32 v21, s26
    s_mov_b64 exec, 1
    buffer_store_dword v21, v4, s[16:19], s30 offen sc1
    s_mov_b64 exec, -1
    s_cmp_lt_u32 s26, 64
    s_cbranch_scc1 Ltr
    s_branch Ldone
Lexact_32:
    v_max3_f32 v22, v44, v45, v46
    v_max_f32 v22, v22, v47
    v_mov_b32 v23, v22
    s_nop 1
    v_permlane16_swap_b32 v22, v23
    v_max_f32 v22, v22, v23
    v_mov_b32 v23, v22
    s_nop 1
    v_permlane32_swap_b32 v22, v23
    v_max_f32 v22, v22, v23
    v_sub_f32 v24, v44, v22
    v_sub_f32 v25, v45, v22
    v_sub_f32 v26, v46, v22
    v_sub_f32 v27, v47, v22
    v_exp_f32 v24, v24
    v_exp_f32 v25, v25
    v_exp_f32 v26, v26
    v_exp_f32 v27, v27
    v_add_f32 v28, v24, v25
    v_add_f32 v23, v26, v27
    v_add_f32 v23, v23, v28
    v_mov_b32 v28, v23
    s_nop 1
    v_permlane16_swap_b32 v23, v28
    v_add_f32 v23, v23, v28
    v_mov_b32 v28, v23
    s_nop 1
    v_permlane32_swap_b32 v23, v28
    v_add_f32 v23, v23, v28
    s_mov_b64 exec, 0xff
    ds_write_b64 v11, v[22:23]
    s_mov_b64 exec, -1
    s_waitcnt lgkmcnt(0)
    s_barrier
    ds_read_b128 v[30:33], v12
    ds_read_b64 v[34:35], v12 offset:16
    s_waitcnt lgkmcnt(0)
    v_max3_f32 v36, v30, v32, v34
    v_sub_f32 v37, v30, v36
    v_sub_f32 v38, v32, v36
    v_sub_f32 v39, v34, v36
    v_sub_f32 v40, v22, v36
    v_exp_f32 v37, v37
    v_exp_f32 v38, v38
    v_exp_f32 v39, v39
    v_exp_f32 v40, v40
    v_mul_f32 v36, v31, v37
    v_fmac_f32 v36, v33, v38
    v_fmac_f32 v36, v35, v39
    v_rcp_f32 v36, v36
    s_nop 0
    v_mul_f32 v36, v36, v40
    v_mul_f32 v24, v24, v36
    v_mul_f32 v25, v25, v36
    v_mul_f32 v26, v26, v36
    v_mul_f32 v27, v27, v36
    s_branch Lexb_33
Lexact_41:
    v_max_f32 v22, v44, v46
    v_mov_b32 v23, v22
    s_nop 1
    v_permlane16_swap_b32 v22, v23
    v_max_f32 v22, v22, v23
    v_mov_b32 v23, v22
    s_nop 1
    v_permlane32_swap_b32 v22, v23
    v_max_f32 v22, v22, v23
    v_sub_f32 v24, v44, v22
    v_sub_f32 v25, v46, v22
    v_exp_f32 v24, v24
    v_exp_f32 v25, v25
    s_nop 0
    v_add_f32 v23, v24, v25
    v_mov_b32 v28, v23
    s_nop 1
    v_permlane16_swap_b32 v23, v28
    v_add_f32 v23, v23, v28
    v_mov_b32 v28, v23
    s_nop 1
    v_permlane32_swap_b32 v23, v28
    v_add_f32 v23, v23, v28
    s_mov_b64 exec, 0xff
    ds_write_b64 v11, v[22:23]
    s_mov_b64 exec, -1
    s_waitcnt lgkmcnt(0)
    s_barrier
    ds_read_b128 v[30:33], v12
    ds_read_b64 v[34:35], v12 offset:16
    s_waitcnt lgkmcnt(0)
    v_max3_f32 v36, v30, v32, v34
    v_sub_f32 v37, v30, v36
    v_sub_f32 v38, v32, v36
    v_sub_f32 v39, v34, v36
    v_sub_f32 v40, v22, v36
    v_exp_f32 v37, v37
    v_exp_f32 v38, v38
    v_exp_f32 v39, v39
    v_exp_f32 v40, v40
    v_mul_f32 v36, v31, v37
    v_fmac_f32 v36, v33, v38
    v_fmac_f32 v36, v35, v39
    v_rcp_f32 v36, v36
    s_nop 0
    v_mul_f32 v36, v36, v40
    v_mul_f32 v24, v24, v36
    v_mul_f32 v25, v25, v36
    s_branch Lexb_42
Lexact_52:
    s_barrier
    s_branch Lexb_53
Lslow_34:
    buffer_store_dwordx2 v[20:21], v13, s[16:19], s31 offen sc1
    s_branch Lback_35
Lslow_43:
    buffer_store_dword v20, v13, s[16:19], s31 offen sc1
    s_branch Lback_44
Lslow_50:
    buffer_store_dword v43, v42, s[16:19], s95 offen sc1
    s_branch Lback_51
Lslow_68:
    buffer_store_dword v104, v12, s[16:19], s33 offen sc1
    s_branch Lback_69
Lslow_90:
    buffer_store_dword v11, v12, s[16:19], s95 offen sc1
    s_branch Lback_91
Lfvx_62:
    s_sleep 2
    buffer_load_dword v1, v14, s[16:19], s88 offen sc1
    s_waitcnt vmcnt(0)
    v_cmp_ge_i32 vcc, s26, v1
    s_cbranch_vccz Lfvb_63
    s_sub_u32 s28, s28, 1
    s_cbranch_scc0 Lfvx_62
    s_branch Lfail
Lfvx_74:
    s_sleep 2
    buffer_load_dword v1, v14, s[16:19], s88 offen sc1
    s_waitcnt vmcnt(0)
    v_cmp_ge_i32 vcc, s26, v1
    s_cbranch_vccz Lfvb_75
    s_sub_u32 s28, s28, 1
    s_cbranch_scc0 Lfvx_74
    s_branch Lfail
Lfvx_84:
    s_sleep 2
    buffer_load_dword v1, v14, s[16:19], s88 offen sc1
    s_waitcnt vmcnt(0)
    v_cmp_ge_i32 vcc, s26, v1
    s_cbranch_vccz Lfvb_85
    s_sub_u32 s28, s28, 1
    s_cbranch_scc0 Lfvx_84
    s_branch Lfail
Lfail:
    v_mov_b32 v20, 0xdead
    v_mov_b32 v21, 0
    s_mov_b64 exec, 1
    buffer_store_dword v20, v21, s[20:23], 0 offen offset:4
    s_mov_b64 exec, -1
    s_waitcnt vmcnt(0)
    s_endpgm
Ldone:
    s_waitcnt vmcnt(0)
    s_endpgm
Lnotchain:
    s_and_b32 s33, s2, 7
    s_sub_u32 s33, s33, 1
    s_lshl_b32 s33, s33, 5
    s_lshr_b32 s34, s2, 3
    s_add_u32 s33, s33, s34
    s_mul_i32 s99, s33, 9363
    s_lshr_b32 s99, s99, 16
    s_mul_i32 s35, s99, 7
    s_sub_u32 s60, s33, s35
    s_load_dwordx2 s[10:11], s[0:1], 56
    s_waitcnt lgkmcnt(0)
    s_mov_b32 s56, s10
    s_mov_b32 s57, s11
    s_mov_b32 s58, 1835008
    s_mov_b32 s59, 0x00020000
    v_and_b32 v250, 63, v0
    v_add_u32 v251, 0, v250
    v_min_u32 v251, 31, v251
    v_lshlrev_b32 v251, 6, v251
    s_mov_b32 s36, 16005120
Lnw_96:
    buffer_load_dword v253, v251, s[16:19], s36 offen sc1
    s_waitcnt vmcnt(0)
    v_cmp_ne_u32 vcc, s98, v253
    s_cbranch_vccz Lnk_97
    s_sleep 1
    s_sub_u32 s28, s28, 1
    s_cbranch_scc0 Lnw_96
    s_branch Lfail
Lnk_97:
    s_mul_i32 s35, s99, 7
    v_and_b32 v250, 63, v0
    v_add_u32 v251, 0, v250
    v_min_u32 v251, 6, v251
    v_add_u32 v251, s35, v251
    v_lshlrev_b32 v251, 6, v251
    s_mov_b32 s36, 15990784
Lnw_98:
    buffer_load_dword v253, v251, s[16:19], s36 offen sc1
    s_waitcnt vmcnt(0)
    v_cmp_ne_u32 vcc, s98, v253
    s_cbranch_vccz Lnk_99
    s_sleep 1
    s_sub_u32 s28, s28, 1
    s_cbranch_scc0 Lnw_98
    s_branch Lfail
Lnk_99:
    s_cmp_lt_u32 s99, 16
    s_cbranch_scc0 Lw_b
    s_mov_b32 s25, s99
    v_and_b32 v1, 63, v0
    v_lshlrev_b32 v2, 4, v1
    v_lshrrev_b32 v4, 4, v1
    v_mov_b32 v13, 0
    v_mov_b32 v14, 1
    v_bfe_u32 v5, v1, 2, 2
    v_lshlrev_b32 v60, 3, v5
    v_and_b32 v5, 3, v1
    v_add_u32 v60, v60, v5
    v_mul_u32_u24 v60, 896, v60
    v_lshrrev_b32 v5, 4, v1
    v_lshl_add_u32 v60, v5, 4, v60
    v_lshrrev_b32 v5, 1, v4
    v_lshlrev_b32 v6, 8, v5
    v_and_b32 v5, 15, v1
    v_lshl_add_u32 v6, v5, 4, v6
    v_and_b32 v5, 1, v4
    v_lshl_add_u32 v6, v5, 3, v6
    s_mul_i32 s33, s24, 3584
    v_add_u32 v6, s33, v6
    v_lshlrev_b32 v7, 6, v4
    v_bfe_u32 v5, v1, 2, 2
    v_lshl_add_u32 v7, v5, 4, v7
    v_and_b32 v5, 1, v1
    v_lshl_add_u32 v7, v5, 3, v7
    s_mul_i32 s33, s24, 2688
    s_add_u32 s33, s33, 57344
    v_add_u32 v7, s33, v7
    v_lshlrev_b32 v8, 4, v0
    v_lshrrev_b32 v5, 4, v0
    v_lshlrev_b32 v5, 7, v5
    v_add_u32 v9, v8, v5
    v_add_u32 v9, 57344, v9
    s_mul_i32 s33, s24, 6144
    s_add_u32 s33, s33, 68096
    v_add_u32 v10, s33, v2
    s_and_b32 s33, s24, 1
    s_lshl_b32 s33, s33, 10
    s_add_u32 s33, s33, 68096
    v_add_u32 v11, s33, v2
    v_and_b32 v5, 15, v1
    v_lshlrev_b32 v12, 4, v5
    v_and_b32 v5, 1, v4
    v_lshl_add_u32 v12, v5, 3, v12
    v_bfe_u32 v5, v1, 2, 2
    v_lshlrev_b32 v15, 3, v5
    v_and_b32 v5, 3, v1
    v_add_u32 v15, v15, v5
    s_and_b32 s33, s24, 1
    s_lshl_b32 s33, s33, 2
    v_add_u32 v15, s33, v15
    v_lshlrev_b32 v5, 3, v4
    v_sub_u32 v15, v15, v5
    v_cmp_le_i32 s[68:69], 0, v15
    v_cmp_le_i32 s[70:71], 1, v15
    v_cmp_le_i32 s[72:73], 2, v15
    v_cmp_le_i32 s[74:75], 3, v15
    v_cmp_le_i32 s[76:77], 4, v15
    v_cmp_le_i32 s[78:79], 5, v15
    v_cmp_le_i32 s[80:81], 6, v15
    v_cmp_le_i32 s[82:83], 7, v15
    s_mov_b32 s61, s60
    s_mul_i32 s63, s61, 28672
    s_mov_b32 s62, 0
    s_mul_i32 s33, s24, 7168
    s_add_u32 s33, s33, s62
    s_lshr_b32 s36, s24, 1
    s_mul_i32 s36, s36, 3584
    s_and_b32 s34, s24, 1
    s_mul_i32 s34, s34, 448
    s_add_u32 s34, s34, s36
    s_add_u32 s34, s34, s63
    s_add_u32 m0, s33, 0
    s_nop 0
    buffer_load_dwordx4 v60, s[12:15], s34 offen offset:0 lds
    s_add_u32 m0, s33, 960
    s_nop 0
    buffer_load_dwordx4 v60, s[12:15], s34 offen offset:64 lds
    s_add_u32 m0, s33, 1920
    s_nop 0
    buffer_load_dwordx4 v60, s[12:15], s34 offen offset:128 lds
    s_add_u32 m0, s33, 2880
    s_nop 0
    buffer_load_dwordx4 v60, s[12:15], s34 offen offset:192 lds
    s_add_u32 m0, s33, 3840
    s_nop 0
    buffer_load_dwordx4 v60, s[12:15], s34 offen offset:256 lds
    s_add_u32 m0, s33, 4800
    s_nop 0
    buffer_load_dwordx4 v60, s[12:15], s34 offen offset:320 lds
    s_add_u32 m0, s33, 5760
    s_nop 0
    buffer_load_dwordx4 v60, s[12:15], s34 offen offset:384 lds
    s_lshl_b32 s35, s25, 2
    s_add_u32 s35, s35, s24
    s_mul_i32 s35, s35, 7
    s_add_u32 s35, s35, 0
    s_mul_i32 s35, s35, 14336
    s_add_u32 s35, s35, 0
    buffer_load_dwordx4 a[0:3], v2, s[16:19], s35 offen offset:0 sc1
    buffer_load_dwordx4 a[4:7], v2, s[16:19], s35 offen offset:1024 sc1
    buffer_load_dwordx4 a[8:11], v2, s[16:19], s35 offen offset:2048 sc1
    buffer_load_dwordx4 a[12:15], v2, s[16:19], s35 offen offset:3072 sc1
    s_add_u32 s35, s35, 4096
    buffer_load_dwordx4 a[16:19], v2, s[16:19], s35 offen offset:0 sc1
    buffer_load_dwordx4 a[20:23], v2, s[16:19], s35 offen offset:1024 sc1
    buffer_load_dwordx4 a[24:27], v2, s[16:19], s35 offen offset:2048 sc1
    buffer_load_dwordx4 a[28:31], v2, s[16:19], s35 offen offset:3072 sc1
    s_add_u32 s35, s35, 4096
    buffer_load_dwordx4 a[32:35], v2, s[16:19], s35 offen offset:0 sc1
    buffer_load_dwordx4 a[36:39], v2, s[16:19], s35 offen offset:1024 sc1
    buffer_load_dwordx4 a[40:43], v2, s[16:19], s35 offen offset:2048 sc1
    buffer_load_dwordx4 a[44:47], v2, s[16:19], s35 offen offset:3072 sc1
    s_add_u32 s35, s35, 4096
    buffer_load_dwordx4 a[48:51], v2, s[16:19], s35 offen offset:0 sc1
    buffer_load_dwordx4 a[52:55], v2, s[16:19], s35 offen offset:1024 sc1
    s_lshl_b32 s35, s25, 2
    s_add_u32 s35, s35, s24
    s_mul_i32 s35, s35, 7
    s_add_u32 s35, s35, 1
    s_mul_i32 s35, s35, 14336
    s_add_u32 s35, s35, 0
    buffer_load_dwordx4 a[56:59], v2, s[16:19], s35 offen offset:0 sc1
    buffer_load_dwordx4 a[60:63], v2, s[16:19], s35 offen offset:1024 sc1
    buffer_load_dwordx4 a[64:67], v2, s[16:19], s35 offen offset:2048 sc1
    buffer_load_dwordx4 a[68:71], v2, s[16:19], s35 offen offset:3072 sc1
    s_add_u32 s35, s35, 4096
    buffer_load_dwordx4 a[72:75], v2, s[16:19], s35 offen offset:0 sc1
    buffer_load_dwordx4 a[76:79], v2, s[16:19], s35 offen offset:1024 sc1
    buffer_load_dwordx4 a[80:83], v2, s[16:19], s35 offen offset:2048 sc1
    buffer_load_dwordx4 a[84:87], v2, s[16:19], s35 offen offset:3072 sc1
    s_add_u32 s35, s35, 4096
    buffer_load_dwordx4 a[88:91], v2, s[16:19], s35 offen offset:0 sc1
    buffer_load_dwordx4 a[92:95], v2, s[16:19], s35 offen offset:1024 sc1
    buffer_load_dwordx4 a[96:99], v2, s[16:19], s35 offen offset:2048 sc1
    buffer_load_dwordx4 a[100:103], v2, s[16:19], s35 offen offset:3072 sc1
    s_add_u32 s35, s35, 4096
    buffer_load_dwordx4 a[104:107], v2, s[16:19], s35 offen offset:0 sc1
    buffer_load_dwordx4 a[108:111], v2, s[16:19], s35 offen offset:1024 sc1
    s_lshl_b32 s35, s25, 2
    s_add_u32 s35, s35, s24
    s_mul_i32 s35, s35, 7
    s_add_u32 s35, s35, 2
    s_mul_i32 s35, s35, 14336
    s_add_u32 s35, s35, 0
    buffer_load_dwordx4 a[112:115], v2, s[16:19], s35 offen offset:0 sc1
    buffer_load_dwordx4 a[116:119], v2, s[16:19], s35 offen offset:1024 sc1
    buffer_load_dwordx4 a[120:123], v2, s[16:19], s35 offen offset:2048 sc1
    buffer_load_dwordx4 a[124:127], v2, s[16:19], s35 offen offset:3072 sc1
    s_add_u32 s35, s35, 4096
    buffer_load_dwordx4 a[128:131], v2, s[16:19], s35 offen offset:0 sc1
    buffer_load_dwordx4 a[132:135], v2, s[16:19], s35 offen offset:1024 sc1
    buffer_load_dwordx4 a[136:139], v2, s[16:19], s35 offen offset:2048 sc1
    buffer_load_dwordx4 a[140:143], v2, s[16:19], s35 offen offset:3072 sc1
    s_add_u32 s35, s35, 4096
    buffer_load_dwordx4 a[144:147], v2, s[16:19], s35 offen offset:0 sc1
    buffer_load_dwordx4 a[148:151], v2, s[16:19], s35 offen offset:1024 sc1
    buffer_load_dwordx4 a[152:155], v2, s[16:19], s35 offen offset:2048 sc1
    buffer_load_dwordx4 a[156:159], v2, s[16:19], s35 offen offset:3072 sc1
    s_add_u32 s35, s35, 4096
    buffer_load_dwordx4 a[160:163], v2, s[16:19], s35 offen offset:0 sc1
    buffer_load_dwordx4 a[164:167], v2, s[16:19], s35 offen offset:1024 sc1
    s_lshl_b32 s35, s25, 2
    s_add_u32 s35, s35, s24
    s_mul_i32 s35, s35, 7
    s_add_u32 s35, s35, 3
    s_mul_i32 s35, s35, 14336
    s_add_u32 s35, s35, 0
    buffer_load_dwordx4 a[168:171], v2, s[16:19], s35 offen offset:0 sc1
    buffer_load_dwordx4 a[172:175], v2, s[16:19], s35 offen offset:1024 sc1
    buffer_load_dwordx4 a[176:179], v2, s[16:19], s35 offen offset:2048 sc1
    buffer_load_dwordx4 a[180:183], v2, s[16:19], s35 offen offset:3072 sc1
    s_add_u32 s35, s35, 4096
    buffer_load_dwordx4 a[184:187], v2, s[16:19], s35 offen offset:0 sc1
    buffer_load_dwordx4 a[188:191], v2, s[16:19], s35 offen offset:1024 sc1
    s_waitcnt vmcnt(16)
    buffer_load_dwordx4 a[192:195], v2, s[16:19], s35 offen offset:2048 sc1
    buffer_load_dwordx4 a[196:199], v2, s[16:19], s35 offen offset:3072 sc1
    s_add_u32 s35, s35, 4096
    buffer_load_dwordx4 a[200:203], v2, s[16:19], s35 offen offset:0 sc1
    buffer_load_dwordx4 a[204:207], v2, s[16:19], s35 offen offset:1024 sc1
    buffer_load_dwordx4 a[208:211], v2, s[16:19], s35 offen offset:2048 sc1
    buffer_load_dwordx4 a[212:215], v2, s[16:19], s35 offen offset:3072 sc1
    s_add_u32 s35, s35, 4096
    buffer_load_dwordx4 a[216:219], v2, s[16:19], s35 offen offset:0 sc1
    buffer_load_dwordx4 a[220:223], v2, s[16:19], s35 offen offset:1024 sc1
    s_lshl_b32 s35, s25, 2
    s_add_u32 s35, s35, s24
    s_mul_i32 s35, s35, 7
    s_add_u32 s35, s35, 4
    s_mul_i32 s35, s35, 14336
    s_add_u32 s35, s35, 0
    buffer_load_dwordx4 a[224:227], v2, s[16:19], s35 offen offset:0 sc1
    buffer_load_dwordx4 a[228:231], v2, s[16:19], s35 offen offset:1024 sc1
    buffer_load_dwordx4 a[232:235], v2, s[16:19], s35 offen offset:2048 sc1
    buffer_load_dwordx4 a[236:239], v2, s[16:19], s35 offen offset:3072 sc1
    s_add_u32 s35, s35, 4096
    buffer_load_dwordx4 a[240:243], v2, s[16:19], s35 offen offset:0 sc1
    buffer_load_dwordx4 a[244:247], v2, s[16:19], s35 offen offset:1024 sc1
    buffer_load_dwordx4 a[248:251], v2, s[16:19], s35 offen offset:2048 sc1
    buffer_load_dwordx4 a[252:255], v2, s[16:19], s35 offen offset:3072 sc1
    s_add_u32 s35, s35, 4096
    buffer_load_dwordx4 v[120:123], v2, s[16:19], s35 offen offset:0 sc1
    buffer_load_dwordx4 v[124:127], v2, s[16:19], s35 offen offset:1024 sc1
    buffer_load_dwordx4 v[128:131], v2, s[16:19], s35 offen offset:2048 sc1
    buffer_load_dwordx4 v[132:135], v2, s[16:19], s35 offen offset:3072 sc1
    s_add_u32 s35, s35, 4096
    buffer_load_dwordx4 v[136:139], v2, s[16:19], s35 offen offset:0 sc1
    buffer_load_dwordx4 v[140:143], v2, s[16:19], s35 offen offset:1024 sc1
    s_lshl_b32 s35, s25, 2
    s_add_u32 s35, s35, s24
    s_mul_i32 s35, s35, 7
    s_add_u32 s35, s35, 5
    s_mul_i32 s35, s35, 14336
    s_add_u32 s35, s35, 0
    buffer_load_dwordx4 v[144:147], v2, s[16:19], s35 offen offset:0 sc1
    buffer_load_dwordx4 v[148:151], v2, s[16:19], s35 offen offset:1024 sc1
    buffer_load_dwordx4 v[152:155], v2, s[16:19], s35 offen offset:2048 sc1
    buffer_load_dwordx4 v[156:159], v2, s[16:19], s35 offen offset:3072 sc1
    s_add_u32 s35, s35, 4096
    buffer_load_dwordx4 v[160:163], v2, s[16:19], s35 offen offset:0 sc1
    buffer_load_dwordx4 v[164:167], v2, s[16:19], s35 offen offset:1024 sc1
    buffer_load_dwordx4 v[168:171], v2, s[16:19], s35 offen offset:2048 sc1
    buffer_load_dwordx4 v[172:175], v2, s[16:19], s35 offen offset:3072 sc1
    s_add_u32 s35, s35, 4096
    buffer_load_dwordx4 v[176:179], v2, s[16:19], s35 offen offset:0 sc1
    buffer_load_dwordx4 v[180:183], v2, s[16:19], s35 offen offset:1024 sc1
    buffer_load_dwordx4 v[184:187], v2, s[16:19], s35 offen offset:2048 sc1
    buffer_load_dwordx4 v[188:191], v2, s[16:19], s35 offen offset:3072 sc1
    s_add_u32 s35, s35, 4096
    buffer_load_dwordx4 v[192:195], v2, s[16:19], s35 offen offset:0 sc1
    buffer_load_dwordx4 v[196:199], v2, s[16:19], s35 offen offset:1024 sc1
    s_lshl_b32 s35, s25, 2
    s_add_u32 s35, s35, s24
    s_mul_i32 s35, s35, 7
    s_add_u32 s35, s35, 6
    s_mul_i32 s35, s35, 14336
    s_add_u32 s35, s35, 0
    buffer_load_dwordx4 v[200:203], v2, s[16:19], s35 offen offset:0 sc1
    buffer_load_dwordx4 v[204:207], v2, s[16:19], s35 offen offset:1024 sc1
    buffer_load_dwordx4 v[208:211], v2, s[16:19], s35 offen offset:2048 sc1
    buffer_load_dwordx4 v[212:215], v2, s[16:19], s35 offen offset:3072 sc1
    s_add_u32 s35, s35, 4096
    buffer_load_dwordx4 v[216:219], v2, s[16:19], s35 offen offset:0 sc1
    buffer_load_dwordx4 v[220:223], v2, s[16:19], s35 offen offset:1024 sc1
    buffer_load_dwordx4 v[224:227], v2, s[16:19], s35 offen offset:2048 sc1
    buffer_load_dwordx4 v[228:231], v2, s[16:19], s35 offen offset:3072 sc1
    s_add_u32 s35, s35, 4096
    buffer_load_dwordx4 v[232:235], v2, s[16:19], s35 offen offset:0 sc1
    buffer_load_dwordx4 v[236:239], v2, s[16:19], s35 offen offset:1024 sc1
    buffer_load_dwordx4 v[240:243], v2, s[16:19], s35 offen offset:2048 sc1
    buffer_load_dwordx4 v[244:247], v2, s[16:19], s35 offen offset:3072 sc1
    s_waitcnt vmcnt(16)
    s_add_u32 s35, s35, 4096
    buffer_load_dwordx4 v[248:251], v2, s[16:19], s35 offen offset:0 sc1
    buffer_load_dwordx4 v[252:255], v2, s[16:19], s35 offen offset:1024 sc1
    s_mov_b32 s84, -1
La_top:
    s_waitcnt vmcnt(0)
    s_barrier
    s_cmp_eq_u32 s84, -1
    s_cbranch_scc1 Las_100
    s_cmp_eq_u32 s24, 0
    s_cbranch_scc0 Las_100
    s_mov_b64 exec, 1
    buffer_store_dword v14, v13, s[16:19], s84 offen sc1
    s_mov_b64 exec, -1
Las_100:
    s_cmp_ge_u32 s61, 64
    s_cbranch_scc1 Ldone
    v_add_u32 v3, s62, v2
    v_add_u32 v5, s62, v6
    s_xor_b32 s62, s62, 28672
    s_add_u32 s63, s63, 200704
    s_add_u32 s33, s61, 7
    s_cmp_ge_u32 s33, 64
    s_cbranch_scc1 La_nodma
    s_mul_i32 s33, s24, 7168
    s_add_u32 s33, s33, s62
    s_lshr_b32 s36, s24, 1
    s_mul_i32 s36, s36, 3584
    s_and_b32 s34, s24, 1
    s_mul_i32 s34, s34, 448
    s_add_u32 s34, s34, s36
    s_add_u32 s34, s34, s63
    s_add_u32 m0, s33, 0
    s_nop 0
    buffer_load_dwordx4 v60, s[12:15], s34 offen offset:0 lds
    s_add_u32 m0, s33, 960
    s_nop 0
    buffer_load_dwordx4 v60, s[12:15], s34 offen offset:64 lds
    s_add_u32 m0, s33, 1920
    s_nop 0
    buffer_load_dwordx4 v60, s[12:15], s34 offen offset:128 lds
    s_add_u32 m0, s33, 2880
    s_nop 0
    buffer_load_dwordx4 v60, s[12:15], s34 offen offset:192 lds
    s_add_u32 m0, s33, 3840
    s_nop 0
    buffer_load_dwordx4 v60, s[12:15], s34 offen offset:256 lds
    s_add_u32 m0, s33, 4800
    s_nop 0
    buffer_load_dwordx4 v60, s[12:15], s34 offen offset:320 lds
    s_add_u32 m0, s33, 5760
    s_nop 0
    buffer_load_dwordx4 v60, s[12:15], s34 offen offset:384 lds
La_nodma:
    ds_read_b128 v[16:19], v3 offset:0
    ds_read_b128 v[20:23], v3 offset:14336
    ds_read_b128 v[24:27], v3 offset:1024
    ds_read_b128 v[28:31], v3 offset:15360
    s_waitcnt lgkmcnt(3)
    v_mfma_f32_16x16x32_bf16 v[64:67], a[0:3], v[16:19], 0
    s_waitcnt lgkmcnt(2)
    v_mfma_f32_16x16x32_bf16 v[92:95], a[0:3], v[20:23], 0
    v_mfma_f32_16x16x32_bf16 v[68:71], a[56:59], v[16:19], 0
    v_mfma_f32_16x16x32_bf16 v[96:99], a[56:59], v[20:23], 0
    v_mfma_f32_16x16x32_bf16 v[72:75], a[112:115], v[16:19], 0
    v_mfma_f32_16x16x32_bf16 v[100:103], a[112:115], v[20:23], 0
    v_mfma_f32_16x16x32_bf16 v[76:79], a[168:171], v[16:19], 0
    v_mfma_f32_16x16x32_bf16 v[104:107], a[168:171], v[20:23], 0
    v_mfma_f32_16x16x32_bf16 v[80:83], a[224:227], v[16:19], 0
    v_mfma_f32_16x16x32_bf16 v[108:111], a[224:227], v[20:23], 0
    v_mfma_f32_16x16x32_bf16 v[84:87], v[144:147], v[16:19], 0
    v_mfma_f32_16x16x32_bf16 v[112:115], v[144:147], v[20:23], 0
    v_mfma_f32_16x16x32_bf16 v[88:91], v[200:203], v[16:19], 0
    v_mfma_f32_16x16x32_bf16 v[116:119], v[200:203], v[20:23], 0
    ds_read_b128 v[16:19], v3 offset:2048
    ds_read_b128 v[20:23], v3 offset:16384
    s_waitcnt lgkmcnt(3)
    v_mfma_f32_16x16x32_bf16 v[64:67], a[4:7], v[24:27], v[64:67]
    s_waitcnt lgkmcnt(2)
    v_mfma_f32_16x16x32_bf16 v[92:95], a[4:7], v[28:31], v[92:95]
    v_mfma_f32_16x16x32_bf16 v[68:71], a[60:63], v[24:27], v[68:71]
    v_mfma_f32_16x16x32_bf16 v[96:99], a[60:63], v[28:31], v[96:99]
    v_mfma_f32_16x16x32_bf16 v[72:75], a[116:119], v[24:27], v[72:75]
    v_mfma_f32_16x16x32_bf16 v[100:103], a[116:119], v[28:31], v[100:103]
    v_mfma_f32_16x16x32_bf16 v[76:79], a[172:175], v[24:27], v[76:79]
    v_mfma_f32_16x16x32_bf16 v[104:107], a[172:175], v[28:31], v[104:107]
    v_mfma_f32_16x16x32_bf16 v[80:83], a[228:231], v[24:27], v[80:83]
    v_mfma_f32_16x16x32_bf16 v[108:111], a[228:231], v[28:31], v[108:111]
    v_mfma_f32_16x16x32_bf16 v[84:87], v[148:151], v[24:27], v[84:87]
    v_mfma_f32_16x16x32_bf16 v[112:115], v[148:151], v[28:31], v[112:115]
    v_mfma_f32_16x16x32_bf16 v[88:91], v[204:207], v[24:27], v[88:91]
    v_mfma_f32_16x16x32_bf16 v[116:119], v[204:207], v[28:31], v[116:119]
    ds_read_b128 v[24:27], v3 offset:3072
    ds_read_b128 v[28:31], v3 offset:17408
    s_waitcnt lgkmcnt(3)
    v_mfma_f32_16x16x32_bf16 v[64:67], a[8:11], v[16:19], v[64:67]
    s_waitcnt lgkmcnt(2)
    v_mfma_f32_16x16x32_bf16 v[92:95], a[8:11], v[20:23], v[92:95]
    v_mfma_f32_16x16x32_bf16 v[68:71], a[64:67], v[16:19], v[68:71]
    v_mfma_f32_16x16x32_bf16 v[96:99], a[64:67], v[20:23], v[96:99]
    v_mfma_f32_16x16x32_bf16 v[72:75], a[120:123], v[16:19], v[72:75]
    v_mfma_f32_16x16x32_bf16 v[100:103], a[120:123], v[20:23], v[100:103]
    v_mfma_f32_16x16x32_bf16 v[76:79], a[176:179], v[16:19], v[76:79]
    v_mfma_f32_16x16x32_bf16 v[104:107], a[176:179], v[20:23], v[104:107]
    v_mfma_f32_16x16x32_bf16 v[80:83], a[232:235], v[16:19], v[80:83]
    v_mfma_f32_16x16x32_bf16 v[108:111], a[232:235], v[20:23], v[108:111]
    v_mfma_f32_16x16x32_bf16 v[84:87], v[152:155], v[16:19], v[84:87]
    v_mfma_f32_16x16x32_bf16 v[112:115], v[152:155], v[20:23], v[112:115]
    v_mfma_f32_16x16x32_bf16 v[88:91], v[208:211], v[16:19], v[88:91]
    v_mfma_f32_16x16x32_bf16 v[116:119], v[208:211], v[20:23], v[116:119]
    ds_read_b128 v[16:19], v3 offset:4096
    ds_read_b128 v[20:23], v3 offset:18432
    s_waitcnt lgkmcnt(3)
    v_mfma_f32_16x16x32_bf16 v[64:67], a[12:15], v[24:27], v[64:67]
    s_waitcnt lgkmcnt(2)
    v_mfma_f32_16x16x32_bf16 v[92:95], a[12:15], v[28:31], v[92:95]
    v_mfma_f32_16x16x32_bf16 v[68:71], a[68:71], v[24:27], v[68:71]
    v_mfma_f32_16x16x32_bf16 v[96:99], a[68:71], v[28:31], v[96:99]
    v_mfma_f32_16x16x32_bf16 v[72:75], a[124:127], v[24:27], v[72:75]
    v_mfma_f32_16x16x32_bf16 v[100:103], a[124:127], v[28:31], v[100:103]
    v_mfma_f32_16x16x32_bf16 v[76:79], a[180:183], v[24:27], v[76:79]
    v_mfma_f32_16x16x32_bf16 v[104:107], a[180:183], v[28:31], v[104:107]
    v_mfma_f32_16x16x32_bf16 v[80:83], a[236:239], v[24:27], v[80:83]
    v_mfma_f32_16x16x32_bf16 v[108:111], a[236:239], v[28:31], v[108:111]
    v_mfma_f32_16x16x32_bf16 v[84:87], v[156:159], v[24:27], v[84:87]
    v_mfma_f32_16x16x32_bf16 v[112:115], v[156:159], v[28:31], v[112:115]
    v_mfma_f32_16x16x32_bf16 v[88:91], v[212:215], v[24:27], v[88:91]
    v_mfma_f32_16x16x32_bf16 v[116:119], v[212:215], v[28:31], v[116:119]
    ds_read_b128 v[24:27], v3 offset:5120
    ds_read_b128 v[28:31], v3 offset:19456
    s_waitcnt lgkmcnt(3)
    v_mfma_f32_16x16x32_bf16 v[64:67], a[16:19], v[16:19], v[64:67]
    s_waitcnt lgkmcnt(2)
    v_mfma_f32_16x16x32_bf16 v[92:95], a[16:19], v[20:23], v[92:95]
    v_mfma_f32_16x16x32_bf16 v[68:71], a[72:75], v[16:19], v[68:71]
    v_mfma_f32_16x16x32_bf16 v[96:99], a[72:75], v[20:23], v[96:99]
    v_mfma_f32_16x16x32_bf16 v[72:75], a[128:131], v[16:19], v[72:75]
    v_mfma_f32_16x16x32_bf16 v[100:103], a[128:131], v[20:23], v[100:103]
    v_mfma_f32_16x16x32_bf16 v[76:79], a[184:187], v[16:19], v[76:79]
    v_mfma_f32_16x16x32_bf16 v[104:107], a[184:187], v[20:23], v[104:107]
    v_mfma_f32_16x16x32_bf16 v[80:83], a[240:243], v[16:19], v[80:83]
    v_mfma_f32_16x16x32_bf16 v[108:111], a[240:243], v[20:23], v[108:111]
    v_mfma_f32_16x16x32_bf16 v[84:87], v[160:163], v[16:19], v[84:87]
    v_mfma_f32_16x16x32_bf16 v[112:115], v[160:163], v[20:23], v[112:115]
    v_mfma_f32_16x16x32_bf16 v[88:91], v[216:219], v[16:19], v[88:91]
    v_mfma_f32_16x16x32_bf16 v[116:119], v[216:219], v[20:23], v[116:119]
    ds_read_b128 v[16:19], v3 offset:6144
    ds_read_b128 v[20:23], v3 offset:20480
    s_waitcnt lgkmcnt(3)
    v_mfma_f32_16x16x32_bf16 v[64:67], a[20:23], v[24:27], v[64:67]
    s_waitcnt lgkmcnt(2)
    v_mfma_f32_16x16x32_bf16 v[92:95], a[20:23], v[28:31], v[92:95]
    v_mfma_f32_16x16x32_bf16 v[68:71], a[76:79], v[24:27], v[68:71]
    v_mfma_f32_16x16x32_bf16 v[96:99], a[76:79], v[28:31], v[96:99]
    v_mfma_f32_16x16x32_bf16 v[72:75], a[132:135], v[24:27], v[72:75]
    v_mfma_f32_16x16x32_bf16 v[100:103], a[132:135], v[28:31], v[100:103]
    v_mfma_f32_16x16x32_bf16 v[76:79], a[188:191], v[24:27], v[76:79]
    v_mfma_f32_16x16x32_bf16 v[104:107], a[188:191], v[28:31], v[104:107]
    v_mfma_f32_16x16x32_bf16 v[80:83], a[244:247], v[24:27], v[80:83]
    v_mfma_f32_16x16x32_bf16 v[108:111], a[244:247], v[28:31], v[108:111]
    v_mfma_f32_16x16x32_bf16 v[84:87], v[164:167], v[24:27], v[84:87]
    v_mfma_f32_16x16x32_bf16 v[112:115], v[164:167], v[28:31], v[112:115]
    v_mfma_f32_16x16x32_bf16 v[88:91], v[220:223], v[24:27], v[88:91]
    v_mfma_f32_16x16x32_bf16 v[116:119], v[220:223], v[28:31], v[116:119]
    ds_read_b128 v[24:27], v3 offset:7168
    ds_read_b128 v[28:31], v3 offset:21504
    s_waitcnt lgkmcnt(3)
    v_mfma_f32_16x16x32_bf16 v[64:67], a[24:27], v[16:19], v[64:67]
    s_waitcnt lgkmcnt(2)
    v_mfma_f32_16x16x32_bf16 v[92:95], a[24:27], v[20:23], v[92:95]
    v_mfma_f32_16x16x32_bf16 v[68:71], a[80:83], v[16:19], v[68:71]
    v_mfma_f32_16x16x32_bf16 v[96:99], a[80:83], v[20:23], v[96:99]
    v_mfma_f32_16x16x32_bf16 v[72:75], a[136:139], v[16:19], v[72:75]
    v_mfma_f32_16x16x32_bf16 v[100:103], a[136:139], v[20:23], v[100:103]
    v_mfma_f32_16x16x32_bf16 v[76:79], a[192:195], v[16:19], v[76:79]
    v_mfma_f32_16x16x32_bf16 v[104:107], a[192:195], v[20:23], v[104:107]
    v_mfma_f32_16x16x32_bf16 v[80:83], a[248:251], v[16:19], v[80:83]
    v_mfma_f32_16x16x32_bf16 v[108:111], a[248:251], v[20:23], v[108:111]
    v_mfma_f32_16x16x32_bf16 v[84:87], v[168:171], v[16:19], v[84:87]
    v_mfma_f32_16x16x32_bf16 v[112:115], v[168:171], v[20:23], v[112:115]
    v_mfma_f32_16x16x32_bf16 v[88:91], v[224:227], v[16:19], v[88:91]
    v_mfma_f32_16x16x32_bf16 v[116:119], v[224:227], v[20:23], v[116:119]
    ds_read_b128 v[16:19], v3 offset:8192
    ds_read_b128 v[20:23], v3 offset:22528
    s_waitcnt lgkmcnt(3)
    v_mfma_f32_16x16x32_bf16 v[64:67], a[28:31], v[24:27], v[64:67]
    s_waitcnt lgkmcnt(2)
    v_mfma_f32_16x16x32_bf16 v[92:95], a[28:31], v[28:31], v[92:95]
    v_mfma_f32_16x16x32_bf16 v[68:71], a[84:87], v[24:27], v[68:71]
    v_mfma_f32_16x16x32_bf16 v[96:99], a[84:87], v[28:31], v[96:99]
    v_mfma_f32_16x16x32_bf16 v[72:75], a[140:143], v[24:27], v[72:75]
    v_mfma_f32_16x16x32_bf16 v[100:103], a[140:143], v[28:31], v[100:103]
    v_mfma_f32_16x16x32_bf16 v[76:79], a[196:199], v[24:27], v[76:79]
    v_mfma_f32_16x16x32_bf16 v[104:107], a[196:199], v[28:31], v[104:107]
    v_mfma_f32_16x16x32_bf16 v[80:83], a[252:255], v[24:27], v[80:83]
    v_mfma_f32_16x16x32_bf16 v[108:111], a[252:255], v[28:31], v[108:111]
    v_mfma_f32_16x16x32_bf16 v[84:87], v[172:175], v[24:27], v[84:87]
    v_mfma_f32_16x16x32_bf16 v[112:115], v[172:175], v[28:31], v[112:115]
    v_mfma_f32_16x16x32_bf16 v[88:91], v[228:231], v[24:27], v[88:91]
    v_mfma_f32_16x16x32_bf16 v[116:119], v[228:231], v[28:31], v[116:119]
    ds_read_b128 v[24:27], v3 offset:9216
    ds_read_b128 v[28:31], v3 offset:23552
    s_waitcnt lgkmcnt(3)
    v_mfma_f32_16x16x32_bf16 v[64:67], a[32:35], v[16:19], v[64:67]
    s_waitcnt lgkmcnt(2)
    v_mfma_f32_16x16x32_bf16 v[92:95], a[32:35], v[20:23], v[92:95]
    v_mfma_f32_16x16x32_bf16 v[68:71], a[88:91], v[16:19], v[68:71]
    v_mfma_f32_16x16x32_bf16 v[96:99], a[88:91], v[20:23], v[96:99]
    v_mfma_f32_16x16x32_bf16 v[72:75], a[144:147], v[16:19], v[72:75]
    v_mfma_f32_16x16x32_bf16 v[100:103], a[144:147], v[20:23], v[100:103]
    v_mfma_f32_16x16x32_bf16 v[76:79], a[200:203], v[16:19], v[76:79]
    v_mfma_f32_16x16x32_bf16 v[104:107], a[200:203], v[20:23], v[104:107]
    v_mfma_f32_16x16x32_bf16 v[80:83], v[120:123], v[16:19], v[80:83]
    v_mfma_f32_16x16x32_bf16 v[108:111], v[120:123], v[20:23], v[108:111]
    v_mfma_f32_16x16x32_bf16 v[84:87], v[176:179], v[16:19], v[84:87]
    v_mfma_f32_16x16x32_bf16 v[112:115], v[176:179], v[20:23], v[112:115]
    v_mfma_f32_16x16x32_bf16 v[88:91], v[232:235], v[16:19], v[88:91]
    v_mfma_f32_16x16x32_bf16 v[116:119], v[232:235], v[20:23], v[116:119]
    ds_read_b128 v[16:19], v3 offset:10240
    ds_read_b128 v[20:23], v3 offset:24576
    s_waitcnt lgkmcnt(3)
    v_mfma_f32_16x16x32_bf16 v[64:67], a[36:39], v[24:27], v[64:67]
    s_waitcnt lgkmcnt(2)
    v_mfma_f32_16x16x32_bf16 v[92:95], a[36:39], v[28:31], v[92:95]
    v_mfma_f32_16x16x32_bf16 v[68:71], a[92:95], v[24:27], v[68:71]
    v_mfma_f32_16x16x32_bf16 v[96:99], a[92:95], v[28:31], v[96:99]
    v_mfma_f32_16x16x32_bf16 v[72:75], a[148:151], v[24:27], v[72:75]
    v_mfma_f32_16x16x32_bf16 v[100:103], a[148:151], v[28:31], v[100:103]
    v_mfma_f32_16x16x32_bf16 v[76:79], a[204:207], v[24:27], v[76:79]
    v_mfma_f32_16x16x32_bf16 v[104:107], a[204:207], v[28:31], v[104:107]
    v_mfma_f32_16x16x32_bf16 v[80:83], v[124:127], v[24:27], v[80:83]
    v_mfma_f32_16x16x32_bf16 v[108:111], v[124:127], v[28:31], v[108:111]
    v_mfma_f32_16x16x32_bf16 v[84:87], v[180:183], v[24:27], v[84:87]
    v_mfma_f32_16x16x32_bf16 v[112:115], v[180:183], v[28:31], v[112:115]
    v_mfma_f32_16x16x32_bf16 v[88:91], v[236:239], v[24:27], v[88:91]
    v_mfma_f32_16x16x32_bf16 v[116:119], v[236:239], v[28:31], v[116:119]
    ds_read_b128 v[24:27], v3 offset:11264
    ds_read_b128 v[28:31], v3 offset:25600
    s_waitcnt lgkmcnt(3)
    v_mfma_f32_16x16x32_bf16 v[64:67], a[40:43], v[16:19], v[64:67]
    s_waitcnt lgkmcnt(2)
    v_mfma_f32_16x16x32_bf16 v[92:95], a[40:43], v[20:23], v[92:95]
    v_mfma_f32_16x16x32_bf16 v[68:71], a[96:99], v[16:19], v[68:71]
    v_mfma_f32_16x16x32_bf16 v[96:99], a[96:99], v[20:23], v[96:99]
    v_mfma_f32_16x16x32_bf16 v[72:75], a[152:155], v[16:19], v[72:75]
    v_mfma_f32_16x16x32_bf16 v[100:103], a[152:155], v[20:23], v[100:103]
    v_mfma_f32_16x16x32_bf16 v[76:79], a[208:211], v[16:19], v[76:79]
    v_mfma_f32_16x16x32_bf16 v[104:107], a[208:211], v[20:23], v[104:107]
    v_mfma_f32_16x16x32_bf16 v[80:83], v[128:131], v[16:19], v[80:83]
    v_mfma_f32_16x16x32_bf16 v[108:111], v[128:131], v[20:23], v[108:111]
    v_mfma_f32_16x16x32_bf16 v[84:87], v[184:187], v[16:19], v[84:87]
    v_mfma_f32_16x16x32_bf16 v[112:115], v[184:187], v[20:23], v[112:115]
    v_mfma_f32_16x16x32_bf16 v[88:91], v[240:243], v[16:19], v[88:91]
    v_mfma_f32_16x16x32_bf16 v[116:119], v[240:243], v[20:23], v[116:119]
    ds_read_b128 v[16:19], v3 offset:12288
    ds_read_b128 v[20:23], v3 offset:26624
    s_waitcnt lgkmcnt(3)
    v_mfma_f32_16x16x32_bf16 v[64:67], a[44:47], v[24:27], v[64:67]
    s_waitcnt lgkmcnt(2)
    v_mfma_f32_16x16x32_bf16 v[92:95], a[44:47], v[28:31], v[92:95]
    v_mfma_f32_16x16x32_bf16 v[68:71], a[100:103], v[24:27], v[68:71]
    v_mfma_f32_16x16x32_bf16 v[96:99], a[100:103], v[28:31], v[96:99]
    v_mfma_f32_16x16x32_bf16 v[72:75], a[156:159], v[24:27], v[72:75]
    v_mfma_f32_16x16x32_bf16 v[100:103], a[156:159], v[28:31], v[100:103]
    v_mfma_f32_16x16x32_bf16 v[76:79], a[212:215], v[24:27], v[76:79]
    v_mfma_f32_16x16x32_bf16 v[104:107], a[212:215], v[28:31], v[104:107]
    v_mfma_f32_16x16x32_bf16 v[80:83], v[132:135], v[24:27], v[80:83]
    v_mfma_f32_16x16x32_bf16 v[108:111], v[132:135], v[28:31], v[108:111]
    v_mfma_f32_16x16x32_bf16 v[84:87], v[188:191], v[24:27], v[84:87]
    v_mfma_f32_16x16x32_bf16 v[112:115], v[188:191], v[28:31], v[112:115]
    v_mfma_f32_16x16x32_bf16 v[88:91], v[244:247], v[24:27], v[88:91]
    v_mfma_f32_16x16x32_bf16 v[116:119], v[244:247], v[28:31], v[116:119]
    ds_read_b128 v[24:27], v3 offset:13312
    ds_read_b128 v[28:31], v3 offset:27648
    s_waitcnt lgkmcnt(3)
    v_mfma_f32_16x16x32_bf16 v[64:67], a[48:51], v[16:19], v[64:67]
    s_waitcnt lgkmcnt(2)
    v_mfma_f32_16x16x32_bf16 v[92:95], a[48:51], v[20:23], v[92:95]
    v_mfma_f32_16x16x32_bf16 v[68:71], a[104:107], v[16:19], v[68:71]
    v_mfma_f32_16x16x32_bf16 v[96:99], a[104:107], v[20:23], v[96:99]
    v_mfma_f32_16x16x32_bf16 v[72:75], a[160:163], v[16:19], v[72:75]
    v_mfma_f32_16x16x32_bf16 v[100:103], a[160:163], v[20:23], v[100:103]
    v_mfma_f32_16x16x32_bf16 v[76:79], a[216:219], v[16:19], v[76:79]
    v_mfma_f32_16x16x32_bf16 v[104:107], a[216:219], v[20:23], v[104:107]
    v_mfma_f32_16x16x32_bf16 v[80:83], v[136:139], v[16:19], v[80:83]
    v_mfma_f32_16x16x32_bf16 v[108:111], v[136:139], v[20:23], v[108:111]
    v_mfma_f32_16x16x32_bf16 v[84:87], v[192:195], v[16:19], v[84:87]
    v_mfma_f32_16x16x32_bf16 v[112:115], v[192:195], v[20:23], v[112:115]
    v_mfma_f32_16x16x32_bf16 v[88:91], v[248:251], v[16:19], v[88:91]
    v_mfma_f32_16x16x32_bf16 v[116:119], v[248:251], v[20:23], v[116:119]
    s_waitcnt lgkmcnt(1)
    v_mfma_f32_16x16x32_bf16 v[64:67], a[52:55], v[24:27], v[64:67]
    s_waitcnt lgkmcnt(0)
    v_mfma_f32_16x16x32_bf16 v[92:95], a[52:55], v[28:31], v[92:95]
    v_mfma_f32_16x16x32_bf16 v[68:71], a[108:111], v[24:27], v[68:71]
    v_mfma_f32_16x16x32_bf16 v[96:99], a[108:111], v[28:31], v[96:99]
    v_mfma_f32_16x16x32_bf16 v[72:75], a[164:167], v[24:27], v[72:75]
    v_mfma_f32_16x16x32_bf16 v[100:103], a[164:167], v[28:31], v[100:103]
    v_mfma_f32_16x16x32_bf16 v[76:79], a[220:223], v[24:27], v[76:79]
    v_mfma_f32_16x16x32_bf16 v[104:107], a[220:223], v[28:31], v[104:107]
    v_mfma_f32_16x16x32_bf16 v[80:83], v[140:143], v[24:27], v[80:83]
    v_mfma_f32_16x16x32_bf16 v[108:111], v[140:143], v[28:31], v[108:111]
    v_mfma_f32_16x16x32_bf16 v[84:87], v[196:199], v[24:27], v[84:87]
    v_mfma_f32_16x16x32_bf16 v[112:115], v[196:199], v[28:31], v[112:115]
    v_mfma_f32_16x16x32_bf16 v[88:91], v[252:255], v[24:27], v[88:91]
    v_mfma_f32_16x16x32_bf16 v[116:119], v[252:255], v[28:31], v[116:119]
    v_cvt_pk_bf16_f32 v32, v64, v65
    v_cvt_pk_bf16_f32 v33, v66, v67
    v_cvt_pk_bf16_f32 v34, v68, v69
    v_cvt_pk_bf16_f32 v35, v70, v71
    v_cvt_pk_bf16_f32 v36, v72, v73
    v_cvt_pk_bf16_f32 v37, v74, v75
    v_cvt_pk_bf16_f32 v38, v76, v77
    v_cvt_pk_bf16_f32 v39, v78, v79
    v_cvt_pk_bf16_f32 v40, v80, v81
    v_cvt_pk_bf16_f32 v41, v82, v83
    v_cvt_pk_bf16_f32 v42, v84, v85
    v_cvt_pk_bf16_f32 v43, v86, v87
    v_cvt_pk_bf16_f32 v44, v88, v89
    v_cvt_pk_bf16_f32 v45, v90, v91
    v_cvt_pk_bf16_f32 v46, v92, v93
    v_cvt_pk_bf16_f32 v47, v94, v95
    v_cvt_pk_bf16_f32 v48, v96, v97
    v_cvt_pk_bf16_f32 v49, v98, v99
    v_cvt_pk_bf16_f32 v50, v100, v101
    v_cvt_pk_bf16_f32 v51, v102, v103
    v_cvt_pk_bf16_f32 v52, v104, v105
    v_cvt_pk_bf16_f32 v53, v106, v107
    v_cvt_pk_bf16_f32 v54, v108, v109
    v_cvt_pk_bf16_f32 v55, v110, v111
    v_cvt_pk_bf16_f32 v56, v112, v113
    v_cvt_pk_bf16_f32 v57, v114, v115
    v_cvt_pk_bf16_f32 v58, v116, v117
    v_cvt_pk_bf16_f32 v59, v118, v119
    ds_read2st64_b64 v[16:19], v5 offset0:0 offset1:1
    ds_read2st64_b64 v[20:23], v5 offset0:2 offset1:3
    ds_read2st64_b64 v[24:27], v5 offset0:4 offset1:5
    ds_read_b64 v[28:29], v5 offset:3072
    s_waitcnt lgkmcnt(3)
    v_mfma_f32_16x16x32_bf16 v[64:67], v[16:19], v[32:35], 0
    s_waitcnt lgkmcnt(2)
    v_mfma_f32_16x16x32_bf16 v[64:67], v[20:23], v[36:39], v[64:67]
    s_waitcnt lgkmcnt(1)
    v_mfma_f32_16x16x32_bf16 v[64:67], v[24:27], v[40:43], v[64:67]
    v_mfma_f32_16x16x32_bf16 v[68:71], v[16:19], v[46:49], 0
    v_mfma_f32_16x16x32_bf16 v[68:71], v[20:23], v[50:53], v[68:71]
    v_mfma_f32_16x16x32_bf16 v[68:71], v[24:27], v[54:57], v[68:71]
    s_waitcnt lgkmcnt(0)
    s_nop 3
    v_mfma_f32_16x16x16_bf16 v[64:67], v[28:29], v[44:45], v[64:67]
    s_nop 1
    v_mfma_f32_16x16x16_bf16 v[68:71], v[28:29], v[58:59], v[68:71]
    ds_read2st64_b64 v[16:19], v5 offset0:28 offset1:29
    ds_read2st64_b64 v[20:23], v5 offset0:30 offset1:31
    ds_read2st64_b64 v[24:27], v5 offset0:32 offset1:33
    ds_read_b64 v[28:29], v5 offset:17408
    s_waitcnt lgkmcnt(3)
    v_mfma_f32_16x16x32_bf16 v[72:75], v[16:19], v[32:35], 0
    s_waitcnt lgkmcnt(2)
    v_mfma_f32_16x16x32_bf16 v[72:75], v[20:23], v[36:39], v[72:75]
    s_waitcnt lgkmcnt(1)
    v_mfma_f32_16x16x32_bf16 v[72:75], v[24:27], v[40:43], v[72:75]
    v_mfma_f32_16x16x32_bf16 v[76:79], v[16:19], v[46:49], 0
    v_mfma_f32_16x16x32_bf16 v[76:79], v[20:23], v[50:53], v[76:79]
    v_mfma_f32_16x16x32_bf16 v[76:79], v[24:27], v[54:57], v[76:79]
    s_waitcnt lgkmcnt(0)
    s_nop 3
    v_mfma_f32_16x16x16_bf16 v[72:75], v[28:29], v[44:45], v[72:75]
    s_nop 1
    v_mfma_f32_16x16x16_bf16 v[76:79], v[28:29], v[58:59], v[76:79]
    s_mul_i32 s64, s61, 7168
    s_add_u32 s64, s64, 14155776
    s_add_u32 s65, s64, 4096
    s_cmp_eq_u32 s24, 3
    s_cbranch_scc1 La_p1
La_p2:
    buffer_load_dwordx4 v[104:107], v8, s[16:19], s64 offen sc1
    buffer_load_dwordx4 v[108:111], v8, s[16:19], s65 offen sc1
    s_waitcnt vmcnt(0)
    v_max3_u32 v112, v104, v105, v106
    v_max_u32 v112, v112, v107
    v_max3_u32 v113, v108, v109, v110
    v_max_u32 v113, v113, v111
    v_max_u32 v112, v112, v113
    v_cmp_eq_u32 vcc, -1, v112
    s_cbranch_vccz Lok_101
    s_sleep 4
    s_sub_u32 s28, s28, 1
    s_cbranch_scc0 La_p2
    s_branch Lfail
Lok_101:
    ds_write_b128 v9, v[104:107]
    ds_write_b128 v9, v[108:111] offset:6144
    s_branch La_pj
La_p1:
    buffer_load_dwordx4 v[104:107], v8, s[16:19], s64 offen sc1
    s_waitcnt vmcnt(0)
    v_max_u32 v112, v104, v105
    v_max_u32 v113, v106, v107
    v_max_u32 v112, v112, v113
    v_cmp_eq_u32 vcc, -1, v112
    s_cbranch_vccz Lok_102
    s_sleep 4
    s_sub_u32 s28, s28, 1
    s_cbranch_scc0 La_p1
    s_branch Lfail
Lok_102:
    ds_write_b128 v9, v[104:107]
La_pj:
    s_waitcnt lgkmcnt(0)
    s_barrier
    ds_read_b64_tr_b16 v[88:89], v7 offset:0
    ds_read_b64_tr_b16 v[90:91], v7 offset:384
    ds_read_b64_tr_b16 v[92:93], v7 offset:768
    ds_read_b64_tr_b16 v[94:95], v7 offset:1152
    ds_read_b64_tr_b16 v[96:97], v7 offset:1536
    ds_read_b64_tr_b16 v[98:99], v7 offset:1920
    ds_read_b64_tr_b16 v[100:101], v7 offset:2304
    s_waitcnt lgkmcnt(5)
    v_mfma_f32_16x16x32_bf16 v[80:83], v[88:91], v[32:35], 0
    s_waitcnt lgkmcnt(3)
    v_mfma_f32_16x16x32_bf16 v[80:83], v[92:95], v[36:39], v[80:83]
    s_waitcnt lgkmcnt(1)
    v_mfma_f32_16x16x32_bf16 v[80:83], v[96:99], v[40:43], v[80:83]
    v_mfma_f32_16x16x32_bf16 v[84:87], v[88:91], v[46:49], 0
    v_mfma_f32_16x16x32_bf16 v[84:87], v[92:95], v[50:53], v[84:87]
    v_mfma_f32_16x16x32_bf16 v[84:87], v[96:99], v[54:57], v[84:87]
    s_waitcnt lgkmcnt(0)
    s_nop 3
    v_mfma_f32_16x16x16_bf16 v[80:83], v[100:101], v[44:45], v[80:83]
    s_nop 1
    v_mfma_f32_16x16x16_bf16 v[84:87], v[100:101], v[58:59], v[84:87]
    ds_write_b128 v10, v[64:67] offset:0
    ds_write_b128 v10, v[68:71] offset:1024
    ds_write_b128 v10, v[72:75] offset:2048
    ds_write_b128 v10, v[76:79] offset:3072
    s_nop 0
    ds_write_b128 v10, v[80:83] offset:4096
    s_nop 1
    ds_write_b128 v10, v[84:87] offset:5120
    s_waitcnt lgkmcnt(0)
    s_barrier
    s_cmp_ge_u32 s24, 2
    s_cbranch_scc1 La_next
    ds_read_b128 v[64:67], v11 offset:0
    ds_read_b128 v[76:79], v11 offset:6144
    ds_read_b128 v[80:83], v11 offset:12288
    ds_read_b128 v[84:87], v11 offset:18432
    s_waitcnt lgkmcnt(1)
    v_add_f32 v76, v76, v80
    s_waitcnt lgkmcnt(0)
    v_add_f32 v64, v64, v84
    v_add_f32 v77, v77, v81
    v_add_f32 v65, v65, v85
    v_add_f32 v78, v78, v82
    v_add_f32 v66, v66, v86
    v_add_f32 v79, v79, v83
    v_add_f32 v67, v67, v87
    v_add_f32 v64, v64, v76
    v_add_f32 v65, v65, v77
    v_add_f32 v66, v66, v78
    v_add_f32 v67, v67, v79
    ds_read_b128 v[68:71], v11 offset:2048
    ds_read_b128 v[76:79], v11 offset:8192
    ds_read_b128 v[80:83], v11 offset:14336
    ds_read_b128 v[84:87], v11 offset:20480
    s_waitcnt lgkmcnt(1)
    v_add_f32 v76, v76, v80
    s_waitcnt lgkmcnt(0)
    v_add_f32 v68, v68, v84
    v_add_f32 v77, v77, v81
    v_add_f32 v69, v69, v85
    v_add_f32 v78, v78, v82
    v_add_f32 v70, v70, v86
    v_add_f32 v79, v79, v83
    v_add_f32 v71, v71, v87
    v_add_f32 v68, v68, v76
    v_add_f32 v69, v69, v77
    v_add_f32 v70, v70, v78
    v_add_f32 v71, v71, v79
    ds_read_b128 v[72:75], v11 offset:4096
    ds_read_b128 v[76:79], v11 offset:10240
    ds_read_b128 v[80:83], v11 offset:16384
    ds_read_b128 v[84:87], v11 offset:22528
    s_waitcnt lgkmcnt(1)
    v_add_f32 v76, v76, v80
    s_waitcnt lgkmcnt(0)
    v_add_f32 v72, v72, v84
    v_add_f32 v77, v77, v81
    v_add_f32 v73, v73, v85
    v_add_f32 v78, v78, v82
    v_add_f32 v74, v74, v86
    v_add_f32 v79, v79, v83
    v_add_f32 v75, v75, v87
    v_add_f32 v72, v72, v76
    v_add_f32 v73, v73, v77
    v_add_f32 v74, v74, v78
    v_add_f32 v75, v75, v79
    v_mov_b32 v76, 0xff800000
    v_cndmask_b32 v64, v76, v64, s[68:69]
    v_cndmask_b32 v65, v76, v65, s[70:71]
    v_cndmask_b32 v66, v76, v66, s[72:73]
    v_cndmask_b32 v67, v76, v67, s[74:75]
    v_cndmask_b32 v68, v76, v68, s[76:77]
    v_cndmask_b32 v69, v76, v69, s[78:79]
    v_cndmask_b32 v70, v76, v70, s[80:81]
    v_cndmask_b32 v71, v76, v71, s[82:83]
    v_max3_f32 v77, v64, v65, v66
    v_max3_f32 v77, v77, v67, v68
    v_max3_f32 v77, v77, v69, v70
    v_max3_f32 v77, v77, v71, v72
    v_max3_f32 v77, v77, v73, v74
    v_max_f32 v77, v77, v75
    v_mov_b32 v78, v77
    s_nop 1
    v_permlane16_swap_b32 v77, v78
    v_max_f32 v77, v77, v78
    v_mov_b32 v78, v77
    s_nop 1
    v_permlane32_swap_b32 v77, v78
    v_max_f32 v77, v77, v78
    v_sub_f32 v64, v64, v77
    v_sub_f32 v65, v65, v77
    v_sub_f32 v66, v66, v77
    v_sub_f32 v67, v67, v77
    v_sub_f32 v68, v68, v77
    v_sub_f32 v69, v69, v77
    v_sub_f32 v70, v70, v77
    v_sub_f32 v71, v71, v77
    v_sub_f32 v72, v72, v77
    v_sub_f32 v73, v73, v77
    v_sub_f32 v74, v74, v77
    v_sub_f32 v75, v75, v77
    v_exp_f32 v64, v64
    v_exp_f32 v65, v65
    v_exp_f32 v66, v66
    v_exp_f32 v67, v67
    v_exp_f32 v68, v68
    v_exp_f32 v69, v69
    v_exp_f32 v70, v70
    v_exp_f32 v71, v71
    v_exp_f32 v72, v72
    v_exp_f32 v73, v73
    v_exp_f32 v74, v74
    v_exp_f32 v75, v75
    v_add_f32 v80, v72, v73
    v_add_f32 v79, v74, v75
    v_add_f32 v80, v80, v79
    v_add_f32 v79, v64, v65
    v_add_f32 v79, v79, v66
    v_add_f32 v79, v79, v67
    v_add_f32 v79, v79, v68
    v_add_f32 v79, v79, v69
    v_add_f32 v79, v79, v70
    v_add_f32 v79, v79, v71
    v_fmac_f32 v79, 0.5, v80
    v_mov_b32 v78, v79
    s_nop 1
    v_permlane16_swap_b32 v79, v78
    v_add_f32 v79, v79, v78
    v_mov_b32 v78, v79
    s_nop 1
    v_permlane32_swap_b32 v79, v78
    v_add_f32 v79, v79, v78
    v_rcp_f32 v79, v79
    s_nop 0
    v_mul_f32 v64, v64, v79
    v_mul_f32 v65, v65, v79
    v_mul_f32 v66, v66, v79
    v_mul_f32 v67, v67, v79
    v_mul_f32 v68, v68, v79
    v_mul_f32 v69, v69, v79
    v_mul_f32 v70, v70, v79
    v_mul_f32 v71, v71, v79
    v_mul_f32 v72, v72, v79
    v_mul_f32 v73, v73, v79
    v_mul_f32 v74, v74, v79
    v_mul_f32 v75, v75, v79
    v_cvt_pk_bf16_f32 v84, v64, v65
    v_cvt_pk_bf16_f32 v85, v66, v67
    v_cvt_pk_bf16_f32 v86, v68, v69
    v_cvt_pk_bf16_f32 v87, v70, v71
    v_cvt_pk_bf16_f32 v88, v72, v73
    v_cvt_pk_bf16_f32 v89, v74, v75
    s_lshl_b32 s33, s61, 4
    s_add_u32 s33, s33, s25
    s_lshl_b32 s33, s33, 1
    s_add_u32 s33, s33, s24
    s_lshl_b32 s33, s33, 10
    s_add_u32 s33, s33, 69206016
    s_lshl_b32 s34, s61, 2
    s_lshr_b32 s35, s25, 2
    s_add_u32 s34, s34, s35
    s_lshl_b32 s34, s34, 1
    s_add_u32 s34, s34, s24
    s_lshl_b32 s34, s34, 10
    s_and_b32 s35, s25, 3
    s_lshl_b32 s35, s35, 8
    s_add_u32 s34, s34, s35
    s_add_u32 s34, s34, 71303168
    buffer_store_dwordx4 v[84:87], v2, s[16:19], s33 offen sc1
    s_mov_b32 exec_hi, 0
    buffer_store_dwordx2 v[88:89], v12, s[16:19], s34 offen sc1
    s_mov_b64 exec, -1
La_next:
    s_lshl_b32 s84, s61, 4
    s_add_u32 s84, s84, s25
    s_lshl_b32 s84, s84, 6
    s_add_u32 s84, s84, 15597568
    s_add_u32 s61, s61, 7
    s_branch La_top
Lw_b:
    s_sub_u32 s25, s99, 16
    v_and_b32 v1, 63, v0
    v_lshlrev_b32 v2, 4, v1
    v_mov_b32 v4, 0
    v_mov_b32 v7, 1
    v_bfe_u32 v5, v1, 2, 2
    v_lshlrev_b32 v8, 3, v5
    v_and_b32 v5, 3, v1
    v_add_u32 v8, v8, v5
    v_mul_u32_u24 v8, 896, v8
    v_lshrrev_b32 v5, 4, v1
    v_lshl_add_u32 v8, v5, 4, v8
    s_mov_b32 s61, s60
    s_mul_i32 s63, s61, 28672
    s_mov_b32 s62, 0
    s_mul_i32 s33, s24, 7168
    s_add_u32 s33, s33, s62
    s_lshr_b32 s36, s24, 1
    s_mul_i32 s36, s36, 3584
    s_and_b32 s34, s24, 1
    s_mul_i32 s34, s34, 448
    s_add_u32 s34, s34, s36
    s_add_u32 s34, s34, s63
    s_add_u32 m0, s33, 0
    s_nop 0
    buffer_load_dwordx4 v8, s[12:15], s34 offen offset:0 lds
    s_add_u32 m0, s33, 960
    s_nop 0
    buffer_load_dwordx4 v8, s[12:15], s34 offen offset:64 lds
    s_add_u32 m0, s33, 1920
    s_nop 0
    buffer_load_dwordx4 v8, s[12:15], s34 offen offset:128 lds
    s_add_u32 m0, s33, 2880
    s_nop 0
    buffer_load_dwordx4 v8, s[12:15], s34 offen offset:192 lds
    s_add_u32 m0, s33, 3840
    s_nop 0
    buffer_load_dwordx4 v8, s[12:15], s34 offen offset:256 lds
    s_add_u32 m0, s33, 4800
    s_nop 0
    buffer_load_dwordx4 v8, s[12:15], s34 offen offset:320 lds
    s_add_u32 m0, s33, 5760
    s_nop 0
    buffer_load_dwordx4 v8, s[12:15], s34 offen offset:384 lds
    s_mul_i32 s33, s24, 7
    s_add_u32 s33, s33, 0
    s_lshr_b32 s35, s33, 1
    s_lshl_b32 s35, s35, 2
    s_lshr_b32 s34, s25, 2
    s_add_u32 s35, s35, s34
    s_lshl_b32 s35, s35, 3
    s_and_b32 s34, s25, 3
    s_lshl_b32 s34, s34, 1
    s_add_u32 s35, s35, s34
    s_and_b32 s33, s33, 1
    s_add_u32 s35, s35, s33
    s_mul_i32 s35, s35, 14336
    s_add_u32 s35, s35, 6815744
    buffer_load_dwordx4 a[0:3], v2, s[16:19], s35 offen offset:0 sc1
    buffer_load_dwordx4 a[4:7], v2, s[16:19], s35 offen offset:1024 sc1
    buffer_load_dwordx4 a[8:11], v2, s[16:19], s35 offen offset:2048 sc1
    buffer_load_dwordx4 a[12:15], v2, s[16:19], s35 offen offset:3072 sc1
    s_add_u32 s35, s35, 4096
    buffer_load_dwordx4 a[16:19], v2, s[16:19], s35 offen offset:0 sc1
    buffer_load_dwordx4 a[20:23], v2, s[16:19], s35 offen offset:1024 sc1
    buffer_load_dwordx4 a[24:27], v2, s[16:19], s35 offen offset:2048 sc1
    buffer_load_dwordx4 a[28:31], v2, s[16:19], s35 offen offset:3072 sc1
    s_add_u32 s35, s35, 4096
    buffer_load_dwordx4 a[32:35], v2, s[16:19], s35 offen offset:0 sc1
    buffer_load_dwordx4 a[36:39], v2, s[16:19], s35 offen offset:1024 sc1
    buffer_load_dwordx4 a[40:43], v2, s[16:19], s35 offen offset:2048 sc1
    buffer_load_dwordx4 a[44:47], v2, s[16:19], s35 offen offset:3072 sc1
    s_add_u32 s35, s35, 4096
    buffer_load_dwordx4 a[48:51], v2, s[16:19], s35 offen offset:0 sc1
    buffer_load_dwordx4 a[52:55], v2, s[16:19], s35 offen offset:1024 sc1
    s_mul_i32 s33, s24, 7
    s_add_u32 s33, s33, 1
    s_lshr_b32 s35, s33, 1
    s_lshl_b32 s35, s35, 2
    s_lshr_b32 s34, s25, 2
    s_add_u32 s35, s35, s34
    s_lshl_b32 s35, s35, 3
    s_and_b32 s34, s25, 3
    s_lshl_b32 s34, s34, 1
    s_add_u32 s35, s35, s34
    s_and_b32 s33, s33, 1
    s_add_u32 s35, s35, s33
    s_mul_i32 s35, s35, 14336
    s_add_u32 s35, s35, 6815744
    buffer_load_dwordx4 a[56:59], v2, s[16:19], s35 offen offset:0 sc1
    buffer_load_dwordx4 a[60:63], v2, s[16:19], s35 offen offset:1024 sc1
    buffer_load_dwordx4 a[64:67], v2, s[16:19], s35 offen offset:2048 sc1
    buffer_load_dwordx4 a[68:71], v2, s[16:19], s35 offen offset:3072 sc1
    s_add_u32 s35, s35, 4096
    buffer_load_dwordx4 a[72:75], v2, s[16:19], s35 offen offset:0 sc1
    buffer_load_dwordx4 a[76:79], v2, s[16:19], s35 offen offset:1024 sc1
    buffer_load_dwordx4 a[80:83], v2, s[16:19], s35 offen offset:2048 sc1
    buffer_load_dwordx4 a[84:87], v2, s[16:19], s35 offen offset:3072 sc1
    s_add_u32 s35, s35, 4096
    buffer_load_dwordx4 a[88:91], v2, s[16:19], s35 offen offset:0 sc1
    buffer_load_dwordx4 a[92:95], v2, s[16:19], s35 offen offset:1024 sc1
    buffer_load_dwordx4 a[96:99], v2, s[16:19], s35 offen offset:2048 sc1
    buffer_load_dwordx4 a[100:103], v2, s[16:19], s35 offen offset:3072 sc1
    s_add_u32 s35, s35, 4096
    buffer_load_dwordx4 a[104:107], v2, s[16:19], s35 offen offset:0 sc1
    buffer_load_dwordx4 a[108:111], v2, s[16:19], s35 offen offset:1024 sc1
    s_mul_i32 s33, s24, 7
    s_add_u32 s33, s33, 2
    s_lshr_b32 s35, s33, 1
    s_lshl_b32 s35, s35, 2
    s_lshr_b32 s34, s25, 2
    s_add_u32 s35, s35, s34
    s_lshl_b32 s35, s35, 3
    s_and_b32 s34, s25, 3
    s_lshl_b32 s34, s34, 1
    s_add_u32 s35, s35, s34
    s_and_b32 s33, s33, 1
    s_add_u32 s35, s35, s33
    s_mul_i32 s35, s35, 14336
    s_add_u32 s35, s35, 6815744
    buffer_load_dwordx4 a[112:115], v2, s[16:19], s35 offen offset:0 sc1
    buffer_load_dwordx4 a[116:119], v2, s[16:19], s35 offen offset:1024 sc1
    buffer_load_dwordx4 a[120:123], v2, s[16:19], s35 offen offset:2048 sc1
    buffer_load_dwordx4 a[124:127], v2, s[16:19], s35 offen offset:3072 sc1
    s_add_u32 s35, s35, 4096
    buffer_load_dwordx4 a[128:131], v2, s[16:19], s35 offen offset:0 sc1
    buffer_load_dwordx4 a[132:135], v2, s[16:19], s35 offen offset:1024 sc1
    buffer_load_dwordx4 a[136:139], v2, s[16:19], s35 offen offset:2048 sc1
    buffer_load_dwordx4 a[140:143], v2, s[16:19], s35 offen offset:3072 sc1
    s_add_u32 s35, s35, 4096
    buffer_load_dwordx4 a[144:147], v2, s[16:19], s35 offen offset:0 sc1
    buffer_load_dwordx4 a[148:151], v2, s[16:19], s35 offen offset:1024 sc1
    buffer_load_dwordx4 a[152:155], v2, s[16:19], s35 offen offset:2048 sc1
    buffer_load_dwordx4 a[156:159], v2, s[16:19], s35 offen offset:3072 sc1
    s_add_u32 s35, s35, 4096
    buffer_load_dwordx4 a[160:163], v2, s[16:19], s35 offen offset:0 sc1
    buffer_load_dwordx4 a[164:167], v2, s[16:19], s35 offen offset:1024 sc1
    s_mul_i32 s33, s24, 7
    s_add_u32 s33, s33, 3
    s_lshr_b32 s35, s33, 1
    s_lshl_b32 s35, s35, 2
    s_lshr_b32 s34, s25, 2
    s_add_u32 s35, s35, s34
    s_lshl_b32 s35, s35, 3
    s_and_b32 s34, s25, 3
    s_lshl_b32 s34, s34, 1
    s_add_u32 s35, s35, s34
    s_and_b32 s33, s33, 1
    s_add_u32 s35, s35, s33
    s_mul_i32 s35, s35, 14336
    s_add_u32 s35, s35, 6815744
    buffer_load_dwordx4 a[168:171], v2, s[16:19], s35 offen offset:0 sc1
    buffer_load_dwordx4 a[172:175], v2, s[16:19], s35 offen offset:1024 sc1
    buffer_load_dwordx4 a[176:179], v2, s[16:19], s35 offen offset:2048 sc1
    buffer_load_dwordx4 a[180:183], v2, s[16:19], s35 offen offset:3072 sc1
    s_add_u32 s35, s35, 4096
    buffer_load_dwordx4 a[184:187], v2, s[16:19], s35 offen offset:0 sc1
    buffer_load_dwordx4 a[188:191], v2, s[16:19], s35 offen offset:1024 sc1
    s_waitcnt vmcnt(16)
    buffer_load_dwordx4 a[192:195], v2, s[16:19], s35 offen offset:2048 sc1
    buffer_load_dwordx4 a[196:199], v2, s[16:19], s35 offen offset:3072 sc1
    s_add_u32 s35, s35, 4096
    buffer_load_dwordx4 a[200:203], v2, s[16:19], s35 offen offset:0 sc1
    buffer_load_dwordx4 a[204:207], v2, s[16:19], s35 offen offset:1024 sc1
    buffer_load_dwordx4 a[208:211], v2, s[16:19], s35 offen offset:2048 sc1
    buffer_load_dwordx4 a[212:215], v2, s[16:19], s35 offen offset:3072 sc1
    s_add_u32 s35, s35, 4096
    buffer_load_dwordx4 a[216:219], v2, s[16:19], s35 offen offset:0 sc1
    buffer_load_dwordx4 a[220:223], v2, s[16:19], s35 offen offset:1024 sc1
    s_mul_i32 s33, s24, 7
    s_add_u32 s33, s33, 4
    s_lshr_b32 s35, s33, 1
    s_lshl_b32 s35, s35, 2
    s_lshr_b32 s34, s25, 2
    s_add_u32 s35, s35, s34
    s_lshl_b32 s35, s35, 3
    s_and_b32 s34, s25, 3
    s_lshl_b32 s34, s34, 1
    s_add_u32 s35, s35, s34
    s_and_b32 s33, s33, 1
    s_add_u32 s35, s35, s33
    s_mul_i32 s35, s35, 14336
    s_add_u32 s35, s35, 6815744
    buffer_load_dwordx4 a[224:227], v2, s[16:19], s35 offen offset:0 sc1
    buffer_load_dwordx4 a[228:231], v2, s[16:19], s35 offen offset:1024 sc1
    buffer_load_dwordx4 a[232:235], v2, s[16:19], s35 offen offset:2048 sc1
    buffer_load_dwordx4 a[236:239], v2, s[16:19], s35 offen offset:3072 sc1
    s_add_u32 s35, s35, 4096
    buffer_load_dwordx4 a[240:243], v2, s[16:19], s35 offen offset:0 sc1
    buffer_load_dwordx4 a[244:247], v2, s[16:19], s35 offen offset:1024 sc1
    buffer_load_dwordx4 a[248:251], v2, s[16:19], s35 offen offset:2048 sc1
    buffer_load_dwordx4 a[252:255], v2, s[16:19], s35 offen offset:3072 sc1
    s_add_u32 s35, s35, 4096
    buffer_load_dwordx4 v[120:123], v2, s[16:19], s35 offen offset:0 sc1
    buffer_load_dwordx4 v[124:127], v2, s[16:19], s35 offen offset:1024 sc1
    buffer_load_dwordx4 v[128:131], v2, s[16:19], s35 offen offset:2048 sc1
    buffer_load_dwordx4 v[132:135], v2, s[16:19], s35 offen offset:3072 sc1
    s_add_u32 s35, s35, 4096
    buffer_load_dwordx4 v[136:139], v2, s[16:19], s35 offen offset:0 sc1
    buffer_load_dwordx4 v[140:143], v2, s[16:19], s35 offen offset:1024 sc1
    s_mul_i32 s33, s24, 7
    s_add_u32 s33, s33, 5
    s_lshr_b32 s35, s33, 1
    s_lshl_b32 s35, s35, 2
    s_lshr_b32 s34, s25, 2
    s_add_u32 s35, s35, s34
    s_lshl_b32 s35, s35, 3
    s_and_b32 s34, s25, 3
    s_lshl_b32 s34, s34, 1
    s_add_u32 s35, s35, s34
    s_and_b32 s33, s33, 1
    s_add_u32 s35, s35, s33
    s_mul_i32 s35, s35, 14336
    s_add_u32 s35, s35, 6815744
    buffer_load_dwordx4 v[144:147], v2, s[16:19], s35 offen offset:0 sc1
    buffer_load_dwordx4 v[148:151], v2, s[16:19], s35 offen offset:1024 sc1
    buffer_load_dwordx4 v[152:155], v2, s[16:19], s35 offen offset:2048 sc1
    buffer_load_dwordx4 v[156:159], v2, s[16:19], s35 offen offset:3072 sc1
    s_add_u32 s35, s35, 4096
    buffer_load_dwordx4 v[160:163], v2, s[16:19], s35 offen offset:0 sc1
    buffer_load_dwordx4 v[164:167], v2, s[16:19], s35 offen offset:1024 sc1
    buffer_load_dwordx4 v[168:171], v2, s[16:19], s35 offen offset:2048 sc1
    buffer_load_dwordx4 v[172:175], v2, s[16:19], s35 offen offset:3072 sc1
    s_add_u32 s35, s35, 4096
    buffer_load_dwordx4 v[176:179], v2, s[16:19], s35 offen offset:0 sc1
    buffer_load_dwordx4 v[180:183], v2, s[16:19], s35 offen offset:1024 sc1
    buffer_load_dwordx4 v[184:187], v2, s[16:19], s35 offen offset:2048 sc1
    buffer_load_dwordx4 v[188:191], v2, s[16:19], s35 offen offset:3072 sc1
    s_add_u32 s35, s35, 4096
    buffer_load_dwordx4 v[192:195], v2, s[16:19], s35 offen offset:0 sc1
    buffer_load_dwordx4 v[196:199], v2, s[16:19], s35 offen offset:1024 sc1
    s_mul_i32 s33, s24, 7
    s_add_u32 s33, s33, 6
    s_lshr_b32 s35, s33, 1
    s_lshl_b32 s35, s35, 2
    s_lshr_b32 s34, s25, 2
    s_add_u32 s35, s35, s34
    s_lshl_b32 s35, s35, 3
    s_and_b32 s34, s25, 3
    s_lshl_b32 s34, s34, 1
    s_add_u32 s35, s35, s34
    s_and_b32 s33, s33, 1
    s_add_u32 s35, s35, s33
    s_mul_i32 s35, s35, 14336
    s_add_u32 s35, s35, 6815744
    buffer_load_dwordx4 v[200:203], v2, s[16:19], s35 offen offset:0 sc1
    buffer_load_dwordx4 v[204:207], v2, s[16:19], s35 offen offset:1024 sc1
    buffer_load_dwordx4 v[208:211], v2, s[16:19], s35 offen offset:2048 sc1
    buffer_load_dwordx4 v[212:215], v2, s[16:19], s35 offen offset:3072 sc1
    s_add_u32 s35, s35, 4096
    buffer_load_dwordx4 v[216:219], v2, s[16:19], s35 offen offset:0 sc1
    buffer_load_dwordx4 v[220:223], v2, s[16:19], s35 offen offset:1024 sc1
    buffer_load_dwordx4 v[224:227], v2, s[16:19], s35 offen offset:2048 sc1
    buffer_load_dwordx4 v[228:231], v2, s[16:19], s35 offen offset:3072 sc1
    s_add_u32 s35, s35, 4096
    buffer_load_dwordx4 v[232:235], v2, s[16:19], s35 offen offset:0 sc1
    buffer_load_dwordx4 v[236:239], v2, s[16:19], s35 offen offset:1024 sc1
    buffer_load_dwordx4 v[240:243], v2, s[16:19], s35 offen offset:2048 sc1
    buffer_load_dwordx4 v[244:247], v2, s[16:19], s35 offen offset:3072 sc1
    s_waitcnt vmcnt(16)
    s_add_u32 s35, s35, 4096
    buffer_load_dwordx4 v[248:251], v2, s[16:19], s35 offen offset:0 sc1
    buffer_load_dwordx4 v[252:255], v2, s[16:19], s35 offen offset:1024 sc1
    s_mov_b32 s84, -1
Lb_top:
    s_waitcnt vmcnt(0)
    s_barrier
    s_cmp_eq_u32 s84, -1
    s_cbranch_scc1 Lbs_103
    s_cmp_eq_u32 s24, 0
    s_cbranch_scc0 Lbs_103
    s_mov_b64 exec, 1
    buffer_store_dword v7, v4, s[16:19], s84 offen sc1
    s_mov_b64 exec, -1
Lbs_103:
    s_cmp_ge_u32 s61, 64
    s_cbranch_scc1 Lb_end
    v_add_u32 v3, s62, v2
    s_xor_b32 s62, s62, 28672
    s_add_u32 s63, s63, 200704
    s_add_u32 s33, s61, 7
    s_cmp_ge_u32 s33, 64
    s_cbranch_scc1 Lb_nodma
    s_mul_i32 s33, s24, 7168
    s_add_u32 s33, s33, s62
    s_lshr_b32 s36, s24, 1
    s_mul_i32 s36, s36, 3584
    s_and_b32 s34, s24, 1
    s_mul_i32 s34, s34, 448
    s_add_u32 s34, s34, s36
    s_add_u32 s34, s34, s63
    s_add_u32 m0, s33, 0
    s_nop 0
    buffer_load_dwordx4 v8, s[12:15], s34 offen offset:0 lds
    s_add_u32 m0, s33, 960
    s_nop 0
    buffer_load_dwordx4 v8, s[12:15], s34 offen offset:64 lds
    s_add_u32 m0, s33, 1920
    s_nop 0
    buffer_load_dwordx4 v8, s[12:15], s34 offen offset:128 lds
    s_add_u32 m0, s33, 2880
    s_nop 0
    buffer_load_dwordx4 v8, s[12:15], s34 offen offset:192 lds
    s_add_u32 m0, s33, 3840
    s_nop 0
    buffer_load_dwordx4 v8, s[12:15], s34 offen offset:256 lds
    s_add_u32 m0, s33, 4800
    s_nop 0
    buffer_load_dwordx4 v8, s[12:15], s34 offen offset:320 lds
    s_add_u32 m0, s33, 5760
    s_nop 0
    buffer_load_dwordx4 v8, s[12:15], s34 offen offset:384 lds
Lb_nodma:
    ds_read_b128 v[16:19], v3 offset:0
    ds_read_b128 v[20:23], v3 offset:14336
    ds_read_b128 v[24:27], v3 offset:1024
    ds_read_b128 v[28:31], v3 offset:15360
    s_waitcnt lgkmcnt(3)
    v_mfma_f32_16x16x32_bf16 v[64:67], v[16:19], a[0:3], 0
    s_waitcnt lgkmcnt(2)
    v_mfma_f32_16x16x32_bf16 v[92:95], v[20:23], a[0:3], 0
    v_mfma_f32_16x16x32_bf16 v[68:71], v[16:19], a[56:59], 0
    v_mfma_f32_16x16x32_bf16 v[96:99], v[20:23], a[56:59], 0
    v_mfma_f32_16x16x32_bf16 v[72:75], v[16:19], a[112:115], 0
    v_mfma_f32_16x16x32_bf16 v[100:103], v[20:23], a[112:115], 0
    v_mfma_f32_16x16x32_bf16 v[76:79], v[16:19], a[168:171], 0
    v_mfma_f32_16x16x32_bf16 v[104:107], v[20:23], a[168:171], 0
    v_mfma_f32_16x16x32_bf16 v[80:83], v[16:19], a[224:227], 0
    v_mfma_f32_16x16x32_bf16 v[108:111], v[20:23], a[224:227], 0
    v_mfma_f32_16x16x32_bf16 v[84:87], v[16:19], v[144:147], 0
    v_mfma_f32_16x16x32_bf16 v[112:115], v[20:23], v[144:147], 0
    v_mfma_f32_16x16x32_bf16 v[88:91], v[16:19], v[200:203], 0
    v_mfma_f32_16x16x32_bf16 v[116:119], v[20:23], v[200:203], 0
    ds_read_b128 v[16:19], v3 offset:2048
    ds_read_b128 v[20:23], v3 offset:16384
    s_waitcnt lgkmcnt(3)
    v_mfma_f32_16x16x32_bf16 v[64:67], v[24:27], a[4:7], v[64:67]
    s_waitcnt lgkmcnt(2)
    v_mfma_f32_16x16x32_bf16 v[92:95], v[28:31], a[4:7], v[92:95]
    v_mfma_f32_16x16x32_bf16 v[68:71], v[24:27], a[60:63], v[68:71]
    v_mfma_f32_16x16x32_bf16 v[96:99], v[28:31], a[60:63], v[96:99]
    v_mfma_f32_16x16x32_bf16 v[72:75], v[24:27], a[116:119], v[72:75]
    v_mfma_f32_16x16x32_bf16 v[100:103], v[28:31], a[116:119], v[100:103]
    v_mfma_f32_16x16x32_bf16 v[76:79], v[24:27], a[172:175], v[76:79]
    v_mfma_f32_16x16x32_bf16 v[104:107], v[28:31], a[172:175], v[104:107]
    v_mfma_f32_16x16x32_bf16 v[80:83], v[24:27], a[228:231], v[80:83]
    v_mfma_f32_16x16x32_bf16 v[108:111], v[28:31], a[228:231], v[108:111]
    v_mfma_f32_16x16x32_bf16 v[84:87], v[24:27], v[148:151], v[84:87]
    v_mfma_f32_16x16x32_bf16 v[112:115], v[28:31], v[148:151], v[112:115]
    v_mfma_f32_16x16x32_bf16 v[88:91], v[24:27], v[204:207], v[88:91]
    v_mfma_f32_16x16x32_bf16 v[116:119], v[28:31], v[204:207], v[116:119]
    ds_read_b128 v[24:27], v3 offset:3072
    ds_read_b128 v[28:31], v3 offset:17408
    s_waitcnt lgkmcnt(3)
    v_mfma_f32_16x16x32_bf16 v[64:67], v[16:19], a[8:11], v[64:67]
    s_waitcnt lgkmcnt(2)
    v_mfma_f32_16x16x32_bf16 v[92:95], v[20:23], a[8:11], v[92:95]
    v_mfma_f32_16x16x32_bf16 v[68:71], v[16:19], a[64:67], v[68:71]
    v_mfma_f32_16x16x32_bf16 v[96:99], v[20:23], a[64:67], v[96:99]
    v_mfma_f32_16x16x32_bf16 v[72:75], v[16:19], a[120:123], v[72:75]
    v_mfma_f32_16x16x32_bf16 v[100:103], v[20:23], a[120:123], v[100:103]
    v_mfma_f32_16x16x32_bf16 v[76:79], v[16:19], a[176:179], v[76:79]
    v_mfma_f32_16x16x32_bf16 v[104:107], v[20:23], a[176:179], v[104:107]
    v_mfma_f32_16x16x32_bf16 v[80:83], v[16:19], a[232:235], v[80:83]
    v_mfma_f32_16x16x32_bf16 v[108:111], v[20:23], a[232:235], v[108:111]
    v_mfma_f32_16x16x32_bf16 v[84:87], v[16:19], v[152:155], v[84:87]
    v_mfma_f32_16x16x32_bf16 v[112:115], v[20:23], v[152:155], v[112:115]
    v_mfma_f32_16x16x32_bf16 v[88:91], v[16:19], v[208:211], v[88:91]
    v_mfma_f32_16x16x32_bf16 v[116:119], v[20:23], v[208:211], v[116:119]
    ds_read_b128 v[16:19], v3 offset:4096
    ds_read_b128 v[20:23], v3 offset:18432
    s_waitcnt lgkmcnt(3)
    v_mfma_f32_16x16x32_bf16 v[64:67], v[24:27], a[12:15], v[64:67]
    s_waitcnt lgkmcnt(2)
    v_mfma_f32_16x16x32_bf16 v[92:95], v[28:31], a[12:15], v[92:95]
    v_mfma_f32_16x16x32_bf16 v[68:71], v[24:27], a[68:71], v[68:71]
    v_mfma_f32_16x16x32_bf16 v[96:99], v[28:31], a[68:71], v[96:99]
    v_mfma_f32_16x16x32_bf16 v[72:75], v[24:27], a[124:127], v[72:75]
    v_mfma_f32_16x16x32_bf16 v[100:103], v[28:31], a[124:127], v[100:103]
    v_mfma_f32_16x16x32_bf16 v[76:79], v[24:27], a[180:183], v[76:79]
    v_mfma_f32_16x16x32_bf16 v[104:107], v[28:31], a[180:183], v[104:107]
    v_mfma_f32_16x16x32_bf16 v[80:83], v[24:27], a[236:239], v[80:83]
    v_mfma_f32_16x16x32_bf16 v[108:111], v[28:31], a[236:239], v[108:111]
    v_mfma_f32_16x16x32_bf16 v[84:87], v[24:27], v[156:159], v[84:87]
    v_mfma_f32_16x16x32_bf16 v[112:115], v[28:31], v[156:159], v[112:115]
    v_mfma_f32_16x16x32_bf16 v[88:91], v[24:27], v[212:215], v[88:91]
    v_mfma_f32_16x16x32_bf16 v[116:119], v[28:31], v[212:215], v[116:119]
    ds_read_b128 v[24:27], v3 offset:5120
    ds_read_b128 v[28:31], v3 offset:19456
    s_waitcnt lgkmcnt(3)
    v_mfma_f32_16x16x32_bf16 v[64:67], v[16:19], a[16:19], v[64:67]
    s_waitcnt lgkmcnt(2)
    v_mfma_f32_16x16x32_bf16 v[92:95], v[20:23], a[16:19], v[92:95]
    v_mfma_f32_16x16x32_bf16 v[68:71], v[16:19], a[72:75], v[68:71]
    v_mfma_f32_16x16x32_bf16 v[96:99], v[20:23], a[72:75], v[96:99]
    v_mfma_f32_16x16x32_bf16 v[72:75], v[16:19], a[128:131], v[72:75]
    v_mfma_f32_16x16x32_bf16 v[100:103], v[20:23], a[128:131], v[100:103]
    v_mfma_f32_16x16x32_bf16 v[76:79], v[16:19], a[184:187], v[76:79]
    v_mfma_f32_16x16x32_bf16 v[104:107], v[20:23], a[184:187], v[104:107]
    v_mfma_f32_16x16x32_bf16 v[80:83], v[16:19], a[240:243], v[80:83]
    v_mfma_f32_16x16x32_bf16 v[108:111], v[20:23], a[240:243], v[108:111]
    v_mfma_f32_16x16x32_bf16 v[84:87], v[16:19], v[160:163], v[84:87]
    v_mfma_f32_16x16x32_bf16 v[112:115], v[20:23], v[160:163], v[112:115]
    v_mfma_f32_16x16x32_bf16 v[88:91], v[16:19], v[216:219], v[88:91]
    v_mfma_f32_16x16x32_bf16 v[116:119], v[20:23], v[216:219], v[116:119]
    ds_read_b128 v[16:19], v3 offset:6144
    ds_read_b128 v[20:23], v3 offset:20480
    s_waitcnt lgkmcnt(3)
    v_mfma_f32_16x16x32_bf16 v[64:67], v[24:27], a[20:23], v[64:67]
    s_waitcnt lgkmcnt(2)
    v_mfma_f32_16x16x32_bf16 v[92:95], v[28:31], a[20:23], v[92:95]
    v_mfma_f32_16x16x32_bf16 v[68:71], v[24:27], a[76:79], v[68:71]
    v_mfma_f32_16x16x32_bf16 v[96:99], v[28:31], a[76:79], v[96:99]
    v_mfma_f32_16x16x32_bf16 v[72:75], v[24:27], a[132:135], v[72:75]
    v_mfma_f32_16x16x32_bf16 v[100:103], v[28:31], a[132:135], v[100:103]
    v_mfma_f32_16x16x32_bf16 v[76:79], v[24:27], a[188:191], v[76:79]
    v_mfma_f32_16x16x32_bf16 v[104:107], v[28:31], a[188:191], v[104:107]
    v_mfma_f32_16x16x32_bf16 v[80:83], v[24:27], a[244:247], v[80:83]
    v_mfma_f32_16x16x32_bf16 v[108:111], v[28:31], a[244:247], v[108:111]
    v_mfma_f32_16x16x32_bf16 v[84:87], v[24:27], v[164:167], v[84:87]
    v_mfma_f32_16x16x32_bf16 v[112:115], v[28:31], v[164:167], v[112:115]
    v_mfma_f32_16x16x32_bf16 v[88:91], v[24:27], v[220:223], v[88:91]
    v_mfma_f32_16x16x32_bf16 v[116:119], v[28:31], v[220:223], v[116:119]
    ds_read_b128 v[24:27], v3 offset:7168
    ds_read_b128 v[28:31], v3 offset:21504
    s_waitcnt lgkmcnt(3)
    v_mfma_f32_16x16x32_bf16 v[64:67], v[16:19], a[24:27], v[64:67]
    s_waitcnt lgkmcnt(2)
    v_mfma_f32_16x16x32_bf16 v[92:95], v[20:23], a[24:27], v[92:95]
    v_mfma_f32_16x16x32_bf16 v[68:71], v[16:19], a[80:83], v[68:71]
    v_mfma_f32_16x16x32_bf16 v[96:99], v[20:23], a[80:83], v[96:99]
    v_mfma_f32_16x16x32_bf16 v[72:75], v[16:19], a[136:139], v[72:75]
    v_mfma_f32_16x16x32_bf16 v[100:103], v[20:23], a[136:139], v[100:103]
    v_mfma_f32_16x16x32_bf16 v[76:79], v[16:19], a[192:195], v[76:79]
    v_mfma_f32_16x16x32_bf16 v[104:107], v[20:23], a[192:195], v[104:107]
    v_mfma_f32_16x16x32_bf16 v[80:83], v[16:19], a[248:251], v[80:83]
    v_mfma_f32_16x16x32_bf16 v[108:111], v[20:23], a[248:251], v[108:111]
    v_mfma_f32_16x16x32_bf16 v[84:87], v[16:19], v[168:171], v[84:87]
    v_mfma_f32_16x16x32_bf16 v[112:115], v[20:23], v[168:171], v[112:115]
    v_mfma_f32_16x16x32_bf16 v[88:91], v[16:19], v[224:227], v[88:91]
    v_mfma_f32_16x16x32_bf16 v[116:119], v[20:23], v[224:227], v[116:119]
    ds_read_b128 v[16:19], v3 offset:8192
    ds_read_b128 v[20:23], v3 offset:22528
    s_waitcnt lgkmcnt(3)
    v_mfma_f32_16x16x32_bf16 v[64:67], v[24:27], a[28:31], v[64:67]
    s_waitcnt lgkmcnt(2)
    v_mfma_f32_16x16x32_bf16 v[92:95], v[28:31], a[28:31], v[92:95]
    v_mfma_f32_16x16x32_bf16 v[68:71], v[24:27], a[84:87], v[68:71]
    v_mfma_f32_16x16x32_bf16 v[96:99], v[28:31], a[84:87], v[96:99]
    v_mfma_f32_16x16x32_bf16 v[72:75], v[24:27], a[140:143], v[72:75]
    v_mfma_f32_16x16x32_bf16 v[100:103], v[28:31], a[140:143], v[100:103]
    v_mfma_f32_16x16x32_bf16 v[76:79], v[24:27], a[196:199], v[76:79]
    v_mfma_f32_16x16x32_bf16 v[104:107], v[28:31], a[196:199], v[104:107]
    v_mfma_f32_16x16x32_bf16 v[80:83], v[24:27], a[252:255], v[80:83]
    v_mfma_f32_16x16x32_bf16 v[108:111], v[28:31], a[252:255], v[108:111]
    v_mfma_f32_16x16x32_bf16 v[84:87], v[24:27], v[172:175], v[84:87]
    v_mfma_f32_16x16x32_bf16 v[112:115], v[28:31], v[172:175], v[112:115]
    v_mfma_f32_16x16x32_bf16 v[88:91], v[24:27], v[228:231], v[88:91]
    v_mfma_f32_16x16x32_bf16 v[116:119], v[28:31], v[228:231], v[116:119]
    ds_read_b128 v[24:27], v3 offset:9216
    ds_read_b128 v[28:31], v3 offset:23552
    s_waitcnt lgkmcnt(3)
    v_mfma_f32_16x16x32_bf16 v[64:67], v[16:19], a[32:35], v[64:67]
    s_waitcnt lgkmcnt(2)
    v_mfma_f32_16x16x32_bf16 v[92:95], v[20:23], a[32:35], v[92:95]
    v_mfma_f32_16x16x32_bf16 v[68:71], v[16:19], a[88:91], v[68:71]
    v_mfma_f32_16x16x32_bf16 v[96:99], v[20:23], a[88:91], v[96:99]
    v_mfma_f32_16x16x32_bf16 v[72:75], v[16:19], a[144:147], v[72:75]
    v_mfma_f32_16x16x32_bf16 v[100:103], v[20:23], a[144:147], v[100:103]
    v_mfma_f32_16x16x32_bf16 v[76:79], v[16:19], a[200:203], v[76:79]
    v_mfma_f32_16x16x32_bf16 v[104:107], v[20:23], a[200:203], v[104:107]
    v_mfma_f32_16x16x32_bf16 v[80:83], v[16:19], v[120:123], v[80:83]
    v_mfma_f32_16x16x32_bf16 v[108:111], v[20:23], v[120:123], v[108:111]
    v_mfma_f32_16x16x32_bf16 v[84:87], v[16:19], v[176:179], v[84:87]
    v_mfma_f32_16x16x32_bf16 v[112:115], v[20:23], v[176:179], v[112:115]
    v_mfma_f32_16x16x32_bf16 v[88:91], v[16:19], v[232:235], v[88:91]
    v_mfma_f32_16x16x32_bf16 v[116:119], v[20:23], v[232:235], v[116:119]
    ds_read_b128 v[16:19], v3 offset:10240
    ds_read_b128 v[20:23], v3 offset:24576
    s_waitcnt lgkmcnt(3)
    v_mfma_f32_16x16x32_bf16 v[64:67], v[24:27], a[36:39], v[64:67]
    s_waitcnt lgkmcnt(2)
    v_mfma_f32_16x16x32_bf16 v[92:95], v[28:31], a[36:39], v[92:95]
    v_mfma_f32_16x16x32_bf16 v[68:71], v[24:27], a[92:95], v[68:71]
    v_mfma_f32_16x16x32_bf16 v[96:99], v[28:31], a[92:95], v[96:99]
    v_mfma_f32_16x16x32_bf16 v[72:75], v[24:27], a[148:151], v[72:75]
    v_mfma_f32_16x16x32_bf16 v[100:103], v[28:31], a[148:151], v[100:103]
    v_mfma_f32_16x16x32_bf16 v[76:79], v[24:27], a[204:207], v[76:79]
    v_mfma_f32_16x16x32_bf16 v[104:107], v[28:31], a[204:207], v[104:107]
    v_mfma_f32_16x16x32_bf16 v[80:83], v[24:27], v[124:127], v[80:83]
    v_mfma_f32_16x16x32_bf16 v[108:111], v[28:31], v[124:127], v[108:111]
    v_mfma_f32_16x16x32_bf16 v[84:87], v[24:27], v[180:183], v[84:87]
    v_mfma_f32_16x16x32_bf16 v[112:115], v[28:31], v[180:183], v[112:115]
    v_mfma_f32_16x16x32_bf16 v[88:91], v[24:27], v[236:239], v[88:91]
    v_mfma_f32_16x16x32_bf16 v[116:119], v[28:31], v[236:239], v[116:119]
    ds_read_b128 v[24:27], v3 offset:11264
    ds_read_b128 v[28:31], v3 offset:25600
    s_waitcnt lgkmcnt(3)
    v_mfma_f32_16x16x32_bf16 v[64:67], v[16:19], a[40:43], v[64:67]
    s_waitcnt lgkmcnt(2)
    v_mfma_f32_16x16x32_bf16 v[92:95], v[20:23], a[40:43], v[92:95]
    v_mfma_f32_16x16x32_bf16 v[68:71], v[16:19], a[96:99], v[68:71]
    v_mfma_f32_16x16x32_bf16 v[96:99], v[20:23], a[96:99], v[96:99]
    v_mfma_f32_16x16x32_bf16 v[72:75], v[16:19], a[152:155], v[72:75]
    v_mfma_f32_16x16x32_bf16 v[100:103], v[20:23], a[152:155], v[100:103]
    v_mfma_f32_16x16x32_bf16 v[76:79], v[16:19], a[208:211], v[76:79]
    v_mfma_f32_16x16x32_bf16 v[104:107], v[20:23], a[208:211], v[104:107]
    v_mfma_f32_16x16x32_bf16 v[80:83], v[16:19], v[128:131], v[80:83]
    v_mfma_f32_16x16x32_bf16 v[108:111], v[20:23], v[128:131], v[108:111]
    v_mfma_f32_16x16x32_bf16 v[84:87], v[16:19], v[184:187], v[84:87]
    v_mfma_f32_16x16x32_bf16 v[112:115], v[20:23], v[184:187], v[112:115]
    v_mfma_f32_16x16x32_bf16 v[88:91], v[16:19], v[240:243], v[88:91]
    v_mfma_f32_16x16x32_bf16 v[116:119], v[20:23], v[240:243], v[116:119]
    ds_read_b128 v[16:19], v3 offset:12288
    ds_read_b128 v[20:23], v3 offset:26624
    s_waitcnt lgkmcnt(3)
    v_mfma_f32_16x16x32_bf16 v[64:67], v[24:27], a[44:47], v[64:67]
    s_waitcnt lgkmcnt(2)
    v_mfma_f32_16x16x32_bf16 v[92:95], v[28:31], a[44:47], v[92:95]
    v_mfma_f32_16x16x32_bf16 v[68:71], v[24:27], a[100:103], v[68:71]
    v_mfma_f32_16x16x32_bf16 v[96:99], v[28:31], a[100:103], v[96:99]
    v_mfma_f32_16x16x32_bf16 v[72:75], v[24:27], a[156:159], v[72:75]
    v_mfma_f32_16x16x32_bf16 v[100:103], v[28:31], a[156:159], v[100:103]
    v_mfma_f32_16x16x32_bf16 v[76:79], v[24:27], a[212:215], v[76:79]
    v_mfma_f32_16x16x32_bf16 v[104:107], v[28:31], a[212:215], v[104:107]
    v_mfma_f32_16x16x32_bf16 v[80:83], v[24:27], v[132:135], v[80:83]
    v_mfma_f32_16x16x32_bf16 v[108:111], v[28:31], v[132:135], v[108:111]
    v_mfma_f32_16x16x32_bf16 v[84:87], v[24:27], v[188:191], v[84:87]
    v_mfma_f32_16x16x32_bf16 v[112:115], v[28:31], v[188:191], v[112:115]
    v_mfma_f32_16x16x32_bf16 v[88:91], v[24:27], v[244:247], v[88:91]
    v_mfma_f32_16x16x32_bf16 v[116:119], v[28:31], v[244:247], v[116:119]
    ds_read_b128 v[24:27], v3 offset:13312
    ds_read_b128 v[28:31], v3 offset:27648
    s_waitcnt lgkmcnt(3)
    v_mfma_f32_16x16x32_bf16 v[64:67], v[16:19], a[48:51], v[64:67]
    s_waitcnt lgkmcnt(2)
    v_mfma_f32_16x16x32_bf16 v[92:95], v[20:23], a[48:51], v[92:95]
    v_mfma_f32_16x16x32_bf16 v[68:71], v[16:19], a[104:107], v[68:71]
    v_mfma_f32_16x16x32_bf16 v[96:99], v[20:23], a[104:107], v[96:99]
    v_mfma_f32_16x16x32_bf16 v[72:75], v[16:19], a[160:163], v[72:75]
    v_mfma_f32_16x16x32_bf16 v[100:103], v[20:23], a[160:163], v[100:103]
    v_mfma_f32_16x16x32_bf16 v[76:79], v[16:19], a[216:219], v[76:79]
    v_mfma_f32_16x16x32_bf16 v[104:107], v[20:23], a[216:219], v[104:107]
    v_mfma_f32_16x16x32_bf16 v[80:83], v[16:19], v[136:139], v[80:83]
    v_mfma_f32_16x16x32_bf16 v[108:111], v[20:23], v[136:139], v[108:111]
    v_mfma_f32_16x16x32_bf16 v[84:87], v[16:19], v[192:195], v[84:87]
    v_mfma_f32_16x16x32_bf16 v[112:115], v[20:23], v[192:195], v[112:115]
    v_mfma_f32_16x16x32_bf16 v[88:91], v[16:19], v[248:251], v[88:91]
    v_mfma_f32_16x16x32_bf16 v[116:119], v[20:23], v[248:251], v[116:119]
    s_waitcnt lgkmcnt(1)
    v_mfma_f32_16x16x32_bf16 v[64:67], v[24:27], a[52:55], v[64:67]
    s_waitcnt lgkmcnt(0)
    v_mfma_f32_16x16x32_bf16 v[92:95], v[28:31], a[52:55], v[92:95]
    v_mfma_f32_16x16x32_bf16 v[68:71], v[24:27], a[108:111], v[68:71]
    v_mfma_f32_16x16x32_bf16 v[96:99], v[28:31], a[108:111], v[96:99]
    v_mfma_f32_16x16x32_bf16 v[72:75], v[24:27], a[164:167], v[72:75]
    v_mfma_f32_16x16x32_bf16 v[100:103], v[28:31], a[164:167], v[100:103]
    v_mfma_f32_16x16x32_bf16 v[76:79], v[24:27], a[220:223], v[76:79]
    v_mfma_f32_16x16x32_bf16 v[104:107], v[28:31], a[220:223], v[104:107]
    v_mfma_f32_16x16x32_bf16 v[80:83], v[24:27], v[140:143], v[80:83]
    v_mfma_f32_16x16x32_bf16 v[108:111], v[28:31], v[140:143], v[108:111]
    v_mfma_f32_16x16x32_bf16 v[84:87], v[24:27], v[196:199], v[84:87]
    v_mfma_f32_16x16x32_bf16 v[112:115], v[28:31], v[196:199], v[112:115]
    v_mfma_f32_16x16x32_bf16 v[88:91], v[24:27], v[252:255], v[88:91]
    v_mfma_f32_16x16x32_bf16 v[116:119], v[28:31], v[252:255], v[116:119]
    s_mul_i32 s64, s61, 458752
    s_add_u32 s64, s64, 16777216
    s_lshr_b32 s33, s25, 2
    s_lshl_b32 s33, s33, 13
    s_add_u32 s64, s64, s33
    s_bfe_u32 s33, s25, 0x10001
    s_lshl_b32 s33, s33, 12
    s_add_u32 s64, s64, s33
    s_and_b32 s33, s25, 1
    s_lshl_b32 s33, s33, 10
    s_add_u32 s64, s64, s33
    s_mul_i32 s33, s24, 7
    s_add_u32 s33, s33, 0
    s_lshr_b32 s34, s33, 1
    s_lshl_b32 s34, s34, 15
    s_and_b32 s33, s33, 1
    s_lshl_b32 s33, s33, 11
    s_add_u32 s34, s34, s33
    s_add_u32 s34, s34, s64
    v_cvt_pk_bf16_f32 v32, v64, v65
    v_cvt_pk_bf16_f32 v33, v66, v67
    v_cvt_pk_bf16_f32 v34, v92, v93
    v_cvt_pk_bf16_f32 v35, v94, v95
    buffer_store_dwordx4 v[32:35], v2, s[16:19], s34 offen sc1
    s_mul_i32 s33, s24, 7
    s_add_u32 s33, s33, 1
    s_lshr_b32 s34, s33, 1
    s_lshl_b32 s34, s34, 15
    s_and_b32 s33, s33, 1
    s_lshl_b32 s33, s33, 11
    s_add_u32 s34, s34, s33
    s_add_u32 s34, s34, s64
    v_cvt_pk_bf16_f32 v36, v68, v69
    v_cvt_pk_bf16_f32 v37, v70, v71
    v_cvt_pk_bf16_f32 v38, v96, v97
    v_cvt_pk_bf16_f32 v39, v98, v99
    buffer_store_dwordx4 v[36:39], v2, s[16:19], s34 offen sc1
    s_mul_i32 s33, s24, 7
    s_add_u32 s33, s33, 2
    s_lshr_b32 s34, s33, 1
    s_lshl_b32 s34, s34, 15
    s_and_b32 s33, s33, 1
    s_lshl_b32 s33, s33, 11
    s_add_u32 s34, s34, s33
    s_add_u32 s34, s34, s64
    v_cvt_pk_bf16_f32 v32, v72, v73
    v_cvt_pk_bf16_f32 v33, v74, v75
    v_cvt_pk_bf16_f32 v34, v100, v101
    v_cvt_pk_bf16_f32 v35, v102, v103
    buffer_store_dwordx4 v[32:35], v2, s[16:19], s34 offen sc1
    s_mul_i32 s33, s24, 7
    s_add_u32 s33, s33, 3
    s_lshr_b32 s34, s33, 1
    s_lshl_b32 s34, s34, 15
    s_and_b32 s33, s33, 1
    s_lshl_b32 s33, s33, 11
    s_add_u32 s34, s34, s33
    s_add_u32 s34, s34, s64
    v_cvt_pk_bf16_f32 v36, v76, v77
    v_cvt_pk_bf16_f32 v37, v78, v79
    v_cvt_pk_bf16_f32 v38, v104, v105
    v_cvt_pk_bf16_f32 v39, v106, v107
    buffer_store_dwordx4 v[36:39], v2, s[16:19], s34 offen sc1
    s_mul_i32 s33, s24, 7
    s_add_u32 s33, s33, 4
    s_lshr_b32 s34, s33, 1
    s_lshl_b32 s34, s34, 15
    s_and_b32 s33, s33, 1
    s_lshl_b32 s33, s33, 11
    s_add_u32 s34, s34, s33
    s_add_u32 s34, s34, s64
    v_cvt_pk_bf16_f32 v32, v80, v81
    v_cvt_pk_bf16_f32 v33, v82, v83
    v_cvt_pk_bf16_f32 v34, v108, v109
    v_cvt_pk_bf16_f32 v35, v110, v111
    buffer_store_dwordx4 v[32:35], v2, s[16:19], s34 offen sc1
    s_mul_i32 s33, s24, 7
    s_add_u32 s33, s33, 5
    s_lshr_b32 s34, s33, 1
    s_lshl_b32 s34, s34, 15
    s_and_b32 s33, s33, 1
    s_lshl_b32 s33, s33, 11
    s_add_u32 s34, s34, s33
    s_add_u32 s34, s34, s64
    v_cvt_pk_bf16_f32 v36, v84, v85
    v_cvt_pk_bf16_f32 v37, v86, v87
    v_cvt_pk_bf16_f32 v38, v112, v113
    v_cvt_pk_bf16_f32 v39, v114, v115
    buffer_store_dwordx4 v[36:39], v2, s[16:19], s34 offen sc1
    s_mul_i32 s33, s24, 7
    s_add_u32 s33, s33, 6
    s_lshr_b32 s34, s33, 1
    s_lshl_b32 s34, s34, 15
    s_and_b32 s33, s33, 1
    s_lshl_b32 s33, s33, 11
    s_add_u32 s34, s34, s33
    s_add_u32 s34, s34, s64
    v_cvt_pk_bf16_f32 v32, v88, v89
    v_cvt_pk_bf16_f32 v33, v90, v91
    v_cvt_pk_bf16_f32 v34, v116, v117
    v_cvt_pk_bf16_f32 v35, v118, v119
    buffer_store_dwordx4 v[32:35], v2, s[16:19], s34 offen sc1
    s_lshl_b32 s84, s61, 4
    s_add_u32 s84, s84, s25
    s_lshl_b32 s84, s84, 6
    s_add_u32 s84, s84, 15532032
    s_add_u32 s61, s61, 7
    s_branch Lb_top
Lb_end:
    s_cmp_lt_u32 s60, 2
    s_cbranch_scc1 Lvm_server
    s_mul_i32 s33, s25, 5
    s_add_u32 s33, s33, s60
    s_sub_u32 s33, s33, 2
    s_cmp_ge_u32 s33, 70
    s_cbranch_scc1 Ldone
    s_mul_i32 s34, s33, 4682
    s_lshr_b32 s34, s34, 16
    s_mul_i32 s35, s34, 14
    s_sub_u32 s66, s33, s35
    s_mov_b32 s61, s34
    s_mov_b32 s62, 0
    v_and_b32 v5, 3, v1
    s_lshl_b32 s33, s24, 2
    v_add_u32 v6, s33, v5
    v_lshlrev_b32 v6, 6, v6
    s_lshl_b32 s33, s66, 7
    v_mov_b32 v8, s33
    v_lshrrev_b32 v3, 4, v1
    v_and_b32 v4, 15, v1
    v_lshrrev_b32 v5, 2, v4
    v_lshlrev_b32 v9, 3, v5
    v_and_b32 v5, 3, v4
    v_add_u32 v9, v9, v5
    s_and_b32 s33, s24, 1
    s_lshl_b32 s33, s33, 2
    v_add_u32 v9, s33, v9
    v_mul_u32_u24 v9, 896, v9
    v_lshl_add_u32 v9, v3, 3, v9
    s_lshl_b32 s33, s66, 6
    s_lshr_b32 s34, s24, 1
    s_lshl_b32 s34, s34, 5
    s_add_u32 s33, s33, s34
    v_add_u32 v9, s33, v9
    s_lshl_b32 s33, s24, 12
    v_add_u32 v10, s33, v2
    s_lshl_b32 s33, s24, 10
    v_add_u32 v11, s33, v2
Lpv_top:
    s_cmp_ge_u32 s61, 64
    s_cbranch_scc1 Ldone
    s_lshl_b32 s33, s61, 10
    s_add_u32 s64, s33, 15532032
Lwf_104:
    buffer_load_dword v128, v6, s[16:19], s64 offen sc1
    s_waitcnt vmcnt(0)
    v_cmp_eq_u32 vcc, -1, v128
    s_cbranch_vccz Lwk_105
    s_sleep 4
    s_sub_u32 s28, s28, 1
    s_cbranch_scc0 Lwf_104
    s_branch Lfail
Lwk_105:
    s_mul_i32 s64, s61, 458752
    s_lshl_b32 s33, s66, 15
    s_add_u32 s64, s64, s33
    s_lshl_b32 s33, s24, 13
    s_add_u32 s64, s64, s33
    s_add_u32 s64, s64, 16777216
    s_add_u32 s65, s64, 4096
    buffer_load_dwordx4 v[16:19], v2, s[16:19], s64 offen offset:0 sc1
    buffer_load_dwordx4 v[24:27], v2, s[16:19], s64 offen offset:1024 sc1
    buffer_load_dwordx4 v[20:23], v2, s[16:19], s64 offen offset:2048 sc1
    buffer_load_dwordx4 v[28:31], v2, s[16:19], s64 offen offset:3072 sc1
    buffer_load_dwordx4 v[32:35], v2, s[16:19], s65 offen offset:0 sc1
    buffer_load_dwordx4 v[40:43], v2, s[16:19], s65 offen offset:1024 sc1
    buffer_load_dwordx4 v[36:39], v2, s[16:19], s65 offen offset:2048 sc1
    buffer_load_dwordx4 v[44:47], v2, s[16:19], s65 offen offset:3072 sc1
    s_lshl_b32 s33, s61, 10
    s_add_u32 s65, s33, 15663104
Lwf_106:
    buffer_load_dword v128, v6, s[16:19], s65 offen sc1
    s_waitcnt vmcnt(0)
    v_cmp_eq_u32 vcc, -1, v128
    s_cbranch_vccz Lwk_107
    s_sleep 4
    s_sub_u32 s28, s28, 1
    s_cbranch_scc0 Lwf_106
    s_branch Lfail
Lwk_107:
    s_mul_i32 s64, s61, 114688
    s_lshl_b32 s33, s66, 13
    s_add_u32 s64, s64, s33
    s_lshl_b32 s33, s24, 10
    s_add_u32 s64, s64, s33
    s_add_u32 s64, s64, 46137344
    s_add_u32 s65, s64, 4096
    buffer_load_dwordx4 v[48:51], v2, s[16:19], s64 offen sc1
    buffer_load_dwordx4 v[52:55], v2, s[16:19], s65 offen sc1
    s_lshl_b32 s33, s61, 10
    s_add_u32 s65, s33, 15597568
Lwf_108:
    buffer_load_dword v128, v6, s[16:19], s65 offen sc1
    s_waitcnt vmcnt(0)
    v_cmp_eq_u32 vcc, -1, v128
    s_cbranch_vccz Lwk_109
    s_sleep 4
    s_sub_u32 s28, s28, 1
    s_cbranch_scc0 Lwf_108
    s_branch Lfail
Lwk_109:
    s_lshl_b32 s64, s61, 15
    s_lshl_b32 s33, s24, 13
    s_add_u32 s64, s64, s33
    s_add_u32 s64, s64, 69206016
    s_add_u32 s65, s64, 4096
    buffer_load_dwordx4 v[64:67], v2, s[16:19], s64 offen offset:0 sc1
    buffer_load_dwordx4 v[68:71], v2, s[16:19], s64 offen offset:1024 sc1
    buffer_load_dwordx4 v[72:75], v2, s[16:19], s64 offen offset:2048 sc1
    buffer_load_dwordx4 v[76:79], v2, s[16:19], s64 offen offset:3072 sc1
    buffer_load_dwordx4 v[80:83], v2, s[16:19], s65 offen offset:0 sc1
    buffer_load_dwordx4 v[84:87], v2, s[16:19], s65 offen offset:1024 sc1
    buffer_load_dwordx4 v[88:91], v2, s[16:19], s65 offen offset:2048 sc1
    buffer_load_dwordx4 v[92:95], v2, s[16:19], s65 offen offset:3072 sc1
    s_lshl_b32 s64, s61, 13
    s_lshl_b32 s33, s24, 11
    s_add_u32 s64, s64, s33
    s_add_u32 s64, s64, 71303168
    buffer_load_dwordx4 v[96:99], v2, s[16:19], s64 offen offset:0 sc1
    buffer_load_dwordx4 v[100:103], v2, s[16:19], s64 offen offset:1024 sc1
    s_waitcnt vmcnt(9)
    v_mfma_f32_16x16x32_bf16 v[112:115], v[16:19], v[64:67], 0
    v_mfma_f32_16x16x32_bf16 v[120:123], v[20:23], v[64:67], 0
    s_waitcnt vmcnt(8)
    v_mfma_f32_16x16x32_bf16 v[116:119], v[16:19], v[68:71], 0
    v_mfma_f32_16x16x32_bf16 v[124:127], v[20:23], v[68:71], 0
    s_waitcnt vmcnt(7)
    v_mfma_f32_16x16x32_bf16 v[112:115], v[24:27], v[72:75], v[112:115]
    v_mfma_f32_16x16x32_bf16 v[120:123], v[28:31], v[72:75], v[120:123]
    s_waitcnt vmcnt(6)
    v_mfma_f32_16x16x32_bf16 v[116:119], v[24:27], v[76:79], v[116:119]
    v_mfma_f32_16x16x32_bf16 v[124:127], v[28:31], v[76:79], v[124:127]
    s_waitcnt vmcnt(5)
    v_mfma_f32_16x16x32_bf16 v[112:115], v[32:35], v[80:83], v[112:115]
    v_mfma_f32_16x16x32_bf16 v[120:123], v[36:39], v[80:83], v[120:123]
    s_waitcnt vmcnt(4)
    v_mfma_f32_16x16x32_bf16 v[116:119], v[32:35], v[84:87], v[116:119]
    v_mfma_f32_16x16x32_bf16 v[124:127], v[36:39], v[84:87], v[124:127]
    s_waitcnt vmcnt(3)
    v_mfma_f32_16x16x32_bf16 v[112:115], v[40:43], v[88:91], v[112:115]
    v_mfma_f32_16x16x32_bf16 v[120:123], v[44:47], v[88:91], v[120:123]
    s_waitcnt vmcnt(2)
    v_mfma_f32_16x16x32_bf16 v[116:119], v[40:43], v[92:95], v[116:119]
    v_mfma_f32_16x16x32_bf16 v[124:127], v[44:47], v[92:95], v[124:127]
    s_waitcnt vmcnt(1)
    v_mfma_f32_16x16x32_bf16 v[112:115], v[48:51], v[96:99], v[112:115]
    v_mfma_f32_16x16x32_bf16 v[120:123], v[52:55], v[96:99], v[120:123]
    s_waitcnt vmcnt(0)
    v_mfma_f32_16x16x32_bf16 v[116:119], v[48:51], v[100:103], v[116:119]
    v_mfma_f32_16x16x32_bf16 v[124:127], v[52:55], v[100:103], v[124:127]
    v_add_u32 v5, s62, v10
    s_nop 2
    ds_write_b128 v5, v[112:115] offset:0
    s_nop 1
    ds_write_b128 v5, v[116:119] offset:1024
    ds_write_b128 v5, v[120:123] offset:2048
    ds_write_b128 v5, v[124:127] offset:3072
    s_waitcnt lgkmcnt(0)
    s_barrier
    v_add_u32 v5, s62, v11
    ds_read_b128 v[128:131], v5 offset:0
    ds_read_b128 v[132:135], v5 offset:4096
    ds_read_b128 v[136:139], v5 offset:8192
    ds_read_b128 v[140:143], v5 offset:12288
    s_waitcnt lgkmcnt(2)
    v_add_f32 v128, v128, v132
    s_waitcnt lgkmcnt(0)
    v_add_f32 v136, v136, v140
    v_add_f32 v129, v129, v133
    v_add_f32 v137, v137, v141
    v_add_f32 v130, v130, v134
    v_add_f32 v138, v138, v142
    v_add_f32 v131, v131, v135
    v_add_f32 v139, v139, v143
    v_add_f32 v128, v128, v136
    v_add_f32 v129, v129, v137
    v_add_f32 v130, v130, v138
    v_add_f32 v131, v131, v139
    v_cvt_pk_bf16_f32 v144, v128, v129
    v_cvt_pk_bf16_f32 v145, v130, v131
    s_mul_i32 s33, s61, 28672
    buffer_store_dwordx2 v[144:145], v9, s[56:59], s33 offen
    s_xor_b32 s62, s62, 16384
    s_add_u32 s61, s61, 5
    s_branch Lpv_top
Lvm_server:
    v_lshrrev_b32 v6, 4, v1
    v_lshlrev_b32 v8, 4, v0
    v_lshrrev_b32 v5, 4, v0
    v_lshlrev_b32 v5, 7, v5
    v_add_u32 v9, v8, v5
    v_mul_u32_u24 v10, 384, v6
    v_bfe_u32 v5, v1, 3, 1
    v_lshl_add_u32 v10, v5, 6, v10
    v_bfe_u32 v5, v1, 1, 1
    v_lshl_add_u32 v10, v5, 5, v10
    v_bfe_u32 v5, v1, 2, 1
    v_lshl_add_u32 v10, v5, 4, v10
    v_and_b32 v5, 1, v1
    v_lshl_add_u32 v10, v5, 3, v10
    v_mov_b32 v11, 0x4444
    v_mov_b32 v5, 0xeeee
    v_cndmask_b32 v11, v11, v5, s[38:39]
    v_and_b32 v5, 15, v1
    v_lshlrev_b32 v12, 4, v5
    v_lshrrev_b32 v5, 5, v1
    v_lshl_add_u32 v12, v5, 12, v12
    v_and_b32 v5, 1, v6
    v_lshl_add_u32 v12, v5, 3, v12
    s_and_b32 s33, s25, 3
    s_lshl_b32 s33, s33, 8
    v_add_u32 v12, s33, v12
    s_mov_b32 s61, s60
    s_mov_b32 s84, -1
Lvm_top:
    s_waitcnt vmcnt(0)
    s_barrier
    s_cmp_eq_u32 s84, -1
    s_cbranch_scc1 Lvs_110
    s_cmp_eq_u32 s24, 0
    s_cbranch_scc0 Lvs_110
    s_mov_b64 exec, 1
    buffer_store_dword v7, v4, s[16:19], s84 offen sc1
    s_mov_b64 exec, -1
Lvs_110:
    s_cmp_ge_u32 s61, 64
    s_cbranch_scc1 Ldone
    s_mul_i32 s64, s61, 7168
    s_add_u32 s64, s64, 14155776
    s_add_u32 s65, s64, 4096
    v_mov_b64 v[64:65], 0
    v_mov_b64 v[66:67], 0
    v_mov_b64 v[68:69], 0
    v_mov_b64 v[70:71], 0
    v_mov_b64 v[72:73], 0
    v_mov_b64 v[74:75], 0
    v_mov_b64 v[76:77], 0
    v_mov_b64 v[78:79], 0
    v_mov_b64 v[80:81], 0
    v_mov_b64 v[82:83], 0
    v_mov_b64 v[84:85], 0
    v_mov_b64 v[86:87], 0
    v_mov_b64 v[88:89], 0
    v_mov_b64 v[90:91], 0
    s_cmp_eq_u32 s24, 3
    s_cbranch_scc1 Lvm_p1
Lvm_p2:
    buffer_load_dwordx4 v[16:19], v8, s[16:19], s64 offen sc1
    buffer_load_dwordx4 v[20:23], v8, s[16:19], s65 offen sc1
    s_waitcnt vmcnt(0)
    v_max3_u32 v24, v16, v17, v18
    v_max_u32 v24, v24, v19
    v_max3_u32 v25, v20, v21, v22
    v_max_u32 v25, v25, v23
    v_max_u32 v24, v24, v25
    v_cmp_eq_u32 vcc, -1, v24
    s_cbranch_vccz Lok_111
    s_sleep 4
    s_sub_u32 s28, s28, 1
    s_cbranch_scc0 Lvm_p2
    s_branch Lfail
Lok_111:
    ds_write_b128 v9, v[16:19]
    ds_write_b128 v9, v[20:23] offset:6144
    s_branch Lvm_pj
Lvm_p1:
    buffer_load_dwordx4 v[16:19], v8, s[16:19], s64 offen sc1
    s_waitcnt vmcnt(0)
    v_max_u32 v24, v16, v17
    v_max_u32 v25, v18, v19
    v_max_u32 v24, v24, v25
    v_cmp_eq_u32 vcc, -1, v24
    s_cbranch_vccz Lok_112
    s_sleep 4
    s_sub_u32 s28, s28, 1
    s_cbranch_scc0 Lvm_p1
    s_branch Lfail
Lok_112:
    ds_write_b128 v9, v[16:19]
Lvm_pj:
    s_waitcnt lgkmcnt(0)
    s_barrier
    ds_read_b64_tr_b16 v[32:33], v10 offset:0
    ds_read_b64_tr_b16 v[34:35], v10 offset:128
    ds_read_b64_tr_b16 v[36:37], v10 offset:1536
    ds_read_b64_tr_b16 v[38:39], v10 offset:1664
    ds_read_b64_tr_b16 v[40:41], v10 offset:3072
    ds_read_b64_tr_b16 v[42:43], v10 offset:3200
    ds_read_b64_tr_b16 v[44:45], v10 offset:4608
    ds_read_b64_tr_b16 v[46:47], v10 offset:4736
    ds_read_b64_tr_b16 v[48:49], v10 offset:6144
    ds_read_b64_tr_b16 v[50:51], v10 offset:6272
    ds_read_b64_tr_b16 v[52:53], v10 offset:7680
    ds_read_b64_tr_b16 v[54:55], v10 offset:7808
    ds_read_b64_tr_b16 v[56:57], v10 offset:9216
    ds_read_b64_tr_b16 v[58:59], v10 offset:9344
    s_waitcnt lgkmcnt(12)
    v_smfmac_f32_16x16x64_bf16 v[64:67], v[32:35], a[0:7], v11
    s_waitcnt lgkmcnt(10)
    v_smfmac_f32_16x16x64_bf16 v[64:67], v[36:39], a[8:15], v11
    s_waitcnt lgkmcnt(8)
    v_smfmac_f32_16x16x64_bf16 v[64:67], v[40:43], a[16:23], v11
    s_waitcnt lgkmcnt(6)
    v_smfmac_f32_16x16x64_bf16 v[64:67], v[44:47], a[24:31], v11
    s_waitcnt lgkmcnt(4)
    v_smfmac_f32_16x16x64_bf16 v[64:67], v[48:51], a[32:39], v11
    s_waitcnt lgkmcnt(2)
    v_smfmac_f32_16x16x64_bf16 v[64:67], v[52:55], a[40:47], v11
    s_waitcnt lgkmcnt(0)
    v_smfmac_f32_16x16x64_bf16 v[64:67], v[56:59], a[48:55], v11
    v_smfmac_f32_16x16x64_bf16 v[68:71], v[32:35], a[56:63], v11
    v_smfmac_f32_16x16x64_bf16 v[68:71], v[36:39], a[64:71], v11
    v_smfmac_f32_16x16x64_bf16 v[68:71], v[40:43], a[72:79], v11
    v_smfmac_f32_16x16x64_bf16 v[68:71], v[44:47], a[80:87], v11
    v_smfmac_f32_16x16x64_bf16 v[68:71], v[48:51], a[88:95], v11
    v_smfmac_f32_16x16x64_bf16 v[68:71], v[52:55], a[96:103], v11
    v_smfmac_f32_16x16x64_bf16 v[68:71], v[56:59], a[104:111], v11
    v_smfmac_f32_16x16x64_bf16 v[72:75], v[32:35], a[112:119], v11
    v_smfmac_f32_16x16x64_bf16 v[72:75], v[36:39], a[120:127], v11
    v_smfmac_f32_16x16x64_bf16 v[72:75], v[40:43], a[128:135], v11
    v_smfmac_f32_16x16x64_bf16 v[72:75], v[44:47], a[136:143], v11
    v_smfmac_f32_16x16x64_bf16 v[72:75], v[48:51], a[144:151], v11
    v_smfmac_f32_16x16x64_bf16 v[72:75], v[52:55], a[152:159], v11
    v_smfmac_f32_16x16x64_bf16 v[72:75], v[56:59], a[160:167], v11
    v_smfmac_f32_16x16x64_bf16 v[76:79], v[32:35], a[168:175], v11
    v_smfmac_f32_16x16x64_bf16 v[76:79], v[36:39], a[176:183], v11
    v_smfmac_f32_16x16x64_bf16 v[76:79], v[40:43], a[184:191], v11
    v_smfmac_f32_16x16x64_bf16 v[76:79], v[44:47], a[192:199], v11
    v_smfmac_f32_16x16x64_bf16 v[76:79], v[48:51], a[200:207], v11
    v_smfmac_f32_16x16x64_bf16 v[76:79], v[52:55], a[208:215], v11
    v_smfmac_f32_16x16x64_bf16 v[76:79], v[56:59], a[216:223], v11
    v_smfmac_f32_16x16x64_bf16 v[80:83], v[32:35], a[224:231], v11
    v_smfmac_f32_16x16x64_bf16 v[80:83], v[36:39], a[232:239], v11
    v_smfmac_f32_16x16x64_bf16 v[80:83], v[40:43], a[240:247], v11
    v_smfmac_f32_16x16x64_bf16 v[80:83], v[44:47], a[248:255], v11
    v_smfmac_f32_16x16x64_bf16 v[80:83], v[48:51], v[120:127], v11
    v_smfmac_f32_16x16x64_bf16 v[80:83], v[52:55], v[128:135], v11
    v_smfmac_f32_16x16x64_bf16 v[80:83], v[56:59], v[136:143], v11
    v_smfmac_f32_16x16x64_bf16 v[84:87], v[32:35], v[144:151], v11
    v_smfmac_f32_16x16x64_bf16 v[84:87], v[36:39], v[152:159], v11
    v_smfmac_f32_16x16x64_bf16 v[84:87], v[40:43], v[160:167], v11
    v_smfmac_f32_16x16x64_bf16 v[84:87], v[44:47], v[168:175], v11
    v_smfmac_f32_16x16x64_bf16 v[84:87], v[48:51], v[176:183], v11
    v_smfmac_f32_16x16x64_bf16 v[84:87], v[52:55], v[184:191], v11
    v_smfmac_f32_16x16x64_bf16 v[84:87], v[56:59], v[192:199], v11
    v_smfmac_f32_16x16x64_bf16 v[88:91], v[32:35], v[200:207], v11
    v_smfmac_f32_16x16x64_bf16 v[88:91], v[36:39], v[208:215], v11
    v_smfmac_f32_16x16x64_bf16 v[88:91], v[40:43], v[216:223], v11
    v_smfmac_f32_16x16x64_bf16 v[88:91], v[44:47], v[224:231], v11
    v_smfmac_f32_16x16x64_bf16 v[88:91], v[48:51], v[232:239], v11
    v_smfmac_f32_16x16x64_bf16 v[88:91], v[52:55], v[240:247], v11
    v_smfmac_f32_16x16x64_bf16 v[88:91], v[56:59], v[248:255], v11
    s_mul_i32 s64, s61, 114688
    s_add_u32 s64, s64, 46137344
    s_lshr_b32 s33, s25, 2
    s_lshl_b32 s33, s33, 10
    s_add_u32 s64, s64, s33
    s_mul_i32 s33, s24, 28672
    s_add_u32 s64, s64, s33
    v_permlane32_swap_b32 v64, v68
    v_permlane32_swap_b32 v65, v69
    v_permlane32_swap_b32 v66, v70
    v_permlane32_swap_b32 v67, v71
    v_pk_add_f32 v[64:65], v[64:65], v[68:69]
    v_pk_add_f32 v[66:67], v[66:67], v[70:71]
    v_cvt_pk_bf16_f32 v92, v64, v65
    v_cvt_pk_bf16_f32 v93, v66, v67
    buffer_store_dwordx2 v[92:93], v12, s[16:19], s64 offen sc1
    s_add_u32 s64, s64, 8192
    v_permlane32_swap_b32 v72, v76
    v_permlane32_swap_b32 v73, v77
    v_permlane32_swap_b32 v74, v78
    v_permlane32_swap_b32 v75, v79
    v_pk_add_f32 v[72:73], v[72:73], v[76:77]
    v_pk_add_f32 v[74:75], v[74:75], v[78:79]
    v_cvt_pk_bf16_f32 v94, v72, v73
    v_cvt_pk_bf16_f32 v95, v74, v75
    buffer_store_dwordx2 v[94:95], v12, s[16:19], s64 offen sc1
    s_add_u32 s64, s64, 8192
    v_permlane32_swap_b32 v80, v84
    v_permlane32_swap_b32 v81, v85
    v_permlane32_swap_b32 v82, v86
    v_permlane32_swap_b32 v83, v87
    v_pk_add_f32 v[80:81], v[80:81], v[84:85]
    v_pk_add_f32 v[82:83], v[82:83], v[86:87]
    v_cvt_pk_bf16_f32 v96, v80, v81
    v_cvt_pk_bf16_f32 v97, v82, v83
    buffer_store_dwordx2 v[96:97], v12, s[16:19], s64 offen sc1
    s_add_u32 s64, s64, 8192
    v_mov_b32 v100, v88
    v_mov_b32 v101, v89
    v_mov_b32 v102, v90
    v_mov_b32 v103, v91
    v_permlane32_swap_b32 v88, v100
    v_permlane32_swap_b32 v89, v101
    v_permlane32_swap_b32 v90, v102
    v_permlane32_swap_b32 v91, v103
    v_pk_add_f32 v[88:89], v[88:89], v[100:101]
    v_pk_add_f32 v[90:91], v[90:91], v[102:103]
    v_cvt_pk_bf16_f32 v98, v88, v89
    v_cvt_pk_bf16_f32 v99, v90, v91
    s_mov_b32 exec_hi, 0
    buffer_store_dwordx2 v[98:99], v12, s[16:19], s64 offen sc1
    s_mov_b64 exec, -1
    s_lshl_b32 s84, s61, 4
    s_add_u32 s84, s84, s25
    s_lshl_b32 s84, s84, 6
    s_add_u32 s84, s84, 15663104
    s_add_u32 s61, s61, 2
    s_branch Lvm_top
Lexit0:
    s_endpgm
.section .rodata,"a"
.p2align 6
.amdhsa_kernel standalone__memory_aug_recurrent_mem_tr__prompt_kernel
  .amdhsa_next_free_vgpr 512
  .amdhsa_next_free_sgpr 102
  .amdhsa_accum_offset 256
  .amdhsa_group_segment_fixed_size 0
  .amdhsa_kernarg_size 80
  .amdhsa_user_sgpr_count 2
  .amdhsa_user_sgpr_kernarg_segment_ptr 1
  .amdhsa_system_sgpr_workgroup_id_x 1
.end_amdhsa_kernel
```
